```python
import torch

def _softmax(x, axis=-1):
    return torch.softmax(x, dim=axis)
def _gelu(x):
    return torch.nn.functional.gelu(x, approximate="tanh")
def _silu(x):
    return torch.nn.functional.silu(x)
def _sigmoid(x):
    return torch.sigmoid(x)
def _layernorm(x, axis=-1, eps=1e-5):
    m = x.mean(dim=axis, keepdim=True)
    v = x.var(dim=axis, keepdim=True, unbiased=False)
    return (x - m) / torch.sqrt(v + eps)
def _scatter_add(tgt, idx, src, axis=0):
    return tgt.clone().index_add_(axis, idx, src)
def _segment_sum(src, seg, n):
    out = torch.zeros((n,) + src.shape[1:], dtype=src.dtype)
    return out.index_add_(0, seg, src)
def _pad(x, pw):
    flat = tuple(v for pair in reversed(pw) for v in pair)
    return torch.nn.functional.pad(x, flat)

kernel_name = 'parallel_sum__sliding_local_dilated__glu_gated_reglu__prompt'

def setup_inputs():

    _w = (lambda a: (lambda t: t.to(torch.bfloat16) if t.is_floating_point() else t)(torch.as_tensor(a)))
    def _A_setup():
        B, S, D = 1, 2048, 512
        return {
            "x": _w((lambda *s: torch.randn(*s, dtype=torch.bfloat16) * 0.05)(B, S, D)),
            "wqkv": _w((lambda *s: torch.randn(*s, dtype=torch.bfloat16) * 0.05)(D, 3 * D)),
            "wo": _w((lambda *s: torch.randn(*s, dtype=torch.bfloat16) * 0.05)(D, D)),
        }
    _A_in = _A_setup()

    def _B_setup():
        B, S, D, F = 1, 2048, 512, 1792
        return {
            "x": _w((lambda *s: torch.randn(*s, dtype=torch.bfloat16) * 0.05)(B, S, D)),
            "W_gate": _w((lambda *s: torch.randn(*s, dtype=torch.bfloat16) * 0.8)(D, F) * (2.0 / D) ** 0.5),
            "W_up": _w((lambda *s: torch.randn(*s, dtype=torch.bfloat16) * 0.8)(D, F) * (2.0 / D) ** 0.5),
            "W_down": _w((lambda *s: torch.randn(*s, dtype=torch.bfloat16) * 0.8)(F, D) * (1.0 / F) ** 0.5),
        }
    _B_in = _B_setup()

    return {
        "A_x": _A_in["x"],
        "A_wqkv": _A_in["wqkv"],
        "A_wo": _A_in["wo"],
        "B_x": _B_in["x"],
        "B_W_gate": _B_in["W_gate"],
        "B_W_up": _B_in["W_up"],
        "B_W_down": _B_in["W_down"],
    }

def reference(A_x, A_wqkv, A_wo, B_x, B_W_gate, B_W_up, B_W_down):
    def _A_ref(x, wqkv, wo):
        B, S, D = x.shape
        H = 32; Dh = D // H
        W, dil = 8, 2
        qkv = (lambda x, *d: x.permute(*d))((x @ wqkv).reshape(B, S, 3, H, Dh), 2, 0, 3, 1, 4)
        q, k, v = qkv[0], qkv[1], qkv[2]
        scale = Dh ** -0.5
        pos = torch.arange(S)
        off = torch.arange(W) * dil
        idx = pos[:, None] - off[None, :]
        mask = idx >= 0
        idx_c = torch.where(mask, idx, 0).reshape(-1)
        kg = k[:, :, idx_c, :].reshape(B, H, S, W, Dh)
        vg = v[:, :, idx_c, :].reshape(B, H, S, W, Dh)
        logits = torch.einsum("bhsd,bhswd->bhsw", q, kg) * scale
        logits = torch.where(mask[None, None, :, :], logits, -1e9)
        attn = _softmax(logits, axis=-1)
        o = torch.einsum("bhsw,bhswd->bhsd", attn, vg)
        return (lambda x, *d: x.permute(*d))(o, 0, 2, 1, 3).reshape(B, S, D) @ wo

    def _B_ref(x, W_gate, W_up, W_down):
        gate = torch.einsum("bsd,df->bsf", x, W_gate)
        up = torch.einsum("bsd,df->bsf", x, W_up)
        gate = gate * (lambda x, dt: x.to(dt))(gate > 0, gate.dtype)
        h = gate * up
        return torch.einsum("bsf,fd->bsd", h, W_down)

    x = A_x
    xn = _layernorm(x, axis=-1)
    return x + _A_ref(xn, A_wqkv, A_wo) + _B_ref(xn, B_W_gate, B_W_up, B_W_down)
```

```asm
; @launch grid=(256,1,1) block=(512,1,1) lds=163840
.amdgcn_target "amdgcn-amd-amdhsa--gfx950"
.text
.globl parallel_sum__sliding_local_dilated__glu_gated_reglu__prompt_kernel
.p2align 8
.type parallel_sum__sliding_local_dilated__glu_gated_reglu__prompt_kernel,@function
parallel_sum__sliding_local_dilated__glu_gated_reglu__prompt_kernel:
    s_load_dwordx2 s[24:25], s[0:1], 0
    s_load_dwordx2 s[28:29], s[0:1], 8
    s_load_dwordx2 s[32:33], s[0:1], 32
    s_load_dwordx2 s[36:37], s[0:1], 40
    s_cmp_ge_u32 s2, 256
    s_cbranch_scc1 L_end
    s_getpc_b64 s[68:69]
L_pc:
    v_lshlrev_b32 v2, 7, v0
    v_lshrrev_b32 v1, 6, v0
    v_min_u32 v2, L_end-L_pc, v2
    v_readfirstlane_b32 s60, v1
    global_load_dword v255, v2, s[68:69]
    v_and_b32 v0, 63, v0
    s_lshl_b32 s61, s2, 2
    s_and_b32 s61, s61, 4
    s_lshr_b32 s68, s2, 3
    s_and_b32 s69, s68, 11
    s_add_u32 s61, s61, s69
    s_and_b32 s62, s2, 6
    s_bfe_u32 s70, s2, 0x10005
    s_add_u32 s62, s62, s70
    s_lshr_b32 s70, s2, 4
    s_and_b32 s70, s70, 8
    s_add_u32 s62, s62, s70
    s_add_u32 s63, s61, s62
    s_and_b32 s63, s63, 7
    s_and_b32 s66, s60, 3
    s_lshl_b32 s81, s66, 12
    s_cmp_lt_u32 s60, 4
    s_cbranch_scc1 L_C
    s_setprio 1
    v_lshrrev_b32 v1, 3, v0
    v_and_b32 v2, 7, v0
    v_lshrrev_b32 v3, 1, v1
    s_lshl_b32 s67, s66, 15
    s_mov_b32 s26, 2097152
    s_mov_b32 s27, 0x20000
    v_xor_b32 v4, v2, v3
    v_lshl_add_u32 v5, v1, 11, s67
    v_lshl_add_u32 v208, v4, 4, v5
    v_xor_b32 v4, 4, v4
    v_lshl_add_u32 v209, v4, 4, v5
    v_add_u32 v209, 16384, v209
    v_add_u32 v210, 1024, v208
    v_add_u32 v211, 1024, v209
    s_lshl_b32 s76, s61, 17
    s_lshl_b32 s71, s63, 7
    s_add_u32 s71, s71, s76
    s_add_u32 m0, s81, 81920
    s_waitcnt lgkmcnt(0)
    buffer_load_dwordx4 v208, s[24:27], s71 offen lds
    s_add_u32 m0, s81, 82944
    s_nop 0
    buffer_load_dwordx4 v209, s[24:27], s71 offen lds
    s_add_u32 m0, s81, 83968
    s_nop 0
    buffer_load_dwordx4 v210, s[24:27], s71 offen lds
    s_add_u32 m0, s81, 84992
    s_nop 0
    buffer_load_dwordx4 v211, s[24:27], s71 offen lds
    s_mov_b32 s30, 1572864
    s_mov_b32 s31, 0x20000
    s_mov_b32 s34, 1835008
    s_mov_b32 s35, 0x20000
    s_mov_b32 s38, 1835008
    s_mov_b32 s39, 0x20000
    s_cmp_lt_u32 s62, 8
    s_cbranch_scc1 L_HA
    s_lshl_b32 s80, s66, 11
    s_lshl_b32 s82, s66, 9
    s_lshl_b32 s67, s66, 4
    v_and_b32 v4, 1, v3
    v_lshlrev_b32 v4, 1, v4
    v_xor_b32 v4, v4, v2
    v_xor_b32 v6, 4, v4
    v_add_u32 v5, s67, v1
    v_add_u32 v7, 8, v5
    v_mul_u32_u24 v8, 3584, v5
    v_mul_u32_u24 v9, 3584, v7
    v_lshl_add_u32 v215, v4, 4, v8
    v_lshl_add_u32 v216, v6, 4, v9
    v_lshrrev_b32 v10, 2, v4
    v_and_b32 v11, 1, v4
    v_lshl_add_u32 v10, v10, 1, v11
    v_lshl_add_u32 v217, v10, 4, v8
    v_lshrrev_b32 v10, 2, v6
    v_and_b32 v11, 1, v6
    v_lshl_add_u32 v10, v10, 1, v11
    v_lshl_add_u32 v218, v10, 4, v9
    v_and_b32 v10, 2, v4
    v_cmp_eq_u32 s[86:87], 0, v10
    s_and_b32 s67, s62, 7
    s_mul_i32 s67, s67, 320
    s_add_u32 s67, s67, 1024
    s_and_b32 s68, s62, 1
    s_lshl_b32 s69, s68, 6
    s_add_u32 s78, s67, s69
    s_xor_b32 s68, s68, 1
    s_lshl_b32 s68, s68, 8
    s_add_u32 s79, s67, s68
    s_add_u32 s67, s63, 0
    s_and_b32 s67, s67, 7
    s_lshl_b32 s71, s67, 7
    s_add_u32 s71, s71, s76
    s_mul_i32 s68, s67, 229376
    s_add_u32 s73, s68, s78
    s_add_u32 s74, s68, s79
    s_add_u32 m0, s80, 0
    s_nop 0
    buffer_load_dwordx4 v215, s[32:35], s73 offen lds
    s_add_u32 m0, s80, 1024
    s_nop 0
    buffer_load_dwordx4 v216, s[32:35], s73 offen lds
    s_add_u32 m0, s80, 8192
    s_nop 0
    buffer_load_dwordx4 v215, s[36:39], s73 offen lds
    s_add_u32 m0, s80, 9216
    s_nop 0
    buffer_load_dwordx4 v216, s[36:39], s73 offen lds
    s_branch L_HB
L_HA:
    s_lshl_b32 s80, s66, 11
    s_lshl_b32 s82, s66, 9
    s_lshl_b32 s67, s66, 4
    v_and_b32 v4, 1, v3
    v_lshlrev_b32 v4, 1, v4
    v_xor_b32 v4, v4, v2
    v_xor_b32 v6, 4, v4
    v_add_u32 v5, s67, v1
    v_add_u32 v7, 8, v5
    v_mul_u32_u24 v8, 3584, v5
    v_mul_u32_u24 v9, 3584, v7
    v_lshl_add_u32 v215, v4, 4, v8
    v_lshl_add_u32 v216, v6, 4, v9
    v_mul_u32_u24 v8, 3072, v5
    v_mul_u32_u24 v9, 3072, v7
    v_lshl_add_u32 v213, v4, 4, v8
    v_lshl_add_u32 v214, v6, 4, v9
    s_lshl_b32 s77, s62, 7
    s_mov_b32 s78, s77
    s_lshl_b32 s67, s66, 2
    v_and_b32 v10, 3, v1
    v_add_u32 v10, s67, v10
    v_and_b32 v11, 7, v10
    v_lshrrev_b32 v12, 3, v10
    v_lshl_add_u32 v11, v11, 1, v12
    v_lshlrev_b32 v11, 10, v11
    v_lshrrev_b32 v12, 1, v10
    v_xor_b32 v12, v12, v2
    v_lshl_add_u32 v212, v12, 4, v11
    s_cmp_eq_u32 s61, 0
    s_cselect_b32 s79, 0, 16384
    s_add_u32 s67, s63, 0
    s_and_b32 s67, s67, 7
    s_lshl_b32 s71, s67, 7
    s_add_u32 s71, s71, s76
    s_mul_i32 s68, s67, 229376
    s_add_u32 s73, s68, s78
    s_mul_i32 s72, s67, 196608
    s_add_u32 s72, s72, s77
    s_sub_u32 s74, s71, s79
    s_add_u32 m0, s80, 0
    s_nop 0
    buffer_load_dwordx4 v213, s[28:31], s72 offen lds
    s_add_u32 m0, s80, 1024
    s_nop 0
    buffer_load_dwordx4 v214, s[28:31], s72 offen lds
    s_mov_b32 exec_hi, 0
    s_add_u32 m0, s82, 114688
    s_nop 0
    buffer_load_dwordx4 v212, s[24:27], s74 offen lds
    s_mov_b64 exec, -1
    s_add_u32 m0, s80, 8192
    s_nop 0
    buffer_load_dwordx4 v215, s[32:35], s73 offen lds
    s_add_u32 m0, s80, 9216
    s_nop 0
    buffer_load_dwordx4 v216, s[32:35], s73 offen lds
    s_load_dwordx2 s[44:45], s[0:1], 16
    s_load_dwordx2 s[40:41], s[0:1], 48
    s_load_dwordx2 s[52:53], s[0:1], 56
    s_load_dwordx2 s[56:57], s[0:1], 64
    s_load_dwordx2 s[48:49], s[0:1], 72
    s_and_b32 s67, s2, 7
    s_lshr_b32 s68, s2, 3
    s_lshr_b32 s70, s68, 4
    s_lshl_b32 s70, s70, 1
    s_and_b32 s69, s68, 1
    s_add_u32 s69, s69, s70
    s_lshl_b32 s64, s67, 2
    s_add_u32 s64, s64, s69
    s_bfe_u32 s65, s68, 0x30001
    s_add_u32 s83, s81, 118784
    s_and_b32 s84, s63, 1
    s_lshl_b32 s84, s84, 1
    s_lshr_b32 s70, s61, 3
    s_add_u32 s97, s84, s70
    s_lshr_b32 s70, s62, 3
    s_add_u32 s84, s84, s70
    s_mov_b32 s42, 1835008
    s_mov_b32 s43, 0x20000
    s_mov_b32 s46, 524288
    s_mov_b32 s47, 0x20000
    s_mov_b32 s50, 268435456
    s_mov_b32 s51, 0x20000
    s_mov_b32 s54, 2097152
    s_mov_b32 s55, 0x20000
    s_mov_b32 s58, 256
    s_mov_b32 s59, 0x20000
    s_waitcnt lgkmcnt(0)
    v_mov_b32 v233, v0
    v_lshrrev_b32 v1, 3, v0
    v_and_b32 v2, 7, v0
    v_bfe_u32 v3, v1, 1, 2
    v_lshlrev_b32 v3, 1, v3
    v_xor_b32 v3, v3, v2
    v_lshlrev_b32 v1, 10, v1
    v_lshl_add_u32 v219, v3, 4, v1
    v_lshrrev_b32 v1, 2, v233
    v_and_b32 v2, 3, v233
    v_lshlrev_b32 v3, 7, v1
    v_lshl_add_u32 v3, v2, 3, v3
    v_add_u32 v3, s83, v3
    v_bfe_u32 v1, v1, 1, 2
    v_xor_b32 v2, 0, v1
    v_lshl_add_u32 v220, v2, 5, v3
    v_xor_b32 v2, 1, v1
    v_lshl_add_u32 v221, v2, 5, v3
    v_xor_b32 v2, 2, v1
    v_lshl_add_u32 v222, v2, 5, v3
    v_xor_b32 v2, 3, v1
    v_lshl_add_u32 v223, v2, 5, v3
    s_lshr_b32 s67, s64, 1
    s_lshl_b32 s67, s67, 4
    s_add_u32 s67, s67, s60
    s_lshl_b32 s67, s67, 7
    s_and_b32 s68, s64, 1
    s_lshl_b32 s68, s68, 3
    s_add_u32 s67, s67, s68
    s_add_u32 s100, s67, 16777216
    s_add_u32 s99, s64, s65
    s_mul_i32 s67, s99, 52
    s_lshr_b32 s67, s67, 8
    s_mul_i32 s67, s67, 5
    s_sub_u32 s67, s99, s67
    s_mul_i32 s68, s60, 5
    s_add_u32 s68, s68, 16
    s_lshl_b32 s70, s65, 7
    s_add_u32 s69, s67, 0
    s_cmp_ge_u32 s69, 5
    s_cselect_b32 s88, 5, 0
    s_sub_u32 s69, s69, s88
    s_add_u32 s69, s69, s68
    s_lshl_b32 s69, s69, 15
    s_add_u32 s88, s69, s70
    s_add_u32 s69, s67, 1
    s_cmp_ge_u32 s69, 5
    s_cselect_b32 s89, 5, 0
    s_sub_u32 s69, s69, s89
    s_add_u32 s69, s69, s68
    s_lshl_b32 s69, s69, 15
    s_add_u32 s89, s69, s70
    s_add_u32 s69, s67, 2
    s_cmp_ge_u32 s69, 5
    s_cselect_b32 s90, 5, 0
    s_sub_u32 s69, s69, s90
    s_add_u32 s69, s69, s68
    s_lshl_b32 s69, s69, 15
    s_add_u32 s90, s69, s70
    s_add_u32 s69, s67, 3
    s_cmp_ge_u32 s69, 5
    s_cselect_b32 s91, 5, 0
    s_sub_u32 s69, s69, s91
    s_add_u32 s69, s69, s68
    s_lshl_b32 s69, s69, 15
    s_add_u32 s91, s69, s70
    s_add_u32 s69, s67, 4
    s_cmp_ge_u32 s69, 5
    s_cselect_b32 s92, 5, 0
    s_sub_u32 s69, s69, s92
    s_add_u32 s69, s69, s68
    s_lshl_b32 s69, s69, 15
    s_add_u32 s92, s69, s70
    s_and_b32 s67, s99, 1
    s_lshl_b32 s68, s60, 1
    s_xor_b32 s69, s67, 0
    s_add_u32 s69, s69, s68
    s_lshl_b32 s69, s69, 15
    s_add_u32 s93, s69, s70
    s_mov_b32 s95, s93
    s_xor_b32 s69, s67, 1
    s_add_u32 s69, s69, s68
    s_lshl_b32 s69, s69, 15
    s_add_u32 s94, s69, s70
    s_mov_b32 s96, s94
    v_lshrrev_b32 v4, 4, v0
    v_bfe_u32 v5, v0, 2, 2
    v_and_b32 v6, 3, v0
    v_lshl_add_u32 v7, v4, 3, v5
    v_lshlrev_b32 v7, 7, v7
    v_lshl_add_u32 v7, v6, 3, v7
    v_lshrrev_b32 v8, 1, v5
    v_and_b32 v9, 1, v4
    v_lshl_add_u32 v8, v9, 1, v8
    s_add_u32 s67, s97, 1
    s_cmp_eq_u32 s97, 0
    s_cselect_b32 s67, 0, s67
    s_lshl_b32 s67, s67, 13
    v_xor_b32 v9, s66, v8
    v_lshl_add_u32 v224, v9, 5, v7
    v_add_u32 v228, s67, v224
    s_cmp_eq_u32 s97, 3
    s_cselect_b32 s67, 1, 6
    s_lshl_b32 s67, s67, 13
    v_add_u32 v229, s67, v228
    v_add_u32 v225, 40960, v224
    v_and_b32 v5, 15, v0
    v_lshrrev_b32 v6, 1, v5
    v_xor_b32 v6, v6, v4
    v_lshlrev_b32 v7, 7, v5
    v_add_u32 v7, 114688, v7
    v_lshl_add_u32 v226, v6, 4, v7
    v_xor_b32 v6, 4, v6
    v_lshl_add_u32 v227, v6, 4, v7
    v_mov_b32 v0, 0
    v_mov_b32 v1, 0
    v_mov_b32 v2, 0
    v_mov_b32 v3, 0
    v_mov_b32 v4, 0
    v_mov_b32 v5, 0
    v_mov_b32 v6, 0
    v_mov_b32 v7, 0
    s_lshl_b32 s67, s84, 12
    s_add_u32 s67, s67, 81920
    s_lshl_b32 s68, s66, 10
    s_add_u32 s67, s67, s68
    v_lshl_add_u32 v232, v233, 4, s67
    v_mov_b32 v234, 0
    v_mov_b32 v235, 0
    v_mov_b32 v236, 0
    v_mov_b32 v237, 0
    v_mov_b32 v238, 0
    v_mov_b32 v239, 0
    v_mov_b32 v240, 0
    v_mov_b32 v241, 0
    v_mov_b32 v242, 0
    v_mov_b32 v243, 0
    v_mov_b32 v244, 0
    v_mov_b32 v245, 0
    v_mov_b32 v250, 0x3f803f80
    v_mov_b32 v251, 0x3f803f80
    v_mov_b32 v252, 0x3f803f80
    v_mov_b32 v253, 0x3f803f80
    s_add_u32 m0, s80, 16384
    s_add_u32 s85, s72, 1024
    buffer_load_dwordx4 v213, s[28:31], s85 offen lds
    s_add_u32 m0, s80, 17408
    s_add_u32 s85, s72, 1024
    buffer_load_dwordx4 v214, s[28:31], s85 offen lds
    s_add_u32 m0, s80, 24576
    s_add_u32 s85, s72, 2048
    buffer_load_dwordx4 v213, s[28:31], s85 offen lds
    s_add_u32 m0, s80, 25600
    s_add_u32 s85, s72, 2048
    buffer_load_dwordx4 v214, s[28:31], s85 offen lds
    s_add_u32 m0, s80, 32768
    s_nop 0
    buffer_load_dwordx4 v215, s[36:39], s73 offen lds
    s_add_u32 m0, s80, 33792
    s_nop 0
    buffer_load_dwordx4 v216, s[36:39], s73 offen lds
    s_lshl_b32 s69, s61, 12
    s_lshr_b32 s70, s63, 1
    s_lshl_b32 s70, s70, 10
    s_add_u32 s69, s69, s70
    s_lshl_b32 s70, s84, 8
    s_add_u32 s69, s69, s70
    s_add_u32 s69, s69, 16842752
    s_lshl_b32 s68, s66, 6
    s_add_u32 s69, s69, s68
    v_and_b32 v62, 0x38, v233
    v_add_u32 v62, s69, v62
    s_add_u32 s69, s97, 1
    s_cmp_eq_u32 s97, 0
    s_cselect_b32 s69, 0, s69
    s_lshl_b32 s69, s69, 8
    s_lshr_b32 s70, s63, 1
    s_mul_i32 s70, s70, 1280
    s_add_u32 s69, s69, s70
    s_lshl_b32 s70, s62, 13
    s_add_u32 s69, s69, s70
    s_add_u32 s69, s69, 16908288
    s_add_u32 s69, s69, s68
    v_and_b32 v63, 0x30, v233
    v_add_u32 v63, s69, v63
    s_lshl_b32 s67, s61, 4
    s_add_u32 s67, s67, s62
    s_lshl_b32 s67, s67, 2
    s_add_u32 s67, s67, s66
    s_mul_i32 s68, s67, 1792
    s_lshl_b32 s67, s67, 9
    v_lshl_add_u32 v57, v233, 7, s68
    v_lshl_add_u32 v56, v233, 7, s67
    v_and_b32 v60, 1, v233
    v_lshlrev_b32 v60, 7, v60
    s_lshl_b32 s67, s61, 12
    s_lshl_b32 s68, s66, 8
    s_add_u32 s67, s67, s68
    s_add_u32 s67, s67, 16842752
    s_sub_u32 s68, s61, 1
    s_max_i32 s68, s68, 0
    s_lshl_b32 s68, s68, 12
    s_add_u32 s68, s68, 16843584
    v_lshl_add_u32 v58, v233, 3, s67
    v_and_b32 v10, 7, v233
    v_bfe_u32 v11, v233, 3, 1
    v_lshl_add_u32 v10, v11, 4, v10
    v_lshl_add_u32 v10, v10, 3, s68
    s_lshl_b32 s67, s66, 7
    s_add_u32 s67, s67, 152832
    v_lshl_add_u32 v230, v233, 2, s67
    v_and_b32 v11, 15, v233
    v_lshlrev_b32 v11, 2, v11
    v_add_u32 v11, 153344, v11
    v_cmp_gt_u32 vcc, 32, v233
    s_nop 1
    v_cndmask_b32 v58, v10, v58, vcc
    v_cndmask_b32 v230, v11, v230, vcc
    s_mul_i32 s67, s66, 320
    s_lshl_b32 s68, s62, 13
    s_add_u32 s68, s68, s67
    s_add_u32 s68, s68, 16908288
    s_add_u32 s67, s67, 151552
    v_min_u32 v10, 39, v233
    v_lshl_add_u32 v59, v10, 3, s68
    v_lshl_add_u32 v231, v10, 3, s67
    s_waitcnt vmcnt(6)
    s_barrier
    s_cmp_lg_u32 s97, 0
    s_cbranch_scc1 L_hA_cr1_0
    ds_read_b64_tr_b16 v[64:65], v228 offset:0
    ds_read_b64_tr_b16 v[66:67], v228 offset:512
    ds_read_b64_tr_b16 v[68:69], v228 offset:4096
    ds_read_b64_tr_b16 v[70:71], v228 offset:4608
    ds_read_b64_tr_b16 v[72:73], v228 offset:8192
    ds_read_b64_tr_b16 v[74:75], v228 offset:8704
    ds_read_b64_tr_b16 v[76:77], v228 offset:12288
    ds_read_b64_tr_b16 v[78:79], v228 offset:12800
L_hA_cr1_0:
    ds_read_b128 v[48:51], v232 offset:0
    s_add_u32 s67, s63, 1
    s_and_b32 s67, s67, 7
    s_lshl_b32 s71, s67, 7
    s_add_u32 s71, s71, s76
    s_mul_i32 s68, s67, 229376
    s_add_u32 s73, s68, s78
    s_mul_i32 s72, s67, 196608
    s_add_u32 s72, s72, s77
    s_sub_u32 s74, s71, s79
    s_add_u32 m0, s81, 98304
    s_nop 0
    buffer_load_dwordx4 v208, s[24:27], s71 offen lds
    s_add_u32 m0, s81, 99328
    s_nop 0
    buffer_load_dwordx4 v209, s[24:27], s71 offen lds
    s_add_u32 m0, s81, 100352
    s_nop 0
    buffer_load_dwordx4 v210, s[24:27], s71 offen lds
    s_add_u32 m0, s81, 101376
    s_nop 0
    buffer_load_dwordx4 v211, s[24:27], s71 offen lds
    s_add_u32 m0, s80, 49152
    s_nop 0
    buffer_load_dwordx4 v213, s[28:31], s72 offen lds
    s_add_u32 m0, s80, 50176
    s_nop 0
    buffer_load_dwordx4 v214, s[28:31], s72 offen lds
    s_mov_b32 exec_hi, 0
    s_add_u32 m0, s82, 116736
    s_nop 0
    buffer_load_dwordx4 v212, s[24:27], s74 offen lds
    s_mov_b64 exec, -1
    s_add_u32 m0, s80, 57344
    s_nop 0
    buffer_load_dwordx4 v215, s[32:35], s73 offen lds
    s_add_u32 m0, s80, 58368
    s_nop 0
    buffer_load_dwordx4 v216, s[32:35], s73 offen lds
    ds_read_b128 v[24:27], v226 offset:0
    ds_read_b128 v[28:31], v227 offset:0
    s_waitcnt vmcnt(9) lgkmcnt(0)
    s_barrier
    s_cmp_eq_u32 s97, 0
    s_cbranch_scc1 L_hA_cr2_0
    ds_read_b64_tr_b16 v[64:65], v228 offset:0
    ds_read_b64_tr_b16 v[66:67], v228 offset:512
    ds_read_b64_tr_b16 v[68:69], v228 offset:4096
    ds_read_b64_tr_b16 v[70:71], v228 offset:4608
L_hA_cr2_0:
    s_add_u32 m0, s80, 65536
    s_add_u32 s85, s72, 1024
    buffer_load_dwordx4 v213, s[28:31], s85 offen lds
    s_add_u32 m0, s80, 66560
    s_add_u32 s85, s72, 1024
    buffer_load_dwordx4 v214, s[28:31], s85 offen lds
    s_add_u32 m0, s80, 73728
    s_add_u32 s85, s72, 2048
    buffer_load_dwordx4 v213, s[28:31], s85 offen lds
    s_add_u32 m0, s80, 74752
    s_add_u32 s85, s72, 2048
    buffer_load_dwordx4 v214, s[28:31], s85 offen lds
    s_add_u32 m0, s80, 40960
    s_nop 0
    buffer_load_dwordx4 v215, s[36:39], s73 offen lds
    s_add_u32 m0, s80, 41984
    s_nop 0
    buffer_load_dwordx4 v216, s[36:39], s73 offen lds
    s_add_u32 s67, s63, 2
    s_and_b32 s67, s67, 7
    s_lshl_b32 s71, s67, 7
    s_add_u32 s71, s71, s76
    s_mul_i32 s68, s67, 229376
    s_add_u32 s73, s68, s78
    s_mul_i32 s72, s67, 196608
    s_add_u32 s72, s72, s77
    s_sub_u32 s74, s71, s79
    s_add_u32 m0, s81, 81920
    s_nop 0
    buffer_load_dwordx4 v208, s[24:27], s71 offen lds
    s_add_u32 m0, s81, 82944
    s_nop 0
    buffer_load_dwordx4 v209, s[24:27], s71 offen lds
    s_add_u32 m0, s81, 83968
    s_nop 0
    buffer_load_dwordx4 v210, s[24:27], s71 offen lds
    s_add_u32 m0, s81, 84992
    s_nop 0
    buffer_load_dwordx4 v211, s[24:27], s71 offen lds
    s_add_u32 m0, s80, 0
    s_nop 0
    buffer_load_dwordx4 v213, s[28:31], s72 offen lds
    s_add_u32 m0, s80, 1024
    s_nop 0
    buffer_load_dwordx4 v214, s[28:31], s72 offen lds
    ds_read_b64_tr_b16 v[8:9], v224 offset:16384
    ds_read_b64_tr_b16 v[10:11], v224 offset:16896
    ds_read_b64_tr_b16 v[12:13], v224 offset:20480
    ds_read_b64_tr_b16 v[14:15], v224 offset:20992
    ds_read_b64_tr_b16 v[16:17], v224 offset:24576
    ds_read_b64_tr_b16 v[18:19], v224 offset:25088
    ds_read_b64_tr_b16 v[20:21], v224 offset:28672
    ds_read_b64_tr_b16 v[22:23], v224 offset:29184
    s_waitcnt vmcnt(12) lgkmcnt(0)
    s_barrier
    s_cmp_lg_u32 s97, 0
    s_cbranch_scc1 L_hA_cr1_1
    ds_read_b64_tr_b16 v[80:81], v229 offset:0
    ds_read_b64_tr_b16 v[82:83], v229 offset:512
    ds_read_b64_tr_b16 v[84:85], v229 offset:4096
    ds_read_b64_tr_b16 v[86:87], v229 offset:4608
    ds_read_b64_tr_b16 v[88:89], v229 offset:8192
    ds_read_b64_tr_b16 v[90:91], v229 offset:8704
    ds_read_b64_tr_b16 v[92:93], v229 offset:12288
    ds_read_b64_tr_b16 v[94:95], v229 offset:12800
L_hA_cr1_1:
    ds_read_b128 v[44:47], v232 offset:16384
    v_mfma_f32_16x16x32_bf16 v[0:3], v[8:11], v[24:27], v[0:3]
    v_mfma_f32_16x16x32_bf16 v[0:3], v[12:15], v[28:31], v[0:3]
    v_mfma_f32_16x16x32_bf16 v[4:7], v[24:27], v[16:19], v[4:7]
    v_mfma_f32_16x16x32_bf16 v[4:7], v[28:31], v[20:23], v[4:7]
    s_mov_b32 exec_hi, 0
    s_add_u32 m0, s82, 114688
    s_nop 0
    buffer_load_dwordx4 v212, s[24:27], s74 offen lds
    s_mov_b64 exec, -1
    s_add_u32 m0, s80, 8192
    s_nop 0
    buffer_load_dwordx4 v215, s[32:35], s73 offen lds
    s_add_u32 m0, s80, 9216
    s_nop 0
    buffer_load_dwordx4 v216, s[32:35], s73 offen lds
    s_add_u32 m0, s80, 16384
    s_add_u32 s85, s72, 1024
    buffer_load_dwordx4 v213, s[28:31], s85 offen lds
    s_add_u32 m0, s80, 17408
    s_add_u32 s85, s72, 1024
    buffer_load_dwordx4 v214, s[28:31], s85 offen lds
    s_add_u32 m0, s80, 24576
    s_add_u32 s85, s72, 2048
    buffer_load_dwordx4 v213, s[28:31], s85 offen lds
    s_add_u32 m0, s80, 25600
    s_add_u32 s85, s72, 2048
    buffer_load_dwordx4 v214, s[28:31], s85 offen lds
    s_add_u32 m0, s80, 32768
    s_nop 0
    buffer_load_dwordx4 v215, s[36:39], s73 offen lds
    ds_read_b128 v[24:27], v226 offset:2048
    ds_read_b128 v[28:31], v227 offset:2048
    s_waitcnt vmcnt(14) lgkmcnt(0)
    s_barrier
    s_cmp_eq_u32 s97, 0
    s_cbranch_scc1 L_hA_cr2_1
    ds_read_b64_tr_b16 v[80:81], v229 offset:0
    ds_read_b64_tr_b16 v[82:83], v229 offset:512
    ds_read_b64_tr_b16 v[84:85], v229 offset:4096
    ds_read_b64_tr_b16 v[86:87], v229 offset:4608
L_hA_cr2_1:
    s_add_u32 m0, s80, 33792
    s_nop 0
    buffer_load_dwordx4 v216, s[36:39], s73 offen lds
    s_add_u32 s67, s63, 3
    s_and_b32 s67, s67, 7
    s_lshl_b32 s71, s67, 7
    s_add_u32 s71, s71, s76
    s_mul_i32 s68, s67, 229376
    s_add_u32 s73, s68, s78
    s_mul_i32 s72, s67, 196608
    s_add_u32 s72, s72, s77
    s_sub_u32 s74, s71, s79
    s_add_u32 m0, s81, 98304
    s_nop 0
    buffer_load_dwordx4 v208, s[24:27], s71 offen lds
    s_add_u32 m0, s81, 99328
    s_nop 0
    buffer_load_dwordx4 v209, s[24:27], s71 offen lds
    s_add_u32 m0, s81, 100352
    s_nop 0
    buffer_load_dwordx4 v210, s[24:27], s71 offen lds
    s_add_u32 m0, s81, 101376
    s_nop 0
    buffer_load_dwordx4 v211, s[24:27], s71 offen lds
    s_add_u32 m0, s80, 49152
    s_nop 0
    buffer_load_dwordx4 v213, s[28:31], s72 offen lds
    s_add_u32 m0, s80, 50176
    s_nop 0
    buffer_load_dwordx4 v214, s[28:31], s72 offen lds
    s_mov_b32 exec_hi, 0
    s_add_u32 m0, s82, 116736
    s_nop 0
    buffer_load_dwordx4 v212, s[24:27], s74 offen lds
    s_mov_b64 exec, -1
    s_add_u32 m0, s80, 57344
    s_nop 0
    buffer_load_dwordx4 v215, s[32:35], s73 offen lds
    s_add_u32 m0, s80, 58368
    s_nop 0
    buffer_load_dwordx4 v216, s[32:35], s73 offen lds
    ds_read_b64_tr_b16 v[8:9], v225 offset:24576
    ds_read_b64_tr_b16 v[10:11], v225 offset:25088
    ds_read_b64_tr_b16 v[12:13], v225 offset:28672
    ds_read_b64_tr_b16 v[14:15], v225 offset:29184
    ds_read_b64_tr_b16 v[16:17], v225 offset:32768
    ds_read_b64_tr_b16 v[18:19], v225 offset:33280
    ds_read_b64_tr_b16 v[20:21], v225 offset:36864
    ds_read_b64_tr_b16 v[22:23], v225 offset:37376
    s_add_u32 m0, s81, 118784
    s_add_u32 s85, s88, 0
    buffer_load_dwordx4 v219, s[40:43], s85 offen lds
    s_add_u32 m0, s81, 119808
    s_add_u32 s85, s88, 8192
    buffer_load_dwordx4 v219, s[40:43], s85 offen lds
    s_waitcnt vmcnt(17) lgkmcnt(0)
    s_barrier
    v_mfma_f32_16x16x32_bf16 v[0:3], v[8:11], v[24:27], v[0:3]
    v_mfma_f32_16x16x32_bf16 v[0:3], v[12:15], v[28:31], v[0:3]
    v_mfma_f32_16x16x32_bf16 v[4:7], v[24:27], v[16:19], v[4:7]
    v_mfma_f32_16x16x32_bf16 v[4:7], v[28:31], v[20:23], v[4:7]
    s_add_u32 m0, s80, 65536
    s_add_u32 s85, s72, 1024
    buffer_load_dwordx4 v213, s[28:31], s85 offen lds
    v_mfma_f32_16x16x32_bf16 v[234:237], v[64:67], v[250:253], v[234:237]
    v_mfma_f32_16x16x32_bf16 v[234:237], v[68:71], v[250:253], v[234:237]
    v_mfma_f32_16x16x32_bf16 v[234:237], v[80:83], v[250:253], v[234:237]
    v_mfma_f32_16x16x32_bf16 v[234:237], v[84:87], v[250:253], v[234:237]
    s_add_u32 m0, s80, 66560
    s_add_u32 s85, s72, 1024
    buffer_load_dwordx4 v214, s[28:31], s85 offen lds
    s_cmp_lg_u32 s97, 0
    s_cbranch_scc1 L_hA_cm
    v_mfma_f32_16x16x32_bf16 v[238:241], v[72:75], v[250:253], v[238:241]
    v_mfma_f32_16x16x32_bf16 v[238:241], v[76:79], v[250:253], v[238:241]
    v_mfma_f32_16x16x32_bf16 v[238:241], v[88:91], v[250:253], v[238:241]
    v_mfma_f32_16x16x32_bf16 v[238:241], v[92:95], v[250:253], v[238:241]
L_hA_cm:
    s_add_u32 m0, s80, 73728
    s_add_u32 s85, s72, 2048
    buffer_load_dwordx4 v213, s[28:31], s85 offen lds
    s_add_u32 m0, s80, 74752
    s_add_u32 s85, s72, 2048
    buffer_load_dwordx4 v214, s[28:31], s85 offen lds
    s_add_u32 m0, s80, 40960
    s_nop 0
    buffer_load_dwordx4 v215, s[36:39], s73 offen lds
    s_add_u32 m0, s80, 41984
    s_nop 0
    buffer_load_dwordx4 v216, s[36:39], s73 offen lds
    ds_read_b128 v[24:27], v226 offset:0
    ds_read_b128 v[28:31], v227 offset:0
    s_waitcnt vmcnt(17) lgkmcnt(0)
    s_barrier
    s_add_u32 s67, s63, 4
    s_and_b32 s67, s67, 7
    s_lshl_b32 s71, s67, 7
    s_add_u32 s71, s71, s76
    s_mul_i32 s68, s67, 229376
    s_add_u32 s73, s68, s78
    s_mul_i32 s72, s67, 196608
    s_add_u32 s72, s72, s77
    s_sub_u32 s74, s71, s79
    s_add_u32 m0, s81, 81920
    s_nop 0
    buffer_load_dwordx4 v208, s[24:27], s71 offen lds
    s_mov_b32 exec_lo, 0x00010001
    s_mov_b32 exec_hi, 0x00010001
    buffer_store_dwordx4 v[234:237], v63, s[48:51], 0 offen sc1
    s_cmp_lg_u32 s97, 0
    s_cbranch_scc1 L_hA_cp
    buffer_store_dwordx4 v[238:241], v63, s[48:51], 0 offen offset:256 sc1
L_hA_cp:
    s_mov_b64 exec, -1
    s_add_u32 m0, s81, 82944
    s_nop 0
    buffer_load_dwordx4 v209, s[24:27], s71 offen lds
    v_lshlrev_b32 v52, 16, v48
    v_and_b32 v53, 0xffff0000, v48
    v_add_f32 v242, v242, v52
    v_add_f32 v243, v243, v53
    v_fmac_f32 v244, v52, v52
    v_fmac_f32 v245, v53, v53
    s_add_u32 m0, s81, 83968
    s_nop 0
    buffer_load_dwordx4 v210, s[24:27], s71 offen lds
    v_lshlrev_b32 v52, 16, v49
    v_and_b32 v53, 0xffff0000, v49
    v_add_f32 v242, v242, v52
    v_add_f32 v243, v243, v53
    v_fmac_f32 v244, v52, v52
    v_fmac_f32 v245, v53, v53
    s_add_u32 m0, s81, 84992
    s_nop 0
    buffer_load_dwordx4 v211, s[24:27], s71 offen lds
    v_lshlrev_b32 v52, 16, v50
    v_and_b32 v53, 0xffff0000, v50
    v_add_f32 v242, v242, v52
    v_add_f32 v243, v243, v53
    v_fmac_f32 v244, v52, v52
    v_fmac_f32 v245, v53, v53
    s_add_u32 m0, s80, 0
    s_nop 0
    buffer_load_dwordx4 v213, s[28:31], s72 offen lds
    v_lshlrev_b32 v52, 16, v51
    v_and_b32 v53, 0xffff0000, v51
    v_add_f32 v242, v242, v52
    v_add_f32 v243, v243, v53
    v_fmac_f32 v244, v52, v52
    v_fmac_f32 v245, v53, v53
    s_add_u32 m0, s80, 1024
    s_nop 0
    buffer_load_dwordx4 v214, s[28:31], s72 offen lds
    s_mov_b32 exec_hi, 0
    s_add_u32 m0, s82, 114688
    s_nop 0
    buffer_load_dwordx4 v212, s[24:27], s74 offen lds
    s_mov_b64 exec, -1
    s_add_u32 m0, s80, 8192
    s_nop 0
    buffer_load_dwordx4 v215, s[32:35], s73 offen lds
    s_add_u32 m0, s80, 9216
    s_nop 0
    buffer_load_dwordx4 v216, s[32:35], s73 offen lds
    ds_read_b64_tr_b16 v[8:9], v224 offset:16384
    ds_read_b64_tr_b16 v[10:11], v224 offset:16896
    ds_read_b64_tr_b16 v[12:13], v224 offset:20480
    ds_read_b64_tr_b16 v[14:15], v224 offset:20992
    ds_read_b64_tr_b16 v[16:17], v224 offset:24576
    ds_read_b64_tr_b16 v[18:19], v224 offset:25088
    ds_read_b64_tr_b16 v[20:21], v224 offset:28672
    ds_read_b64_tr_b16 v[22:23], v224 offset:29184
    s_add_u32 m0, s81, 120832
    s_add_u32 s85, s88, 16384
    buffer_load_dwordx4 v219, s[40:43], s85 offen lds
    s_add_u32 m0, s81, 121856
    s_add_u32 s85, s88, 24576
    buffer_load_dwordx4 v219, s[40:43], s85 offen lds
    s_waitcnt vmcnt(19) lgkmcnt(0)
    s_barrier
    v_mfma_f32_16x16x32_bf16 v[0:3], v[8:11], v[24:27], v[0:3]
    v_mfma_f32_16x16x32_bf16 v[0:3], v[12:15], v[28:31], v[0:3]
    v_mfma_f32_16x16x32_bf16 v[4:7], v[24:27], v[16:19], v[4:7]
    v_mfma_f32_16x16x32_bf16 v[4:7], v[28:31], v[20:23], v[4:7]
    s_add_u32 m0, s80, 16384
    s_add_u32 s85, s72, 1024
    buffer_load_dwordx4 v213, s[28:31], s85 offen lds
    v_lshlrev_b32 v52, 16, v44
    v_and_b32 v53, 0xffff0000, v44
    v_add_f32 v242, v242, v52
    v_add_f32 v243, v243, v53
    v_fmac_f32 v244, v52, v52
    v_fmac_f32 v245, v53, v53
    s_add_u32 m0, s80, 17408
    s_add_u32 s85, s72, 1024
    buffer_load_dwordx4 v214, s[28:31], s85 offen lds
    v_lshlrev_b32 v52, 16, v45
    v_and_b32 v53, 0xffff0000, v45
    v_add_f32 v242, v242, v52
    v_add_f32 v243, v243, v53
    v_fmac_f32 v244, v52, v52
    v_fmac_f32 v245, v53, v53
    s_add_u32 m0, s80, 24576
    s_add_u32 s85, s72, 2048
    buffer_load_dwordx4 v213, s[28:31], s85 offen lds
    v_lshlrev_b32 v52, 16, v46
    v_and_b32 v53, 0xffff0000, v46
    v_add_f32 v242, v242, v52
    v_add_f32 v243, v243, v53
    v_fmac_f32 v244, v52, v52
    v_fmac_f32 v245, v53, v53
    s_add_u32 m0, s80, 25600
    s_add_u32 s85, s72, 2048
    buffer_load_dwordx4 v214, s[28:31], s85 offen lds
    v_lshlrev_b32 v52, 16, v47
    v_and_b32 v53, 0xffff0000, v47
    v_add_f32 v242, v242, v52
    v_add_f32 v243, v243, v53
    v_fmac_f32 v244, v52, v52
    v_fmac_f32 v245, v53, v53
    s_add_u32 m0, s80, 32768
    s_nop 0
    buffer_load_dwordx4 v215, s[36:39], s73 offen lds
    s_add_u32 m0, s80, 33792
    s_nop 0
    buffer_load_dwordx4 v216, s[36:39], s73 offen lds
    ds_read_b128 v[24:27], v226 offset:2048
    ds_read_b128 v[28:31], v227 offset:2048
    s_waitcnt vmcnt(17) lgkmcnt(0)
    s_barrier
    s_add_u32 s67, s63, 5
    s_and_b32 s67, s67, 7
    s_lshl_b32 s71, s67, 7
    s_add_u32 s71, s71, s76
    s_mul_i32 s68, s67, 229376
    s_add_u32 s73, s68, s78
    s_mul_i32 s72, s67, 196608
    s_add_u32 s72, s72, s77
    s_sub_u32 s74, s71, s79
    s_add_u32 m0, s81, 98304
    s_nop 0
    buffer_load_dwordx4 v208, s[24:27], s71 offen lds
    v_add_f32 v242, v242, v243
    v_add_f32 v243, v244, v245
    s_nop 1
    s_add_u32 m0, s81, 99328
    s_nop 0
    buffer_load_dwordx4 v209, s[24:27], s71 offen lds
    v_add_f32_dpp v242, v242, v242 quad_perm:[1,0,3,2] row_mask:0xf bank_mask:0xf
    v_add_f32_dpp v243, v243, v243 quad_perm:[1,0,3,2] row_mask:0xf bank_mask:0xf
    s_nop 0
    s_add_u32 m0, s81, 100352
    s_nop 0
    buffer_load_dwordx4 v210, s[24:27], s71 offen lds
    v_add_f32_dpp v242, v242, v242 quad_perm:[2,3,0,1] row_mask:0xf bank_mask:0xf
    v_add_f32_dpp v243, v243, v243 quad_perm:[2,3,0,1] row_mask:0xf bank_mask:0xf
    s_nop 0
    s_add_u32 m0, s81, 101376
    s_nop 0
    buffer_load_dwordx4 v211, s[24:27], s71 offen lds
    v_add_f32_dpp v242, v242, v242 row_half_mirror row_mask:0xf bank_mask:0xf
    v_add_f32_dpp v243, v243, v243 row_half_mirror row_mask:0xf bank_mask:0xf
    s_nop 0
    s_add_u32 m0, s80, 49152
    s_nop 0
    buffer_load_dwordx4 v213, s[28:31], s72 offen lds
    s_mov_b32 exec_lo, 0x01010101
    s_mov_b32 exec_hi, 0x01010101
    buffer_store_dwordx2 v[242:243], v62, s[48:51], 0 offen sc1
    s_mov_b64 exec, -1
    s_add_u32 m0, s80, 50176
    s_nop 0
    buffer_load_dwordx4 v214, s[28:31], s72 offen lds
    s_mov_b32 exec_hi, 0
    s_add_u32 m0, s82, 116736
    s_nop 0
    buffer_load_dwordx4 v212, s[24:27], s74 offen lds
    s_mov_b64 exec, -1
    s_add_u32 m0, s80, 57344
    s_nop 0
    buffer_load_dwordx4 v215, s[32:35], s73 offen lds
    s_add_u32 m0, s80, 58368
    s_nop 0
    buffer_load_dwordx4 v216, s[32:35], s73 offen lds
    ds_read_b64_tr_b16 v[8:9], v225 offset:24576
    ds_read_b64_tr_b16 v[10:11], v225 offset:25088
    ds_read_b64_tr_b16 v[12:13], v225 offset:28672
    ds_read_b64_tr_b16 v[14:15], v225 offset:29184
    ds_read_b64_tr_b16 v[16:17], v225 offset:32768
    ds_read_b64_tr_b16 v[18:19], v225 offset:33280
    ds_read_b64_tr_b16 v[20:21], v225 offset:36864
    ds_read_b64_tr_b16 v[22:23], v225 offset:37376
    s_add_u32 m0, s81, 135168
    s_add_u32 s85, s89, 0
    buffer_load_dwordx4 v219, s[40:43], s85 offen lds
    s_add_u32 m0, s81, 136192
    s_add_u32 s85, s89, 8192
    buffer_load_dwordx4 v219, s[40:43], s85 offen lds
    s_waitcnt vmcnt(19) lgkmcnt(0)
    s_barrier
    v_mfma_f32_16x16x32_bf16 v[0:3], v[8:11], v[24:27], v[0:3]
    v_mfma_f32_16x16x32_bf16 v[0:3], v[12:15], v[28:31], v[0:3]
    v_mfma_f32_16x16x32_bf16 v[4:7], v[24:27], v[16:19], v[4:7]
    v_mfma_f32_16x16x32_bf16 v[4:7], v[28:31], v[20:23], v[4:7]
    s_add_u32 m0, s80, 65536
    s_add_u32 s85, s72, 1024
    buffer_load_dwordx4 v213, s[28:31], s85 offen lds
    s_add_u32 m0, s80, 66560
    s_add_u32 s85, s72, 1024
    buffer_load_dwordx4 v214, s[28:31], s85 offen lds
    s_add_u32 m0, s80, 73728
    s_add_u32 s85, s72, 2048
    buffer_load_dwordx4 v213, s[28:31], s85 offen lds
    s_add_u32 m0, s80, 74752
    s_add_u32 s85, s72, 2048
    buffer_load_dwordx4 v214, s[28:31], s85 offen lds
    s_add_u32 m0, s80, 40960
    s_nop 0
    buffer_load_dwordx4 v215, s[36:39], s73 offen lds
    s_add_u32 m0, s80, 41984
    s_nop 0
    buffer_load_dwordx4 v216, s[36:39], s73 offen lds
    ds_read_b128 v[24:27], v226 offset:0
    ds_read_b128 v[28:31], v227 offset:0
    s_waitcnt vmcnt(17) lgkmcnt(0)
    s_barrier
    s_add_u32 s67, s63, 6
    s_and_b32 s67, s67, 7
    s_lshl_b32 s71, s67, 7
    s_add_u32 s71, s71, s76
    s_mul_i32 s68, s67, 229376
    s_add_u32 s73, s68, s78
    s_mul_i32 s72, s67, 196608
    s_add_u32 s72, s72, s77
    s_sub_u32 s74, s71, s79
    s_add_u32 m0, s81, 81920
    s_nop 0
    buffer_load_dwordx4 v208, s[24:27], s71 offen lds
    buffer_load_dword v61, v60, s[56:59], 0 offen sc1
    s_add_u32 m0, s81, 82944
    s_nop 0
    buffer_load_dwordx4 v209, s[24:27], s71 offen lds
    s_add_u32 m0, s81, 83968
    s_nop 0
    buffer_load_dwordx4 v210, s[24:27], s71 offen lds
    s_add_u32 m0, s81, 84992
    s_nop 0
    buffer_load_dwordx4 v211, s[24:27], s71 offen lds
    s_add_u32 m0, s80, 0
    s_nop 0
    buffer_load_dwordx4 v213, s[28:31], s72 offen lds
    s_add_u32 m0, s80, 1024
    s_nop 0
    buffer_load_dwordx4 v214, s[28:31], s72 offen lds
    s_mov_b32 exec_hi, 0
    s_add_u32 m0, s82, 114688
    s_nop 0
    buffer_load_dwordx4 v212, s[24:27], s74 offen lds
    s_mov_b64 exec, -1
    s_add_u32 m0, s80, 8192
    s_nop 0
    buffer_load_dwordx4 v215, s[32:35], s73 offen lds
    s_add_u32 m0, s80, 9216
    s_nop 0
    buffer_load_dwordx4 v216, s[32:35], s73 offen lds
    ds_read_b64_tr_b16 v[8:9], v224 offset:16384
    ds_read_b64_tr_b16 v[10:11], v224 offset:16896
    ds_read_b64_tr_b16 v[12:13], v224 offset:20480
    ds_read_b64_tr_b16 v[14:15], v224 offset:20992
    ds_read_b64_tr_b16 v[16:17], v224 offset:24576
    ds_read_b64_tr_b16 v[18:19], v224 offset:25088
    ds_read_b64_tr_b16 v[20:21], v224 offset:28672
    ds_read_b64_tr_b16 v[22:23], v224 offset:29184
    s_add_u32 m0, s81, 137216
    s_add_u32 s85, s89, 16384
    buffer_load_dwordx4 v219, s[40:43], s85 offen lds
    s_add_u32 m0, s81, 138240
    s_add_u32 s85, s89, 24576
    buffer_load_dwordx4 v219, s[40:43], s85 offen lds
    s_waitcnt vmcnt(20) lgkmcnt(0)
    s_barrier
    v_mfma_f32_16x16x32_bf16 v[0:3], v[8:11], v[24:27], v[0:3]
    v_mfma_f32_16x16x32_bf16 v[0:3], v[12:15], v[28:31], v[0:3]
    v_mfma_f32_16x16x32_bf16 v[4:7], v[24:27], v[16:19], v[4:7]
    v_mfma_f32_16x16x32_bf16 v[4:7], v[28:31], v[20:23], v[4:7]
    s_add_u32 m0, s80, 16384
    s_add_u32 s85, s72, 1024
    buffer_load_dwordx4 v213, s[28:31], s85 offen lds
    s_add_u32 m0, s80, 17408
    s_add_u32 s85, s72, 1024
    buffer_load_dwordx4 v214, s[28:31], s85 offen lds
    s_add_u32 m0, s80, 24576
    s_add_u32 s85, s72, 2048
    buffer_load_dwordx4 v213, s[28:31], s85 offen lds
    s_add_u32 m0, s80, 25600
    s_add_u32 s85, s72, 2048
    buffer_load_dwordx4 v214, s[28:31], s85 offen lds
    s_add_u32 m0, s80, 32768
    s_nop 0
    buffer_load_dwordx4 v215, s[36:39], s73 offen lds
    s_add_u32 m0, s80, 33792
    s_nop 0
    buffer_load_dwordx4 v216, s[36:39], s73 offen lds
    ds_read_b128 v[24:27], v226 offset:2048
    ds_read_b128 v[28:31], v227 offset:2048
    s_waitcnt vmcnt(18) lgkmcnt(0)
    s_barrier
    s_add_u32 s67, s63, 7
    s_and_b32 s67, s67, 7
    s_lshl_b32 s71, s67, 7
    s_add_u32 s71, s71, s76
    s_mul_i32 s68, s67, 229376
    s_add_u32 s73, s68, s78
    s_mul_i32 s72, s67, 196608
    s_add_u32 s72, s72, s77
    s_sub_u32 s74, s71, s79
    s_add_u32 m0, s81, 98304
    s_nop 0
    buffer_load_dwordx4 v208, s[24:27], s71 offen lds
    s_waitcnt vmcnt(17)
    v_cmp_gt_u32 vcc, 128, v61
    s_mov_b32 s98, 0
    s_nop 2
    s_cmp_eq_u64 vcc, 0
    s_cbranch_scc1 L_hA_cnt_done
L_hA_cnt:
    s_sleep 4
    buffer_load_dword v61, v60, s[56:59], 0 offen sc1
    s_waitcnt vmcnt(0)
    v_cmp_gt_u32 vcc, 128, v61
    s_nop 3
    s_cmp_eq_u64 vcc, 0
    s_cbranch_scc1 L_hA_cnt_done
    s_add_u32 s98, s98, 1
    s_cmp_lt_u32 s98, 0x40000
    s_cbranch_scc1 L_hA_cnt
L_hA_cnt_done:
    s_add_u32 m0, s81, 99328
    s_nop 0
    buffer_load_dwordx4 v209, s[24:27], s71 offen lds
    s_add_u32 m0, s81, 100352
    s_nop 0
    buffer_load_dwordx4 v210, s[24:27], s71 offen lds
    s_add_u32 m0, s81, 101376
    s_nop 0
    buffer_load_dwordx4 v211, s[24:27], s71 offen lds
    s_add_u32 m0, s80, 49152
    s_nop 0
    buffer_load_dwordx4 v213, s[28:31], s72 offen lds
    s_add_u32 m0, s80, 50176
    s_nop 0
    buffer_load_dwordx4 v214, s[28:31], s72 offen lds
    s_mov_b32 exec_hi, 0
    s_add_u32 m0, s82, 116736
    s_nop 0
    buffer_load_dwordx4 v212, s[24:27], s74 offen lds
    s_mov_b64 exec, -1
    s_add_u32 m0, s80, 57344
    s_nop 0
    buffer_load_dwordx4 v215, s[32:35], s73 offen lds
    s_add_u32 m0, s80, 58368
    s_nop 0
    buffer_load_dwordx4 v216, s[32:35], s73 offen lds
    ds_read_b64_tr_b16 v[8:9], v225 offset:24576
    ds_read_b64_tr_b16 v[10:11], v225 offset:25088
    ds_read_b64_tr_b16 v[12:13], v225 offset:28672
    ds_read_b64_tr_b16 v[14:15], v225 offset:29184
    ds_read_b64_tr_b16 v[16:17], v225 offset:32768
    ds_read_b64_tr_b16 v[18:19], v225 offset:33280
    ds_read_b64_tr_b16 v[20:21], v225 offset:36864
    ds_read_b64_tr_b16 v[22:23], v225 offset:37376
    s_waitcnt vmcnt(50)
    ds_read_b64_tr_b16 v[64:65], v220 offset:0
    ds_read_b64_tr_b16 v[66:67], v220 offset:2048
    ds_read_b64_tr_b16 v[68:69], v221 offset:0
    ds_read_b64_tr_b16 v[70:71], v221 offset:2048
    ds_read_b64_tr_b16 v[72:73], v222 offset:0
    ds_read_b64_tr_b16 v[74:75], v222 offset:2048
    ds_read_b64_tr_b16 v[76:77], v223 offset:0
    ds_read_b64_tr_b16 v[78:79], v223 offset:2048
    s_waitcnt lgkmcnt(0)
    s_add_u32 m0, s81, 118784
    s_add_u32 s85, s90, 0
    buffer_load_dwordx4 v219, s[40:43], s85 offen lds
    s_add_u32 m0, s81, 119808
    s_add_u32 s85, s90, 8192
    buffer_load_dwordx4 v219, s[40:43], s85 offen lds
    s_waitcnt vmcnt(19) lgkmcnt(0)
    s_barrier
    v_mfma_f32_16x16x32_bf16 v[0:3], v[8:11], v[24:27], v[0:3]
    v_mfma_f32_16x16x32_bf16 v[0:3], v[12:15], v[28:31], v[0:3]
    v_mfma_f32_16x16x32_bf16 v[4:7], v[24:27], v[16:19], v[4:7]
    v_mfma_f32_16x16x32_bf16 v[4:7], v[28:31], v[20:23], v[4:7]
    s_add_u32 m0, s80, 65536
    s_add_u32 s85, s72, 1024
    buffer_load_dwordx4 v213, s[28:31], s85 offen lds
    s_add_u32 m0, s80, 66560
    s_add_u32 s85, s72, 1024
    buffer_load_dwordx4 v214, s[28:31], s85 offen lds
    s_add_u32 m0, s80, 73728
    s_add_u32 s85, s72, 2048
    buffer_load_dwordx4 v213, s[28:31], s85 offen lds
    s_add_u32 m0, s80, 74752
    s_add_u32 s85, s72, 2048
    buffer_load_dwordx4 v214, s[28:31], s85 offen lds
    s_add_u32 m0, s80, 40960
    s_nop 0
    buffer_load_dwordx4 v215, s[36:39], s73 offen lds
    s_add_u32 m0, s80, 41984
    s_nop 0
    buffer_load_dwordx4 v216, s[36:39], s73 offen lds
    ds_read_b128 v[24:27], v226 offset:0
    ds_read_b128 v[28:31], v227 offset:0
    s_waitcnt vmcnt(17) lgkmcnt(0)
    s_barrier
    ds_read_b64_tr_b16 v[8:9], v224 offset:16384
    ds_read_b64_tr_b16 v[10:11], v224 offset:16896
    ds_read_b64_tr_b16 v[12:13], v224 offset:20480
    ds_read_b64_tr_b16 v[14:15], v224 offset:20992
    ds_read_b64_tr_b16 v[16:17], v224 offset:24576
    ds_read_b64_tr_b16 v[18:19], v224 offset:25088
    ds_read_b64_tr_b16 v[20:21], v224 offset:28672
    ds_read_b64_tr_b16 v[22:23], v224 offset:29184
    s_waitcnt vmcnt(23)
    ds_read_b64_tr_b16 v[80:81], v220 offset:16384
    ds_read_b64_tr_b16 v[82:83], v220 offset:18432
    ds_read_b64_tr_b16 v[84:85], v221 offset:16384
    ds_read_b64_tr_b16 v[86:87], v221 offset:18432
    ds_read_b64_tr_b16 v[88:89], v222 offset:16384
    ds_read_b64_tr_b16 v[90:91], v222 offset:18432
    ds_read_b64_tr_b16 v[92:93], v223 offset:16384
    ds_read_b64_tr_b16 v[94:95], v223 offset:18432
    s_waitcnt lgkmcnt(0)
    s_add_u32 m0, s81, 120832
    s_add_u32 s85, s90, 16384
    buffer_load_dwordx4 v219, s[40:43], s85 offen lds
    buffer_load_dwordx2 v[32:33], v58, s[48:51], 0 offen offset:0 sc1
    buffer_load_dwordx2 v[40:41], v59, s[48:51], 0 offen offset:0 sc1
    buffer_load_dwordx2 v[34:35], v58, s[48:51], 0 offen offset:1024 sc1
    buffer_load_dwordx2 v[42:43], v59, s[48:51], 0 offen offset:1280 sc1
    buffer_load_dwordx2 v[36:37], v58, s[48:51], 0 offen offset:2048 sc1
    buffer_load_dwordx2 v[44:45], v59, s[48:51], 0 offen offset:2560 sc1
    buffer_load_dwordx2 v[38:39], v58, s[48:51], 0 offen offset:3072 sc1
    buffer_load_dwordx2 v[46:47], v59, s[48:51], 0 offen offset:3840 sc1
    s_add_u32 m0, s81, 121856
    s_add_u32 s85, s90, 24576
    buffer_load_dwordx4 v219, s[40:43], s85 offen lds
    s_add_u32 m0, s81, 135168
    s_add_u32 s85, s91, 0
    buffer_load_dwordx4 v219, s[40:43], s85 offen lds
    s_add_u32 m0, s81, 136192
    s_add_u32 s85, s91, 8192
    buffer_load_dwordx4 v219, s[40:43], s85 offen lds
    s_add_u32 m0, s81, 137216
    s_add_u32 s85, s91, 16384
    buffer_load_dwordx4 v219, s[40:43], s85 offen lds
    s_add_u32 m0, s81, 138240
    s_add_u32 s85, s91, 24576
    buffer_load_dwordx4 v219, s[40:43], s85 offen lds
    s_add_u32 m0, s81, 0
    s_add_u32 s85, s88, 4294311936
    buffer_load_dwordx4 v219, s[40:43], s85 offen lds
    s_add_u32 m0, s81, 1024
    s_add_u32 s85, s88, 4294320128
    buffer_load_dwordx4 v219, s[40:43], s85 offen lds
    s_add_u32 m0, s81, 2048
    s_add_u32 s85, s88, 4294328320
    buffer_load_dwordx4 v219, s[40:43], s85 offen lds
    s_add_u32 m0, s81, 3072
    s_add_u32 s85, s88, 4294336512
    buffer_load_dwordx4 v219, s[40:43], s85 offen lds
    s_waitcnt vmcnt(26) lgkmcnt(0)
    s_barrier
    v_mfma_f32_16x16x32_bf16 v[0:3], v[8:11], v[24:27], v[0:3]
    v_mfma_f32_16x16x32_bf16 v[0:3], v[12:15], v[28:31], v[0:3]
    v_mfma_f32_16x16x32_bf16 v[4:7], v[24:27], v[16:19], v[4:7]
    v_mfma_f32_16x16x32_bf16 v[4:7], v[28:31], v[20:23], v[4:7]
    ds_read_b128 v[24:27], v226 offset:2048
    ds_read_b128 v[28:31], v227 offset:2048
    s_add_u32 m0, s81, 81920
    s_add_u32 s85, s89, 4294311936
    buffer_load_dwordx4 v219, s[40:43], s85 offen lds
    s_add_u32 m0, s81, 82944
    s_add_u32 s85, s89, 4294320128
    buffer_load_dwordx4 v219, s[40:43], s85 offen lds
    s_add_u32 m0, s81, 83968
    s_add_u32 s85, s89, 4294328320
    buffer_load_dwordx4 v219, s[40:43], s85 offen lds
    s_add_u32 m0, s81, 84992
    s_add_u32 s85, s89, 4294336512
    buffer_load_dwordx4 v219, s[40:43], s85 offen lds
    s_add_u32 m0, s81, 16384
    s_add_u32 s85, s90, 4294311936
    buffer_load_dwordx4 v219, s[40:43], s85 offen lds
    s_add_u32 m0, s81, 17408
    s_add_u32 s85, s90, 4294320128
    buffer_load_dwordx4 v219, s[40:43], s85 offen lds
    s_waitcnt vmcnt(24) lgkmcnt(0)
    s_barrier
    ds_read_b64_tr_b16 v[8:9], v225 offset:24576
    ds_read_b64_tr_b16 v[10:11], v225 offset:25088
    ds_read_b64_tr_b16 v[12:13], v225 offset:28672
    ds_read_b64_tr_b16 v[14:15], v225 offset:29184
    ds_read_b64_tr_b16 v[16:17], v225 offset:32768
    ds_read_b64_tr_b16 v[18:19], v225 offset:33280
    ds_read_b64_tr_b16 v[20:21], v225 offset:36864
    ds_read_b64_tr_b16 v[22:23], v225 offset:37376
    s_add_u32 m0, s81, 18432
    s_add_u32 s85, s90, 4294328320
    buffer_load_dwordx4 v219, s[40:43], s85 offen lds
    s_waitcnt vmcnt(16)
    v_max3_u32 v52, v32, v33, v34
    v_max3_u32 v53, v35, v36, v37
    v_max3_u32 v52, v52, v38, v39
    v_max3_u32 v53, v53, v40, v41
    v_max3_u32 v52, v52, v42, v43
    v_max3_u32 v53, v53, v44, v45
    v_max3_u32 v52, v52, v46, v47
    v_max_u32 v52, v52, v53
    v_cmp_eq_u32 vcc, -1, v52
    s_mov_b32 s98, 0
    s_nop 2
    s_cmp_eq_u64 vcc, 0
    s_cbranch_scc1 L_hA_gf_ok
L_hA_gf:
    s_sleep 2
    buffer_load_dwordx2 v[32:33], v58, s[48:51], 0 offen offset:0 sc1
    buffer_load_dwordx2 v[40:41], v59, s[48:51], 0 offen offset:0 sc1
    buffer_load_dwordx2 v[34:35], v58, s[48:51], 0 offen offset:1024 sc1
    buffer_load_dwordx2 v[42:43], v59, s[48:51], 0 offen offset:1280 sc1
    buffer_load_dwordx2 v[36:37], v58, s[48:51], 0 offen offset:2048 sc1
    buffer_load_dwordx2 v[44:45], v59, s[48:51], 0 offen offset:2560 sc1
    buffer_load_dwordx2 v[38:39], v58, s[48:51], 0 offen offset:3072 sc1
    buffer_load_dwordx2 v[46:47], v59, s[48:51], 0 offen offset:3840 sc1
    s_waitcnt vmcnt(0)
    v_max3_u32 v52, v32, v33, v34
    v_max3_u32 v53, v35, v36, v37
    v_max3_u32 v52, v52, v38, v39
    v_max3_u32 v53, v53, v40, v41
    v_max3_u32 v52, v52, v42, v43
    v_max3_u32 v53, v53, v44, v45
    v_max3_u32 v52, v52, v46, v47
    v_max_u32 v52, v52, v53
    v_cmp_eq_u32 vcc, -1, v52
    s_nop 3
    s_cmp_eq_u64 vcc, 0
    s_cbranch_scc1 L_hA_gf_ok
    s_add_u32 s98, s98, 1
    s_cmp_lt_u32 s98, 0x40000
    s_cbranch_scc1 L_hA_gf
L_hA_gf_ok:
    s_add_u32 m0, s81, 19456
    s_add_u32 s85, s90, 4294336512
    buffer_load_dwordx4 v219, s[40:43], s85 offen lds
    v_add_f32 v32, v32, v34
    v_add_f32 v36, v36, v38
    v_add_f32 v33, v33, v35
    v_add_f32 v37, v37, v39
    v_add_f32 v40, v40, v42
    v_add_f32 v44, v44, v46
    v_add_f32 v41, v41, v43
    v_add_f32 v45, v45, v47
    v_add_f32 v32, v32, v36
    v_add_f32 v33, v33, v37
    v_add_f32 v40, v40, v44
    v_add_f32 v41, v41, v45
    s_waitcnt vmcnt(16)
    ds_read_b64_tr_b16 v[96:97], v220 offset:0
    ds_read_b64_tr_b16 v[98:99], v220 offset:2048
    ds_read_b64_tr_b16 v[100:101], v221 offset:0
    ds_read_b64_tr_b16 v[102:103], v221 offset:2048
    ds_read_b64_tr_b16 v[104:105], v222 offset:0
    ds_read_b64_tr_b16 v[106:107], v222 offset:2048
    ds_read_b64_tr_b16 v[108:109], v223 offset:0
    ds_read_b64_tr_b16 v[110:111], v223 offset:2048
    s_waitcnt lgkmcnt(0)
    s_add_u32 m0, s81, 118784
    s_add_u32 s85, s92, 0
    buffer_load_dwordx4 v219, s[40:43], s85 offen lds
    v_mul_f32 v32, 0x3b000000, v32
    v_mul_f32 v33, 0x3b000000, v33
    ds_write_b64 v231, v[40:41]
    v_fma_f32 v33, -v32, v32, v33
    v_max_f32 v33, 0, v33
    v_add_f32 v33, 0x3727c5ac, v33
    s_add_u32 m0, s81, 119808
    s_add_u32 s85, s92, 8192
    buffer_load_dwordx4 v219, s[40:43], s85 offen lds
    v_rsq_f32 v33, v33
    ds_write_b32 v230, v32
    ds_write_b32 v230, v33 offset:576
    s_add_u32 m0, s81, 120832
    s_add_u32 s85, s92, 16384
    buffer_load_dwordx4 v219, s[40:43], s85 offen lds
    s_add_u32 m0, s81, 121856
    s_add_u32 s85, s92, 24576
    buffer_load_dwordx4 v219, s[40:43], s85 offen lds
    s_add_u32 m0, s81, 49152
    s_add_u32 s85, s91, 4294311936
    buffer_load_dwordx4 v219, s[40:43], s85 offen lds
    s_add_u32 m0, s81, 50176
    s_add_u32 s85, s91, 4294320128
    buffer_load_dwordx4 v219, s[40:43], s85 offen lds
    s_add_u32 m0, s81, 51200
    s_add_u32 s85, s91, 4294328320
    buffer_load_dwordx4 v219, s[40:43], s85 offen lds
    s_add_u32 m0, s81, 52224
    s_add_u32 s85, s91, 4294336512
    buffer_load_dwordx4 v219, s[40:43], s85 offen lds
    s_waitcnt lgkmcnt(0)
    s_barrier
    v_mfma_f32_16x16x32_bf16 v[0:3], v[8:11], v[24:27], v[0:3]
    v_mfma_f32_16x16x32_bf16 v[0:3], v[12:15], v[28:31], v[0:3]
    v_mfma_f32_16x16x32_bf16 v[4:7], v[24:27], v[16:19], v[4:7]
    v_mfma_f32_16x16x32_bf16 v[4:7], v[28:31], v[20:23], v[4:7]
    s_setprio 0
    s_mov_b32 s67, 4294914048
    v_add_u32 v246, s67, v220
    v_add_u32 v247, s67, v221
    v_add_u32 v248, s67, v222
    v_add_u32 v249, s67, v223
    s_mov_b32 s67, 4294848512
    v_add_u32 v242, s67, v220
    v_add_u32 v243, s67, v221
    v_add_u32 v244, s67, v222
    v_add_u32 v245, s67, v223
    s_add_u32 m0, s81, 98304
    s_add_u32 s85, s92, 4294311936
    buffer_load_dwordx4 v219, s[40:43], s85 offen lds
    s_add_u32 m0, s81, 99328
    s_add_u32 s85, s92, 4294320128
    buffer_load_dwordx4 v219, s[40:43], s85 offen lds
    s_add_u32 m0, s81, 100352
    s_add_u32 s85, s92, 4294328320
    buffer_load_dwordx4 v219, s[40:43], s85 offen lds
    s_add_u32 m0, s81, 101376
    s_add_u32 s85, s92, 4294336512
    buffer_load_dwordx4 v219, s[40:43], s85 offen lds
    s_add_u32 m0, s81, 32768
    s_add_u32 s85, s93, 0
    buffer_load_dwordx4 v219, s[40:43], s85 offen lds
    s_add_u32 m0, s81, 33792
    s_add_u32 s85, s93, 8192
    buffer_load_dwordx4 v219, s[40:43], s85 offen lds
    s_add_u32 m0, s81, 34816
    s_add_u32 s85, s93, 16384
    buffer_load_dwordx4 v219, s[40:43], s85 offen lds
    s_add_u32 m0, s81, 35840
    s_add_u32 s85, s93, 24576
    buffer_load_dwordx4 v219, s[40:43], s85 offen lds
    s_add_u32 m0, s81, 65536
    s_add_u32 s85, s94, 0
    buffer_load_dwordx4 v219, s[40:43], s85 offen lds
    s_add_u32 m0, s81, 66560
    s_add_u32 s85, s94, 8192
    buffer_load_dwordx4 v219, s[40:43], s85 offen lds
    s_add_u32 m0, s81, 67584
    s_add_u32 s85, s94, 16384
    buffer_load_dwordx4 v219, s[40:43], s85 offen lds
    s_add_u32 m0, s81, 68608
    s_add_u32 s85, s94, 24576
    buffer_load_dwordx4 v219, s[40:43], s85 offen lds
    v_and_b32 v32, 15, v233
    v_lshrrev_b32 v33, 4, v233
    s_lshl_b32 s67, s66, 6
    s_add_u32 s67, s67, 151552
    v_lshlrev_b32 v34, 2, v32
    v_lshlrev_b32 v35, 4, v33
    v_add_u32 v36, 153344, v34
    v_add_u32 v37, 153344, v35
    v_add_u32 v38, s67, v35
    v_add_u32 v39, s67, v34
    ds_read2_b32 v[40:41], v36 offset0:0 offset1:144
    ds_read_b128 v[44:47], v38 offset:512
    ds_read_b32 v42, v39 offset:768
    ds_read_b128 v[48:51], v37
    ds_read_b128 v[52:55], v37 offset:576
    s_lshl_b32 s67, s66, 10
    s_add_u32 s67, s67, 153984
    v_and_b32 v56, 7, v32
    v_lshl_add_u32 v56, v33, 3, v56
    v_lshlrev_b32 v56, 3, v56
    v_lshrrev_b32 v57, 3, v32
    v_lshl_add_u32 v56, v57, 9, v56
    v_add_u32 v56, s67, v56
    v_and_b32 v57, 1, v33
    v_lshl_add_u32 v57, v57, 4, v32
    v_lshlrev_b32 v57, 3, v57
    v_lshrrev_b32 v58, 1, v33
    v_lshl_add_u32 v57, v58, 9, v57
    v_add_u32 v57, s67, v57
    s_waitcnt lgkmcnt(0)
    v_pk_fma_f32 v[0:1], v[44:45], v[40:41], v[0:1] op_sel:[0,0,0] op_sel_hi:[1,0,1] neg_lo:[0,1,0] neg_hi:[0,1,0]
    v_pk_fma_f32 v[2:3], v[46:47], v[40:41], v[2:3] op_sel:[0,0,0] op_sel_hi:[1,0,1] neg_lo:[0,1,0] neg_hi:[0,1,0]
    v_pk_fma_f32 v[4:5], v[48:49], v[42:43], v[4:5] op_sel:[0,0,0] op_sel_hi:[1,0,1] neg_lo:[0,1,0] neg_hi:[0,1,0]
    v_pk_fma_f32 v[6:7], v[50:51], v[42:43], v[6:7] op_sel:[0,0,0] op_sel_hi:[1,0,1] neg_lo:[0,1,0] neg_hi:[0,1,0]
    v_pk_mul_f32 v[0:1], v[0:1], v[40:41] op_sel:[0,1] op_sel_hi:[1,1]
    v_pk_mul_f32 v[2:3], v[2:3], v[40:41] op_sel:[0,1] op_sel_hi:[1,1]
    v_pk_mul_f32 v[4:5], v[4:5], v[52:53]
    v_pk_mul_f32 v[6:7], v[6:7], v[54:55]
    v_cvt_pk_bf16_f32 v0, v0, v1
    v_cvt_pk_bf16_f32 v1, v2, v3
    v_cvt_pk_bf16_f32 v4, v4, v5
    v_cvt_pk_bf16_f32 v5, v6, v7
    ds_write_b64 v56, v[0:1]
    ds_write_b64 v57, v[4:5] offset:256
    s_waitcnt vmcnt(32)
    ds_read_b64_tr_b16 v[112:113], v220 offset:16384
    ds_read_b64_tr_b16 v[114:115], v220 offset:18432
    ds_read_b64_tr_b16 v[116:117], v221 offset:16384
    ds_read_b64_tr_b16 v[118:119], v221 offset:18432
    ds_read_b64_tr_b16 v[120:121], v222 offset:16384
    ds_read_b64_tr_b16 v[122:123], v222 offset:18432
    ds_read_b64_tr_b16 v[124:125], v223 offset:16384
    ds_read_b64_tr_b16 v[126:127], v223 offset:18432
    s_waitcnt lgkmcnt(0)
    s_add_u32 m0, s81, 135168
    s_add_u32 s85, s95, 0
    buffer_load_dwordx4 v219, s[44:47], s85 offen lds
    s_add_u32 m0, s81, 136192
    s_add_u32 s85, s95, 8192
    buffer_load_dwordx4 v219, s[44:47], s85 offen lds
    s_add_u32 m0, s81, 137216
    s_add_u32 s85, s95, 16384
    buffer_load_dwordx4 v219, s[44:47], s85 offen lds
    s_add_u32 m0, s81, 138240
    s_add_u32 s85, s95, 24576
    buffer_load_dwordx4 v219, s[44:47], s85 offen lds
    s_waitcnt vmcnt(20)
    ds_read_b64_tr_b16 v[128:129], v220 offset:0
    ds_read_b64_tr_b16 v[130:131], v220 offset:2048
    ds_read_b64_tr_b16 v[132:133], v221 offset:0
    ds_read_b64_tr_b16 v[134:135], v221 offset:2048
    ds_read_b64_tr_b16 v[136:137], v222 offset:0
    ds_read_b64_tr_b16 v[138:139], v222 offset:2048
    ds_read_b64_tr_b16 v[140:141], v223 offset:0
    ds_read_b64_tr_b16 v[142:143], v223 offset:2048
    s_waitcnt lgkmcnt(0)
    s_add_u32 m0, s81, 118784
    s_add_u32 s85, s96, 0
    buffer_load_dwordx4 v219, s[44:47], s85 offen lds
    s_add_u32 m0, s81, 119808
    s_add_u32 s85, s96, 8192
    buffer_load_dwordx4 v219, s[44:47], s85 offen lds
    s_add_u32 m0, s81, 120832
    s_add_u32 s85, s96, 16384
    buffer_load_dwordx4 v219, s[44:47], s85 offen lds
    s_add_u32 m0, s81, 121856
    s_add_u32 s85, s96, 24576
    buffer_load_dwordx4 v219, s[44:47], s85 offen lds
    s_waitcnt vmcnt(16) lgkmcnt(0)
    s_barrier
    s_waitcnt vmcnt(12)
    ds_read_b64_tr_b16 v[144:145], v242 offset:32768
    ds_read_b64_tr_b16 v[146:147], v242 offset:34816
    ds_read_b64_tr_b16 v[148:149], v243 offset:32768
    ds_read_b64_tr_b16 v[150:151], v243 offset:34816
    ds_read_b64_tr_b16 v[152:153], v244 offset:32768
    ds_read_b64_tr_b16 v[154:155], v244 offset:34816
    ds_read_b64_tr_b16 v[156:157], v245 offset:32768
    ds_read_b64_tr_b16 v[158:159], v245 offset:34816
    s_waitcnt vmcnt(8)
    ds_read_b64_tr_b16 v[160:161], v246 offset:0
    ds_read_b64_tr_b16 v[162:163], v246 offset:2048
    ds_read_b64_tr_b16 v[164:165], v247 offset:0
    ds_read_b64_tr_b16 v[166:167], v247 offset:2048
    ds_read_b64_tr_b16 v[168:169], v248 offset:0
    ds_read_b64_tr_b16 v[170:171], v248 offset:2048
    ds_read_b64_tr_b16 v[172:173], v249 offset:0
    ds_read_b64_tr_b16 v[174:175], v249 offset:2048
    s_waitcnt vmcnt(4)
    ds_read_b64_tr_b16 v[176:177], v220 offset:16384
    ds_read_b64_tr_b16 v[178:179], v220 offset:18432
    ds_read_b64_tr_b16 v[180:181], v221 offset:16384
    ds_read_b64_tr_b16 v[182:183], v221 offset:18432
    ds_read_b64_tr_b16 v[184:185], v222 offset:16384
    ds_read_b64_tr_b16 v[186:187], v222 offset:18432
    ds_read_b64_tr_b16 v[188:189], v223 offset:16384
    ds_read_b64_tr_b16 v[190:191], v223 offset:18432
    s_waitcnt vmcnt(0)
    ds_read_b64_tr_b16 v[192:193], v220 offset:0
    ds_read_b64_tr_b16 v[194:195], v220 offset:2048
    ds_read_b64_tr_b16 v[196:197], v221 offset:0
    ds_read_b64_tr_b16 v[198:199], v221 offset:2048
    ds_read_b64_tr_b16 v[200:201], v222 offset:0
    ds_read_b64_tr_b16 v[202:203], v222 offset:2048
    ds_read_b64_tr_b16 v[204:205], v223 offset:0
    ds_read_b64_tr_b16 v[206:207], v223 offset:2048
    s_add_u32 s76, s81, 32768
    s_add_u32 s77, s81, 65536
    s_add_u32 s78, s81, 118784
    s_add_u32 s79, s81, 135168
    v_mov_b32 v253, v233
    v_mov_b32 v252, v219
    s_waitcnt lgkmcnt(0)
L_P2N:
    buffer_load_dwordx2 v[0:1], off, s[48:51], s100 offset:1024 sc1
    s_mul_i32 s75, s64, 368640
    s_lshr_b32 s88, s88, 15
    s_mul_i32 s88, s88, 5120
    s_add_u32 s88, s88, s75
    s_lshr_b32 s89, s89, 15
    s_mul_i32 s89, s89, 5120
    s_add_u32 s89, s89, s75
    s_lshr_b32 s90, s90, 15
    s_mul_i32 s90, s90, 5120
    s_add_u32 s90, s90, s75
    s_lshr_b32 s91, s91, 15
    s_mul_i32 s91, s91, 5120
    s_add_u32 s91, s91, s75
    s_lshr_b32 s92, s92, 15
    s_mul_i32 s92, s92, 5120
    s_add_u32 s92, s92, s75
    s_lshr_b32 s71, s93, 15
    s_mul_i32 s71, s71, 5120
    s_add_u32 s71, s71, s75
    s_lshr_b32 s72, s94, 15
    s_mul_i32 s72, s72, 5120
    s_add_u32 s72, s72, s75
    s_lshr_b32 s73, s95, 15
    s_mul_i32 s73, s73, 5120
    s_add_u32 s73, s73, s75
    s_add_u32 s73, s73, 286720
    s_lshr_b32 s74, s96, 15
    s_mul_i32 s74, s74, 5120
    s_add_u32 s74, s74, s75
    s_add_u32 s74, s74, 286720
    v_lshrrev_b32 v208, 3, v253
    v_and_b32 v209, 7, v253
    v_lshlrev_b32 v209, 4, v209
    v_add_u32 v210, 0, v208
    v_mul_u32_u24 v211, 37, v210
    v_lshrrev_b32 v211, 8, v211
    v_add_u32 v210, v210, v211
    v_and_b32 v211, 7, v210
    v_cmp_lt_u32 vcc, 2, v211
    s_nop 1
    v_addc_co_u32 v210, vcc, 0, v210, vcc
    v_lshl_add_u32 v248, v210, 7, v209
    v_add_u32 v210, 8, v208
    v_mul_u32_u24 v211, 37, v210
    v_lshrrev_b32 v211, 8, v211
    v_add_u32 v210, v210, v211
    v_and_b32 v211, 7, v210
    v_cmp_lt_u32 vcc, 2, v211
    s_nop 1
    v_addc_co_u32 v210, vcc, 0, v210, vcc
    v_lshl_add_u32 v249, v210, 7, v209
    v_add_u32 v210, 16, v208
    v_mul_u32_u24 v211, 37, v210
    v_lshrrev_b32 v211, 8, v211
    v_add_u32 v210, v210, v211
    v_and_b32 v211, 7, v210
    v_cmp_lt_u32 vcc, 2, v211
    s_nop 1
    v_addc_co_u32 v210, vcc, 0, v210, vcc
    v_lshl_add_u32 v250, v210, 7, v209
    v_add_u32 v210, 24, v208
    v_mul_u32_u24 v211, 37, v210
    v_lshrrev_b32 v211, 8, v211
    v_add_u32 v210, v210, v211
    v_and_b32 v211, 7, v210
    v_cmp_lt_u32 vcc, 2, v211
    s_nop 1
    v_addc_co_u32 v210, vcc, 0, v210, vcc
    v_lshl_add_u32 v251, v210, 7, v209
    v_and_b32 v254, 15, v253
    v_lshrrev_b32 v255, 4, v253
    v_lshlrev_b32 v254, 8, v254
    v_and_b32 v253, 7, v253
    v_xor_b32 v255, v255, v253
    v_lshl_add_u32 v254, v255, 4, v254
    s_waitcnt vmcnt(0)
    v_and_b32 v0, v0, v1
    s_nop 0
    v_readfirstlane_b32 s70, v0
    s_cmp_eq_u32 s70, 1
    s_cbranch_scc1 L_pollBN_ok
    s_mov_b32 s98, 0
L_pollBN:
    s_sleep 1
    buffer_load_dwordx2 v[0:1], off, s[48:51], s100 offset:1024 sc1
    s_waitcnt vmcnt(0)
    v_and_b32 v0, v0, v1
    s_nop 0
    v_readfirstlane_b32 s70, v0
    s_cmp_eq_u32 s70, 1
    s_cbranch_scc1 L_pollBN_ok
    s_add_u32 s98, s98, 1
    s_cmp_lt_u32 s98, 0x40000
    s_cbranch_scc1 L_pollBN
L_pollBN_ok:
    buffer_load_dwordx4 v[208:211], v248, s[48:51], s88 offen sc1
    buffer_load_dwordx4 v[212:215], v248, s[48:51], s89 offen sc1
    buffer_load_dwordx4 v[216:219], v249, s[48:51], s88 offen sc1
    buffer_load_dwordx4 v[220:223], v249, s[48:51], s89 offen sc1
    buffer_load_dwordx4 v[224:227], v250, s[48:51], s88 offen sc1
    buffer_load_dwordx4 v[228:231], v250, s[48:51], s89 offen sc1
    buffer_load_dwordx4 v[232:235], v251, s[48:51], s88 offen sc1
    buffer_load_dwordx4 v[236:239], v251, s[48:51], s89 offen sc1
    buffer_load_dwordx4 v[240:243], v248, s[48:51], s90 offen sc1
    buffer_load_dwordx4 v[244:247], v248, s[48:51], s91 offen sc1
    s_waitcnt vmcnt(8)
    v_mfma_f32_16x16x32_bf16 v[0:3], v[64:67], v[208:211], 0
    v_mfma_f32_16x16x32_bf16 v[0:3], v[80:83], v[212:215], v[0:3]
    v_mfma_f32_16x16x32_bf16 v[16:19], v[68:71], v[208:211], 0
    v_mfma_f32_16x16x32_bf16 v[16:19], v[84:87], v[212:215], v[16:19]
    v_mfma_f32_16x16x32_bf16 v[32:35], v[72:75], v[208:211], 0
    v_mfma_f32_16x16x32_bf16 v[32:35], v[88:91], v[212:215], v[32:35]
    v_mfma_f32_16x16x32_bf16 v[48:51], v[76:79], v[208:211], 0
    v_mfma_f32_16x16x32_bf16 v[48:51], v[92:95], v[212:215], v[48:51]
    buffer_load_dwordx4 v[208:211], v249, s[48:51], s90 offen sc1
    buffer_load_dwordx4 v[212:215], v249, s[48:51], s91 offen sc1
    s_waitcnt vmcnt(8)
    v_mfma_f32_16x16x32_bf16 v[4:7], v[64:67], v[216:219], 0
    v_mfma_f32_16x16x32_bf16 v[4:7], v[80:83], v[220:223], v[4:7]
    v_mfma_f32_16x16x32_bf16 v[20:23], v[68:71], v[216:219], 0
    v_mfma_f32_16x16x32_bf16 v[20:23], v[84:87], v[220:223], v[20:23]
    v_mfma_f32_16x16x32_bf16 v[36:39], v[72:75], v[216:219], 0
    v_mfma_f32_16x16x32_bf16 v[36:39], v[88:91], v[220:223], v[36:39]
    v_mfma_f32_16x16x32_bf16 v[52:55], v[76:79], v[216:219], 0
    v_mfma_f32_16x16x32_bf16 v[52:55], v[92:95], v[220:223], v[52:55]
    buffer_load_dwordx4 v[216:219], v250, s[48:51], s90 offen sc1
    buffer_load_dwordx4 v[220:223], v250, s[48:51], s91 offen sc1
    s_waitcnt vmcnt(8)
    v_mfma_f32_16x16x32_bf16 v[8:11], v[64:67], v[224:227], 0
    v_mfma_f32_16x16x32_bf16 v[8:11], v[80:83], v[228:231], v[8:11]
    v_mfma_f32_16x16x32_bf16 v[24:27], v[68:71], v[224:227], 0
    v_mfma_f32_16x16x32_bf16 v[24:27], v[84:87], v[228:231], v[24:27]
    v_mfma_f32_16x16x32_bf16 v[40:43], v[72:75], v[224:227], 0
    v_mfma_f32_16x16x32_bf16 v[40:43], v[88:91], v[228:231], v[40:43]
    v_mfma_f32_16x16x32_bf16 v[56:59], v[76:79], v[224:227], 0
    v_mfma_f32_16x16x32_bf16 v[56:59], v[92:95], v[228:231], v[56:59]
    buffer_load_dwordx4 v[224:227], v251, s[48:51], s90 offen sc1
    buffer_load_dwordx4 v[228:231], v251, s[48:51], s91 offen sc1
    s_waitcnt vmcnt(8)
    v_mfma_f32_16x16x32_bf16 v[12:15], v[64:67], v[232:235], 0
    v_mfma_f32_16x16x32_bf16 v[12:15], v[80:83], v[236:239], v[12:15]
    v_mfma_f32_16x16x32_bf16 v[28:31], v[68:71], v[232:235], 0
    v_mfma_f32_16x16x32_bf16 v[28:31], v[84:87], v[236:239], v[28:31]
    v_mfma_f32_16x16x32_bf16 v[44:47], v[72:75], v[232:235], 0
    v_mfma_f32_16x16x32_bf16 v[44:47], v[88:91], v[236:239], v[44:47]
    v_mfma_f32_16x16x32_bf16 v[60:63], v[76:79], v[232:235], 0
    v_mfma_f32_16x16x32_bf16 v[60:63], v[92:95], v[236:239], v[60:63]
    buffer_load_dwordx4 v[232:235], v248, s[48:51], s92 offen sc1
    buffer_load_dwordx4 v[236:239], v249, s[48:51], s92 offen sc1
    s_waitcnt vmcnt(8)
    v_mfma_f32_16x16x32_bf16 v[0:3], v[96:99], v[240:243], v[0:3]
    v_mfma_f32_16x16x32_bf16 v[0:3], v[112:115], v[244:247], v[0:3]
    v_mfma_f32_16x16x32_bf16 v[16:19], v[100:103], v[240:243], v[16:19]
    v_mfma_f32_16x16x32_bf16 v[16:19], v[116:119], v[244:247], v[16:19]
    v_mfma_f32_16x16x32_bf16 v[32:35], v[104:107], v[240:243], v[32:35]
    v_mfma_f32_16x16x32_bf16 v[32:35], v[120:123], v[244:247], v[32:35]
    v_mfma_f32_16x16x32_bf16 v[48:51], v[108:111], v[240:243], v[48:51]
    v_mfma_f32_16x16x32_bf16 v[48:51], v[124:127], v[244:247], v[48:51]
    buffer_load_dwordx4 v[240:243], v250, s[48:51], s92 offen sc1
    buffer_load_dwordx4 v[244:247], v251, s[48:51], s92 offen sc1
    s_waitcnt vmcnt(8)
    buffer_load_dword v253, off, s[48:51], s100 offset:0 sc1
    buffer_load_dword v255, off, s[48:51], s100 offset:4 sc1
    v_mfma_f32_16x16x32_bf16 v[4:7], v[96:99], v[208:211], v[4:7]
    v_mfma_f32_16x16x32_bf16 v[4:7], v[112:115], v[212:215], v[4:7]
    v_mfma_f32_16x16x32_bf16 v[20:23], v[100:103], v[208:211], v[20:23]
    v_mfma_f32_16x16x32_bf16 v[20:23], v[116:119], v[212:215], v[20:23]
    v_mfma_f32_16x16x32_bf16 v[36:39], v[104:107], v[208:211], v[36:39]
    v_mfma_f32_16x16x32_bf16 v[36:39], v[120:123], v[212:215], v[36:39]
    v_mfma_f32_16x16x32_bf16 v[52:55], v[108:111], v[208:211], v[52:55]
    v_mfma_f32_16x16x32_bf16 v[52:55], v[124:127], v[212:215], v[52:55]
    s_waitcnt vmcnt(8)
    v_mfma_f32_16x16x32_bf16 v[8:11], v[96:99], v[216:219], v[8:11]
    v_mfma_f32_16x16x32_bf16 v[8:11], v[112:115], v[220:223], v[8:11]
    v_mfma_f32_16x16x32_bf16 v[24:27], v[100:103], v[216:219], v[24:27]
    v_mfma_f32_16x16x32_bf16 v[24:27], v[116:119], v[220:223], v[24:27]
    v_mfma_f32_16x16x32_bf16 v[40:43], v[104:107], v[216:219], v[40:43]
    v_mfma_f32_16x16x32_bf16 v[40:43], v[120:123], v[220:223], v[40:43]
    v_mfma_f32_16x16x32_bf16 v[56:59], v[108:111], v[216:219], v[56:59]
    v_mfma_f32_16x16x32_bf16 v[56:59], v[124:127], v[220:223], v[56:59]
    s_waitcnt vmcnt(6)
    v_mfma_f32_16x16x32_bf16 v[12:15], v[96:99], v[224:227], v[12:15]
    v_mfma_f32_16x16x32_bf16 v[12:15], v[112:115], v[228:231], v[12:15]
    v_mfma_f32_16x16x32_bf16 v[28:31], v[100:103], v[224:227], v[28:31]
    v_mfma_f32_16x16x32_bf16 v[28:31], v[116:119], v[228:231], v[28:31]
    v_mfma_f32_16x16x32_bf16 v[44:47], v[104:107], v[224:227], v[44:47]
    v_mfma_f32_16x16x32_bf16 v[44:47], v[120:123], v[228:231], v[44:47]
    v_mfma_f32_16x16x32_bf16 v[60:63], v[108:111], v[224:227], v[60:63]
    v_mfma_f32_16x16x32_bf16 v[60:63], v[124:127], v[228:231], v[60:63]
    s_waitcnt vmcnt(0)
    v_and_b32 v253, v253, v255
    s_nop 0
    v_readfirstlane_b32 s70, v253
    s_cmp_eq_u32 s70, 1
    s_cbranch_scc1 L_pollAN_ok
    s_mov_b32 s98, 0
L_pollAN:
    s_sleep 1
    buffer_load_dword v253, off, s[48:51], s100 offset:0 sc1
    buffer_load_dword v255, off, s[48:51], s100 offset:4 sc1
    s_waitcnt vmcnt(0)
    v_and_b32 v253, v253, v255
    s_nop 0
    v_readfirstlane_b32 s70, v253
    s_cmp_eq_u32 s70, 1
    s_cbranch_scc1 L_pollAN_ok
    s_add_u32 s98, s98, 1
    s_cmp_lt_u32 s98, 0x40000
    s_cbranch_scc1 L_pollAN
L_pollAN_ok:
    buffer_load_dwordx4 v[208:211], v248, s[48:51], s71 offen sc1
    buffer_load_dwordx4 v[212:215], v248, s[48:51], s72 offen sc1
    buffer_load_dwordx4 v[216:219], v249, s[48:51], s71 offen sc1
    buffer_load_dwordx4 v[220:223], v249, s[48:51], s72 offen sc1
    buffer_load_dwordx4 v[224:227], v248, s[48:51], s73 offen sc1
    buffer_load_dwordx4 v[228:231], v248, s[48:51], s74 offen sc1
    s_waitcnt vmcnt(11)
    v_mfma_f32_16x16x32_bf16 v[0:3], v[128:131], v[232:235], v[0:3]
    v_mfma_f32_16x16x32_bf16 v[16:19], v[132:135], v[232:235], v[16:19]
    v_mfma_f32_16x16x32_bf16 v[32:35], v[136:139], v[232:235], v[32:35]
    v_mfma_f32_16x16x32_bf16 v[48:51], v[140:143], v[232:235], v[48:51]
    buffer_load_dwordx4 v[232:235], v249, s[48:51], s73 offen sc1
    s_waitcnt vmcnt(11)
    v_mfma_f32_16x16x32_bf16 v[4:7], v[128:131], v[236:239], v[4:7]
    v_mfma_f32_16x16x32_bf16 v[20:23], v[132:135], v[236:239], v[20:23]
    v_mfma_f32_16x16x32_bf16 v[36:39], v[136:139], v[236:239], v[36:39]
    v_mfma_f32_16x16x32_bf16 v[52:55], v[140:143], v[236:239], v[52:55]
    buffer_load_dwordx4 v[236:239], v249, s[48:51], s74 offen sc1
    s_waitcnt vmcnt(11)
    v_mfma_f32_16x16x32_bf16 v[8:11], v[128:131], v[240:243], v[8:11]
    v_mfma_f32_16x16x32_bf16 v[24:27], v[132:135], v[240:243], v[24:27]
    v_mfma_f32_16x16x32_bf16 v[40:43], v[136:139], v[240:243], v[40:43]
    v_mfma_f32_16x16x32_bf16 v[56:59], v[140:143], v[240:243], v[56:59]
    buffer_load_dwordx4 v[240:243], v250, s[48:51], s71 offen sc1
    s_waitcnt vmcnt(11)
    v_mfma_f32_16x16x32_bf16 v[12:15], v[128:131], v[244:247], v[12:15]
    v_mfma_f32_16x16x32_bf16 v[28:31], v[132:135], v[244:247], v[28:31]
    v_mfma_f32_16x16x32_bf16 v[44:47], v[136:139], v[244:247], v[44:47]
    v_mfma_f32_16x16x32_bf16 v[60:63], v[140:143], v[244:247], v[60:63]
    buffer_load_dwordx4 v[244:247], v250, s[48:51], s72 offen sc1
    s_waitcnt vmcnt(8)
    s_waitcnt lgkmcnt(0)
    v_mfma_f32_16x16x32_bf16 v[0:3], v[144:147], v[208:211], v[0:3]
    v_mfma_f32_16x16x32_bf16 v[0:3], v[160:163], v[212:215], v[0:3]
    v_mfma_f32_16x16x32_bf16 v[16:19], v[148:151], v[208:211], v[16:19]
    v_mfma_f32_16x16x32_bf16 v[16:19], v[164:167], v[212:215], v[16:19]
    v_mfma_f32_16x16x32_bf16 v[32:35], v[152:155], v[208:211], v[32:35]
    v_mfma_f32_16x16x32_bf16 v[32:35], v[168:171], v[212:215], v[32:35]
    v_mfma_f32_16x16x32_bf16 v[48:51], v[156:159], v[208:211], v[48:51]
    v_mfma_f32_16x16x32_bf16 v[48:51], v[172:175], v[212:215], v[48:51]
    buffer_load_dwordx4 v[208:211], v251, s[48:51], s71 offen sc1
    buffer_load_dwordx4 v[212:215], v251, s[48:51], s72 offen sc1
    s_waitcnt vmcnt(8)
    v_mfma_f32_16x16x32_bf16 v[4:7], v[144:147], v[216:219], v[4:7]
    v_mfma_f32_16x16x32_bf16 v[4:7], v[160:163], v[220:223], v[4:7]
    v_mfma_f32_16x16x32_bf16 v[20:23], v[148:151], v[216:219], v[20:23]
    v_mfma_f32_16x16x32_bf16 v[20:23], v[164:167], v[220:223], v[20:23]
    v_mfma_f32_16x16x32_bf16 v[36:39], v[152:155], v[216:219], v[36:39]
    v_mfma_f32_16x16x32_bf16 v[36:39], v[168:171], v[220:223], v[36:39]
    v_mfma_f32_16x16x32_bf16 v[52:55], v[156:159], v[216:219], v[52:55]
    v_mfma_f32_16x16x32_bf16 v[52:55], v[172:175], v[220:223], v[52:55]
    buffer_load_dwordx4 v[216:219], v250, s[48:51], s73 offen sc1
    buffer_load_dwordx4 v[220:223], v250, s[48:51], s74 offen sc1
    v_mbcnt_lo_u32_b32 v64, -1, 0
    v_mbcnt_hi_u32_b32 v64, -1, v64
    v_and_b32 v66, 7, v64
    v_lshrrev_b32 v71, 3, v64
    s_lshl_b32 s68, s60, 3
    v_add_u32 v72, s68, v71
    v_and_b32 v75, 15, v72
    v_bfe_u32 v74, v72, 4, 1
    v_lshl_add_u32 v73, v75, 1, v74
    v_and_b32 v74, 32, v72
    v_add_u32 v73, v73, v74
    v_lshlrev_b32 v73, 10, v73
    v_lshl_add_u32 v73, v66, 4, v73
    s_lshl_b32 s69, s64, 16
    s_lshl_b32 s68, s65, 7
    s_add_u32 s69, s69, s68
    s_lshr_b32 s67, s60, 1
    s_mov_b32 s88, 0
    s_cmp_eq_u32 s67, 1
    s_cselect_b32 s88, 81920, s88
    s_cmp_eq_u32 s67, 2
    s_cselect_b32 s88, 16384, s88
    s_cmp_eq_u32 s67, 3
    s_cselect_b32 s88, 49152, s88
    s_mov_b32 s89, 32768
    s_cmp_eq_u32 s67, 1
    s_cselect_b32 s89, 65536, s89
    s_cmp_eq_u32 s67, 2
    s_cselect_b32 s89, 118784, s89
    s_cmp_eq_u32 s67, 3
    s_cselect_b32 s89, 135168, s89
    v_lshlrev_b32 v74, 1, v66
    v_xor_b32 v74, v74, v71
    v_lshlrev_b32 v80, 8, v75
    v_lshl_add_u32 v80, v74, 4, v80
    v_add_u32 v81, s88, v80
    v_add_u32 v83, s89, v80
    v_xor_b32 v82, 16, v81
    v_xor_b32 v84, 16, v83
    s_waitcnt vmcnt(8)
    v_mfma_f32_16x16x32_bf16 v[0:3], v[176:179], v[224:227], v[0:3]
    v_mfma_f32_16x16x32_bf16 v[0:3], v[192:195], v[228:231], v[0:3]
    v_mfma_f32_16x16x32_bf16 v[16:19], v[180:183], v[224:227], v[16:19]
    v_mfma_f32_16x16x32_bf16 v[16:19], v[196:199], v[228:231], v[16:19]
    v_mfma_f32_16x16x32_bf16 v[32:35], v[184:187], v[224:227], v[32:35]
    v_mfma_f32_16x16x32_bf16 v[32:35], v[200:203], v[228:231], v[32:35]
    v_mfma_f32_16x16x32_bf16 v[48:51], v[188:191], v[224:227], v[48:51]
    v_mfma_f32_16x16x32_bf16 v[48:51], v[204:207], v[228:231], v[48:51]
    buffer_load_dwordx4 v[224:227], v251, s[48:51], s73 offen sc1
    buffer_load_dwordx4 v[228:231], v251, s[48:51], s74 offen sc1
    s_waitcnt vmcnt(8)
    v_mfma_f32_16x16x32_bf16 v[4:7], v[176:179], v[232:235], v[4:7]
    v_mfma_f32_16x16x32_bf16 v[4:7], v[192:195], v[236:239], v[4:7]
    v_mfma_f32_16x16x32_bf16 v[20:23], v[180:183], v[232:235], v[20:23]
    v_mfma_f32_16x16x32_bf16 v[20:23], v[196:199], v[236:239], v[20:23]
    v_mfma_f32_16x16x32_bf16 v[36:39], v[184:187], v[232:235], v[36:39]
    v_mfma_f32_16x16x32_bf16 v[36:39], v[200:203], v[236:239], v[36:39]
    v_mfma_f32_16x16x32_bf16 v[52:55], v[188:191], v[232:235], v[52:55]
    v_mfma_f32_16x16x32_bf16 v[52:55], v[204:207], v[236:239], v[52:55]
    s_waitcnt vmcnt(6)
    v_mfma_f32_16x16x32_bf16 v[8:11], v[144:147], v[240:243], v[8:11]
    v_mfma_f32_16x16x32_bf16 v[8:11], v[160:163], v[244:247], v[8:11]
    v_mfma_f32_16x16x32_bf16 v[24:27], v[148:151], v[240:243], v[24:27]
    v_mfma_f32_16x16x32_bf16 v[24:27], v[164:167], v[244:247], v[24:27]
    v_mfma_f32_16x16x32_bf16 v[40:43], v[152:155], v[240:243], v[40:43]
    v_mfma_f32_16x16x32_bf16 v[40:43], v[168:171], v[244:247], v[40:43]
    v_mfma_f32_16x16x32_bf16 v[56:59], v[156:159], v[240:243], v[56:59]
    v_mfma_f32_16x16x32_bf16 v[56:59], v[172:175], v[244:247], v[56:59]
    v_add_u32 v253, s76, v254
    v_xor_b32 v255, 64, v253
    ds_write_b128 v253, v[0:3] offset:0
    ds_write_b128 v255, v[16:19] offset:0
    ds_write_b128 v253, v[32:35] offset:128
    ds_write_b128 v255, v[48:51] offset:128
    s_waitcnt vmcnt(4)
    v_mfma_f32_16x16x32_bf16 v[12:15], v[144:147], v[208:211], v[12:15]
    v_mfma_f32_16x16x32_bf16 v[12:15], v[160:163], v[212:215], v[12:15]
    v_mfma_f32_16x16x32_bf16 v[28:31], v[148:151], v[208:211], v[28:31]
    v_mfma_f32_16x16x32_bf16 v[28:31], v[164:167], v[212:215], v[28:31]
    v_mfma_f32_16x16x32_bf16 v[44:47], v[152:155], v[208:211], v[44:47]
    v_mfma_f32_16x16x32_bf16 v[44:47], v[168:171], v[212:215], v[44:47]
    v_mfma_f32_16x16x32_bf16 v[60:63], v[156:159], v[208:211], v[60:63]
    v_mfma_f32_16x16x32_bf16 v[60:63], v[172:175], v[212:215], v[60:63]
    v_add_u32 v253, s77, v254
    v_xor_b32 v255, 64, v253
    ds_write_b128 v253, v[4:7] offset:0
    ds_write_b128 v255, v[20:23] offset:0
    ds_write_b128 v253, v[36:39] offset:128
    ds_write_b128 v255, v[52:55] offset:128
    s_waitcnt lgkmcnt(0)
    s_barrier
    s_waitcnt vmcnt(2)
    v_mfma_f32_16x16x32_bf16 v[8:11], v[176:179], v[216:219], v[8:11]
    v_mfma_f32_16x16x32_bf16 v[8:11], v[192:195], v[220:223], v[8:11]
    v_mfma_f32_16x16x32_bf16 v[24:27], v[180:183], v[216:219], v[24:27]
    v_mfma_f32_16x16x32_bf16 v[24:27], v[196:199], v[220:223], v[24:27]
    v_mfma_f32_16x16x32_bf16 v[40:43], v[184:187], v[216:219], v[40:43]
    v_mfma_f32_16x16x32_bf16 v[40:43], v[200:203], v[220:223], v[40:43]
    v_mfma_f32_16x16x32_bf16 v[56:59], v[188:191], v[216:219], v[56:59]
    v_mfma_f32_16x16x32_bf16 v[56:59], v[204:207], v[220:223], v[56:59]
    s_waitcnt vmcnt(0)
    v_mfma_f32_16x16x32_bf16 v[12:15], v[176:179], v[224:227], v[12:15]
    v_mfma_f32_16x16x32_bf16 v[12:15], v[192:195], v[228:231], v[12:15]
    v_mfma_f32_16x16x32_bf16 v[28:31], v[180:183], v[224:227], v[28:31]
    v_mfma_f32_16x16x32_bf16 v[28:31], v[196:199], v[228:231], v[28:31]
    v_mfma_f32_16x16x32_bf16 v[44:47], v[184:187], v[224:227], v[44:47]
    v_mfma_f32_16x16x32_bf16 v[44:47], v[200:203], v[228:231], v[44:47]
    v_mfma_f32_16x16x32_bf16 v[60:63], v[188:191], v[224:227], v[60:63]
    v_mfma_f32_16x16x32_bf16 v[60:63], v[204:207], v[228:231], v[60:63]
    s_branch L_P2T
L_HB:
    s_load_dwordx2 s[44:45], s[0:1], 16
    s_load_dwordx2 s[40:41], s[0:1], 48
    s_load_dwordx2 s[52:53], s[0:1], 56
    s_load_dwordx2 s[56:57], s[0:1], 64
    s_load_dwordx2 s[48:49], s[0:1], 72
    s_and_b32 s67, s2, 7
    s_lshr_b32 s68, s2, 3
    s_lshr_b32 s70, s68, 4
    s_lshl_b32 s70, s70, 1
    s_and_b32 s69, s68, 1
    s_add_u32 s69, s69, s70
    s_lshl_b32 s64, s67, 2
    s_add_u32 s64, s64, s69
    s_bfe_u32 s65, s68, 0x30001
    s_add_u32 s83, s81, 118784
    s_and_b32 s84, s63, 1
    s_lshl_b32 s84, s84, 1
    s_lshr_b32 s70, s61, 3
    s_add_u32 s97, s84, s70
    s_lshr_b32 s70, s62, 3
    s_add_u32 s84, s84, s70
    s_mov_b32 s42, 1835008
    s_mov_b32 s43, 0x20000
    s_mov_b32 s46, 524288
    s_mov_b32 s47, 0x20000
    s_mov_b32 s50, 268435456
    s_mov_b32 s51, 0x20000
    s_mov_b32 s54, 2097152
    s_mov_b32 s55, 0x20000
    s_mov_b32 s58, 256
    s_mov_b32 s59, 0x20000
    s_waitcnt lgkmcnt(0)
    v_mov_b32 v233, v0
    v_lshrrev_b32 v1, 3, v0
    v_and_b32 v2, 7, v0
    v_bfe_u32 v3, v1, 1, 2
    v_lshlrev_b32 v3, 1, v3
    v_xor_b32 v3, v3, v2
    v_lshlrev_b32 v1, 10, v1
    v_lshl_add_u32 v219, v3, 4, v1
    v_lshrrev_b32 v1, 2, v233
    v_and_b32 v2, 3, v233
    v_lshlrev_b32 v3, 7, v1
    v_lshl_add_u32 v3, v2, 3, v3
    v_add_u32 v3, s83, v3
    v_bfe_u32 v1, v1, 1, 2
    v_xor_b32 v2, 0, v1
    v_lshl_add_u32 v220, v2, 5, v3
    v_xor_b32 v2, 1, v1
    v_lshl_add_u32 v221, v2, 5, v3
    v_xor_b32 v2, 2, v1
    v_lshl_add_u32 v222, v2, 5, v3
    v_xor_b32 v2, 3, v1
    v_lshl_add_u32 v223, v2, 5, v3
    s_lshr_b32 s67, s64, 1
    s_lshl_b32 s67, s67, 4
    s_add_u32 s67, s67, s60
    s_lshl_b32 s67, s67, 7
    s_and_b32 s68, s64, 1
    s_lshl_b32 s68, s68, 3
    s_add_u32 s67, s67, s68
    s_add_u32 s100, s67, 16777216
    s_add_u32 s99, s64, s65
    s_mul_i32 s67, s99, 52
    s_lshr_b32 s67, s67, 8
    s_mul_i32 s67, s67, 5
    s_sub_u32 s67, s99, s67
    s_mul_i32 s68, s60, 5
    s_add_u32 s68, s68, 16
    s_lshl_b32 s70, s65, 7
    s_add_u32 s69, s67, 0
    s_cmp_ge_u32 s69, 5
    s_cselect_b32 s88, 5, 0
    s_sub_u32 s69, s69, s88
    s_add_u32 s69, s69, s68
    s_lshl_b32 s69, s69, 15
    s_add_u32 s88, s69, s70
    s_add_u32 s69, s67, 1
    s_cmp_ge_u32 s69, 5
    s_cselect_b32 s89, 5, 0
    s_sub_u32 s69, s69, s89
    s_add_u32 s69, s69, s68
    s_lshl_b32 s69, s69, 15
    s_add_u32 s89, s69, s70
    s_add_u32 s69, s67, 2
    s_cmp_ge_u32 s69, 5
    s_cselect_b32 s90, 5, 0
    s_sub_u32 s69, s69, s90
    s_add_u32 s69, s69, s68
    s_lshl_b32 s69, s69, 15
    s_add_u32 s90, s69, s70
    s_add_u32 s69, s67, 3
    s_cmp_ge_u32 s69, 5
    s_cselect_b32 s91, 5, 0
    s_sub_u32 s69, s69, s91
    s_add_u32 s69, s69, s68
    s_lshl_b32 s69, s69, 15
    s_add_u32 s91, s69, s70
    s_add_u32 s69, s67, 4
    s_cmp_ge_u32 s69, 5
    s_cselect_b32 s92, 5, 0
    s_sub_u32 s69, s69, s92
    s_add_u32 s69, s69, s68
    s_lshl_b32 s69, s69, 15
    s_add_u32 s92, s69, s70
    s_and_b32 s67, s99, 1
    s_lshl_b32 s68, s60, 1
    s_xor_b32 s69, s67, 0
    s_add_u32 s69, s69, s68
    s_lshl_b32 s69, s69, 15
    s_add_u32 s93, s69, s70
    s_mov_b32 s95, s93
    s_xor_b32 s69, s67, 1
    s_add_u32 s69, s69, s68
    s_lshl_b32 s69, s69, 15
    s_add_u32 s94, s69, s70
    s_mov_b32 s96, s94
    v_lshrrev_b32 v4, 4, v0
    v_bfe_u32 v5, v0, 2, 2
    v_and_b32 v6, 3, v0
    v_lshl_add_u32 v7, v4, 3, v5
    v_lshlrev_b32 v7, 7, v7
    v_lshl_add_u32 v7, v6, 3, v7
    v_lshrrev_b32 v8, 1, v5
    v_and_b32 v9, 1, v4
    v_lshl_add_u32 v8, v9, 1, v8
    s_add_u32 s67, s97, 1
    s_cmp_eq_u32 s97, 0
    s_cselect_b32 s67, 0, s67
    s_lshl_b32 s67, s67, 13
    v_xor_b32 v9, s66, v8
    v_lshl_add_u32 v224, v9, 5, v7
    v_add_u32 v228, s67, v224
    s_cmp_eq_u32 s97, 3
    s_cselect_b32 s67, 1, 6
    s_lshl_b32 s67, s67, 13
    v_add_u32 v229, s67, v228
    s_lshl_b32 s67, s84, 12
    s_add_u32 s67, s67, 81920
    s_lshl_b32 s68, s66, 10
    s_add_u32 s67, s67, s68
    v_lshl_add_u32 v232, v233, 4, s67
    v_mov_b32 v234, 0
    v_mov_b32 v235, 0
    v_mov_b32 v236, 0
    v_mov_b32 v237, 0
    v_mov_b32 v238, 0
    v_mov_b32 v239, 0
    v_mov_b32 v240, 0
    v_mov_b32 v241, 0
    v_mov_b32 v242, 0
    v_mov_b32 v243, 0
    v_mov_b32 v244, 0
    v_mov_b32 v245, 0
    v_mov_b32 v250, 0x3f803f80
    v_mov_b32 v251, 0x3f803f80
    v_mov_b32 v252, 0x3f803f80
    v_mov_b32 v253, 0x3f803f80
    s_add_u32 m0, s80, 16384
    s_add_u32 s85, s73, 128
    buffer_load_dwordx4 v215, s[32:35], s85 offen lds
    s_add_u32 m0, s80, 17408
    s_add_u32 s85, s73, 128
    buffer_load_dwordx4 v216, s[32:35], s85 offen lds
    s_add_u32 m0, s80, 24576
    s_add_u32 s85, s73, 128
    buffer_load_dwordx4 v215, s[36:39], s85 offen lds
    s_add_u32 m0, s80, 25600
    s_add_u32 s85, s73, 128
    buffer_load_dwordx4 v216, s[36:39], s85 offen lds
    s_mov_b64 exec, s[86:87]
    s_add_u32 m0, s80, 32768
    s_nop 0
    buffer_load_dwordx4 v217, s[32:35], s74 offen lds
    s_mov_b64 exec, -1
    s_not_b64 exec, s[86:87]
    s_add_u32 m0, s80, 32768
    s_nop 0
    buffer_load_dwordx4 v217, s[36:39], s74 offen lds
    s_mov_b64 exec, -1
    s_mov_b64 exec, s[86:87]
    s_add_u32 m0, s80, 33792
    s_nop 0
    buffer_load_dwordx4 v218, s[32:35], s74 offen lds
    s_mov_b64 exec, -1
    s_not_b64 exec, s[86:87]
    s_add_u32 m0, s80, 33792
    s_nop 0
    buffer_load_dwordx4 v218, s[36:39], s74 offen lds
    s_mov_b64 exec, -1
    s_lshl_b32 s69, s61, 12
    s_lshr_b32 s70, s63, 1
    s_lshl_b32 s70, s70, 10
    s_add_u32 s69, s69, s70
    s_lshl_b32 s70, s84, 8
    s_add_u32 s69, s69, s70
    s_add_u32 s69, s69, 16842752
    s_lshl_b32 s68, s66, 6
    s_add_u32 s69, s69, s68
    v_and_b32 v62, 0x38, v233
    v_add_u32 v62, s69, v62
    s_add_u32 s69, s97, 1
    s_cmp_eq_u32 s97, 0
    s_cselect_b32 s69, 0, s69
    s_lshl_b32 s69, s69, 8
    s_lshr_b32 s70, s63, 1
    s_mul_i32 s70, s70, 1280
    s_add_u32 s69, s69, s70
    s_lshl_b32 s70, s62, 13
    s_add_u32 s69, s69, s70
    s_add_u32 s69, s69, 16908288
    s_add_u32 s69, s69, s68
    v_and_b32 v63, 0x30, v233
    v_add_u32 v63, s69, v63
    s_lshl_b32 s67, s61, 4
    s_add_u32 s67, s67, s62
    s_lshl_b32 s67, s67, 2
    s_add_u32 s67, s67, s66
    s_mul_i32 s68, s67, 1792
    s_lshl_b32 s67, s67, 9
    v_lshl_add_u32 v57, v233, 7, s68
    v_lshl_add_u32 v56, v233, 7, s67
    v_and_b32 v60, 1, v233
    v_lshlrev_b32 v60, 7, v60
    s_lshl_b32 s67, s61, 12
    s_lshl_b32 s68, s66, 8
    s_add_u32 s67, s67, s68
    s_add_u32 s67, s67, 16842752
    s_sub_u32 s68, s61, 1
    s_max_i32 s68, s68, 0
    s_lshl_b32 s68, s68, 12
    s_add_u32 s68, s68, 16843584
    v_lshl_add_u32 v58, v233, 3, s67
    v_and_b32 v10, 7, v233
    v_bfe_u32 v11, v233, 3, 1
    v_lshl_add_u32 v10, v11, 4, v10
    v_lshl_add_u32 v10, v10, 3, s68
    s_lshl_b32 s67, s66, 7
    s_add_u32 s67, s67, 152832
    v_lshl_add_u32 v230, v233, 2, s67
    v_and_b32 v11, 15, v233
    v_lshlrev_b32 v11, 2, v11
    v_add_u32 v11, 153344, v11
    v_cmp_gt_u32 vcc, 32, v233
    s_nop 1
    v_cndmask_b32 v58, v10, v58, vcc
    v_cndmask_b32 v230, v11, v230, vcc
    s_mul_i32 s67, s66, 320
    s_lshl_b32 s68, s62, 13
    s_add_u32 s68, s68, s67
    s_add_u32 s68, s68, 16908288
    s_add_u32 s67, s67, 151552
    v_min_u32 v10, 39, v233
    v_lshl_add_u32 v59, v10, 3, s68
    v_lshl_add_u32 v231, v10, 3, s67
    s_waitcnt vmcnt(8)
    s_barrier
    s_cmp_lg_u32 s97, 0
    s_cbranch_scc1 L_hB_cr1_0
    ds_read_b64_tr_b16 v[64:65], v228 offset:0
    ds_read_b64_tr_b16 v[66:67], v228 offset:512
    ds_read_b64_tr_b16 v[68:69], v228 offset:4096
    ds_read_b64_tr_b16 v[70:71], v228 offset:4608
    ds_read_b64_tr_b16 v[72:73], v228 offset:8192
    ds_read_b64_tr_b16 v[74:75], v228 offset:8704
    ds_read_b64_tr_b16 v[76:77], v228 offset:12288
    ds_read_b64_tr_b16 v[78:79], v228 offset:12800
L_hB_cr1_0:
    ds_read_b128 v[48:51], v232 offset:0
    s_add_u32 s67, s63, 1
    s_and_b32 s67, s67, 7
    s_lshl_b32 s71, s67, 7
    s_add_u32 s71, s71, s76
    s_mul_i32 s68, s67, 229376
    s_add_u32 s73, s68, s78
    s_add_u32 s74, s68, s79
    s_add_u32 m0, s81, 98304
    s_nop 0
    buffer_load_dwordx4 v208, s[24:27], s71 offen lds
    s_add_u32 m0, s81, 99328
    s_nop 0
    buffer_load_dwordx4 v209, s[24:27], s71 offen lds
    s_add_u32 m0, s81, 100352
    s_nop 0
    buffer_load_dwordx4 v210, s[24:27], s71 offen lds
    s_add_u32 m0, s81, 101376
    s_nop 0
    buffer_load_dwordx4 v211, s[24:27], s71 offen lds
    s_add_u32 m0, s80, 49152
    s_nop 0
    buffer_load_dwordx4 v215, s[32:35], s73 offen lds
    s_add_u32 m0, s80, 50176
    s_nop 0
    buffer_load_dwordx4 v216, s[32:35], s73 offen lds
    s_add_u32 m0, s80, 57344
    s_nop 0
    buffer_load_dwordx4 v215, s[36:39], s73 offen lds
    s_add_u32 m0, s80, 58368
    s_nop 0
    buffer_load_dwordx4 v216, s[36:39], s73 offen lds
    s_add_u32 m0, s80, 65536
    s_add_u32 s85, s73, 128
    buffer_load_dwordx4 v215, s[32:35], s85 offen lds
    s_waitcnt vmcnt(9) lgkmcnt(0)
    s_barrier
    s_cmp_eq_u32 s97, 0
    s_cbranch_scc1 L_hB_cr2_0
    ds_read_b64_tr_b16 v[64:65], v228 offset:0
    ds_read_b64_tr_b16 v[66:67], v228 offset:512
    ds_read_b64_tr_b16 v[68:69], v228 offset:4096
    ds_read_b64_tr_b16 v[70:71], v228 offset:4608
L_hB_cr2_0:
    s_add_u32 m0, s80, 66560
    s_add_u32 s85, s73, 128
    buffer_load_dwordx4 v216, s[32:35], s85 offen lds
    s_add_u32 m0, s80, 73728
    s_add_u32 s85, s73, 128
    buffer_load_dwordx4 v215, s[36:39], s85 offen lds
    s_add_u32 m0, s80, 74752
    s_add_u32 s85, s73, 128
    buffer_load_dwordx4 v216, s[36:39], s85 offen lds
    s_mov_b64 exec, s[86:87]
    s_add_u32 m0, s80, 40960
    s_nop 0
    buffer_load_dwordx4 v217, s[32:35], s74 offen lds
    s_mov_b64 exec, -1
    s_not_b64 exec, s[86:87]
    s_add_u32 m0, s80, 40960
    s_nop 0
    buffer_load_dwordx4 v217, s[36:39], s74 offen lds
    s_mov_b64 exec, -1
    s_mov_b64 exec, s[86:87]
    s_add_u32 m0, s80, 41984
    s_nop 0
    buffer_load_dwordx4 v218, s[32:35], s74 offen lds
    s_mov_b64 exec, -1
    s_not_b64 exec, s[86:87]
    s_add_u32 m0, s80, 41984
    s_nop 0
    buffer_load_dwordx4 v218, s[36:39], s74 offen lds
    s_mov_b64 exec, -1
    s_add_u32 s67, s63, 2
    s_and_b32 s67, s67, 7
    s_lshl_b32 s71, s67, 7
    s_add_u32 s71, s71, s76
    s_mul_i32 s68, s67, 229376
    s_add_u32 s73, s68, s78
    s_add_u32 s74, s68, s79
    s_add_u32 m0, s81, 81920
    s_nop 0
    buffer_load_dwordx4 v208, s[24:27], s71 offen lds
    s_add_u32 m0, s81, 82944
    s_nop 0
    buffer_load_dwordx4 v209, s[24:27], s71 offen lds
    s_add_u32 m0, s81, 83968
    s_nop 0
    buffer_load_dwordx4 v210, s[24:27], s71 offen lds
    s_add_u32 m0, s81, 84992
    s_nop 0
    buffer_load_dwordx4 v211, s[24:27], s71 offen lds
    s_add_u32 m0, s80, 0
    s_nop 0
    buffer_load_dwordx4 v215, s[32:35], s73 offen lds
    s_waitcnt vmcnt(13) lgkmcnt(0)
    s_barrier
    s_cmp_lg_u32 s97, 0
    s_cbranch_scc1 L_hB_cr1_1
    ds_read_b64_tr_b16 v[80:81], v229 offset:0
    ds_read_b64_tr_b16 v[82:83], v229 offset:512
    ds_read_b64_tr_b16 v[84:85], v229 offset:4096
    ds_read_b64_tr_b16 v[86:87], v229 offset:4608
    ds_read_b64_tr_b16 v[88:89], v229 offset:8192
    ds_read_b64_tr_b16 v[90:91], v229 offset:8704
    ds_read_b64_tr_b16 v[92:93], v229 offset:12288
    ds_read_b64_tr_b16 v[94:95], v229 offset:12800
L_hB_cr1_1:
    ds_read_b128 v[44:47], v232 offset:16384
    s_add_u32 m0, s80, 1024
    s_nop 0
    buffer_load_dwordx4 v216, s[32:35], s73 offen lds
    s_add_u32 m0, s80, 8192
    s_nop 0
    buffer_load_dwordx4 v215, s[36:39], s73 offen lds
    s_add_u32 m0, s80, 9216
    s_nop 0
    buffer_load_dwordx4 v216, s[36:39], s73 offen lds
    s_add_u32 m0, s80, 16384
    s_add_u32 s85, s73, 128
    buffer_load_dwordx4 v215, s[32:35], s85 offen lds
    s_add_u32 m0, s80, 17408
    s_add_u32 s85, s73, 128
    buffer_load_dwordx4 v216, s[32:35], s85 offen lds
    s_add_u32 m0, s80, 24576
    s_add_u32 s85, s73, 128
    buffer_load_dwordx4 v215, s[36:39], s85 offen lds
    s_add_u32 m0, s80, 25600
    s_add_u32 s85, s73, 128
    buffer_load_dwordx4 v216, s[36:39], s85 offen lds
    s_mov_b64 exec, s[86:87]
    s_add_u32 m0, s80, 32768
    s_nop 0
    buffer_load_dwordx4 v217, s[32:35], s74 offen lds
    s_mov_b64 exec, -1
    s_waitcnt vmcnt(13) lgkmcnt(0)
    s_barrier
    s_cmp_eq_u32 s97, 0
    s_cbranch_scc1 L_hB_cr2_1
    ds_read_b64_tr_b16 v[80:81], v229 offset:0
    ds_read_b64_tr_b16 v[82:83], v229 offset:512
    ds_read_b64_tr_b16 v[84:85], v229 offset:4096
    ds_read_b64_tr_b16 v[86:87], v229 offset:4608
L_hB_cr2_1:
    s_not_b64 exec, s[86:87]
    s_add_u32 m0, s80, 32768
    s_nop 0
    buffer_load_dwordx4 v217, s[36:39], s74 offen lds
    s_mov_b64 exec, -1
    s_mov_b64 exec, s[86:87]
    s_add_u32 m0, s80, 33792
    s_nop 0
    buffer_load_dwordx4 v218, s[32:35], s74 offen lds
    s_mov_b64 exec, -1
    s_not_b64 exec, s[86:87]
    s_add_u32 m0, s80, 33792
    s_nop 0
    buffer_load_dwordx4 v218, s[36:39], s74 offen lds
    s_mov_b64 exec, -1
    s_add_u32 s67, s63, 3
    s_and_b32 s67, s67, 7
    s_lshl_b32 s71, s67, 7
    s_add_u32 s71, s71, s76
    s_mul_i32 s68, s67, 229376
    s_add_u32 s73, s68, s78
    s_add_u32 s74, s68, s79
    s_add_u32 m0, s81, 98304
    s_nop 0
    buffer_load_dwordx4 v208, s[24:27], s71 offen lds
    s_add_u32 m0, s81, 99328
    s_nop 0
    buffer_load_dwordx4 v209, s[24:27], s71 offen lds
    s_add_u32 m0, s81, 100352
    s_nop 0
    buffer_load_dwordx4 v210, s[24:27], s71 offen lds
    s_add_u32 m0, s81, 101376
    s_nop 0
    buffer_load_dwordx4 v211, s[24:27], s71 offen lds
    s_add_u32 m0, s80, 49152
    s_nop 0
    buffer_load_dwordx4 v215, s[32:35], s73 offen lds
    s_add_u32 m0, s80, 50176
    s_nop 0
    buffer_load_dwordx4 v216, s[32:35], s73 offen lds
    s_add_u32 m0, s80, 57344
    s_nop 0
    buffer_load_dwordx4 v215, s[36:39], s73 offen lds
    s_add_u32 m0, s80, 58368
    s_nop 0
    buffer_load_dwordx4 v216, s[36:39], s73 offen lds
    s_waitcnt vmcnt(16) lgkmcnt(0)
    s_barrier
    s_add_u32 m0, s80, 65536
    s_add_u32 s85, s73, 128
    buffer_load_dwordx4 v215, s[32:35], s85 offen lds
    v_mfma_f32_16x16x32_bf16 v[234:237], v[64:67], v[250:253], v[234:237]
    v_mfma_f32_16x16x32_bf16 v[234:237], v[68:71], v[250:253], v[234:237]
    v_mfma_f32_16x16x32_bf16 v[234:237], v[80:83], v[250:253], v[234:237]
    v_mfma_f32_16x16x32_bf16 v[234:237], v[84:87], v[250:253], v[234:237]
    s_add_u32 m0, s80, 66560
    s_add_u32 s85, s73, 128
    buffer_load_dwordx4 v216, s[32:35], s85 offen lds
    s_cmp_lg_u32 s97, 0
    s_cbranch_scc1 L_hB_cm
    v_mfma_f32_16x16x32_bf16 v[238:241], v[72:75], v[250:253], v[238:241]
    v_mfma_f32_16x16x32_bf16 v[238:241], v[76:79], v[250:253], v[238:241]
    v_mfma_f32_16x16x32_bf16 v[238:241], v[88:91], v[250:253], v[238:241]
    v_mfma_f32_16x16x32_bf16 v[238:241], v[92:95], v[250:253], v[238:241]
L_hB_cm:
    s_add_u32 m0, s80, 73728
    s_add_u32 s85, s73, 128
    buffer_load_dwordx4 v215, s[36:39], s85 offen lds
    s_add_u32 m0, s80, 74752
    s_add_u32 s85, s73, 128
    buffer_load_dwordx4 v216, s[36:39], s85 offen lds
    s_mov_b64 exec, s[86:87]
    s_add_u32 m0, s80, 40960
    s_nop 0
    buffer_load_dwordx4 v217, s[32:35], s74 offen lds
    s_mov_b64 exec, -1
    s_not_b64 exec, s[86:87]
    s_add_u32 m0, s80, 40960
    s_nop 0
    buffer_load_dwordx4 v217, s[36:39], s74 offen lds
    s_mov_b64 exec, -1
    s_mov_b64 exec, s[86:87]
    s_add_u32 m0, s80, 41984
    s_nop 0
    buffer_load_dwordx4 v218, s[32:35], s74 offen lds
    s_mov_b64 exec, -1
    s_not_b64 exec, s[86:87]
    s_add_u32 m0, s80, 41984
    s_nop 0
    buffer_load_dwordx4 v218, s[36:39], s74 offen lds
    s_mov_b64 exec, -1
    s_add_u32 m0, s81, 118784
    s_add_u32 s85, s88, 0
    buffer_load_dwordx4 v219, s[40:43], s85 offen lds
    s_waitcnt vmcnt(17) lgkmcnt(0)
    s_barrier
    s_add_u32 s67, s63, 4
    s_and_b32 s67, s67, 7
    s_lshl_b32 s71, s67, 7
    s_add_u32 s71, s71, s76
    s_mul_i32 s68, s67, 229376
    s_add_u32 s73, s68, s78
    s_add_u32 s74, s68, s79
    s_add_u32 m0, s81, 81920
    s_nop 0
    buffer_load_dwordx4 v208, s[24:27], s71 offen lds
    s_mov_b32 exec_lo, 0x00010001
    s_mov_b32 exec_hi, 0x00010001
    buffer_store_dwordx4 v[234:237], v63, s[48:51], 0 offen sc1
    s_cmp_lg_u32 s97, 0
    s_cbranch_scc1 L_hB_cp
    buffer_store_dwordx4 v[238:241], v63, s[48:51], 0 offen offset:256 sc1
L_hB_cp:
    s_mov_b64 exec, -1
    s_add_u32 m0, s81, 82944
    s_nop 0
    buffer_load_dwordx4 v209, s[24:27], s71 offen lds
    v_lshlrev_b32 v52, 16, v48
    v_and_b32 v53, 0xffff0000, v48
    v_add_f32 v242, v242, v52
    v_add_f32 v243, v243, v53
    v_fmac_f32 v244, v52, v52
    v_fmac_f32 v245, v53, v53
    s_add_u32 m0, s81, 83968
    s_nop 0
    buffer_load_dwordx4 v210, s[24:27], s71 offen lds
    v_lshlrev_b32 v52, 16, v49
    v_and_b32 v53, 0xffff0000, v49
    v_add_f32 v242, v242, v52
    v_add_f32 v243, v243, v53
    v_fmac_f32 v244, v52, v52
    v_fmac_f32 v245, v53, v53
    s_add_u32 m0, s81, 84992
    s_nop 0
    buffer_load_dwordx4 v211, s[24:27], s71 offen lds
    v_lshlrev_b32 v52, 16, v50
    v_and_b32 v53, 0xffff0000, v50
    v_add_f32 v242, v242, v52
    v_add_f32 v243, v243, v53
    v_fmac_f32 v244, v52, v52
    v_fmac_f32 v245, v53, v53
    s_add_u32 m0, s80, 0
    s_nop 0
    buffer_load_dwordx4 v215, s[32:35], s73 offen lds
    v_lshlrev_b32 v52, 16, v51
    v_and_b32 v53, 0xffff0000, v51
    v_add_f32 v242, v242, v52
    v_add_f32 v243, v243, v53
    v_fmac_f32 v244, v52, v52
    v_fmac_f32 v245, v53, v53
    s_add_u32 m0, s80, 1024
    s_nop 0
    buffer_load_dwordx4 v216, s[32:35], s73 offen lds
    s_add_u32 m0, s80, 8192
    s_nop 0
    buffer_load_dwordx4 v215, s[36:39], s73 offen lds
    s_add_u32 m0, s80, 9216
    s_nop 0
    buffer_load_dwordx4 v216, s[36:39], s73 offen lds
    s_waitcnt vmcnt(17) lgkmcnt(0)
    s_barrier
    s_add_u32 m0, s80, 16384
    s_add_u32 s85, s73, 128
    buffer_load_dwordx4 v215, s[32:35], s85 offen lds
    v_lshlrev_b32 v52, 16, v44
    v_and_b32 v53, 0xffff0000, v44
    v_add_f32 v242, v242, v52
    v_add_f32 v243, v243, v53
    v_fmac_f32 v244, v52, v52
    v_fmac_f32 v245, v53, v53
    s_add_u32 m0, s80, 17408
    s_add_u32 s85, s73, 128
    buffer_load_dwordx4 v216, s[32:35], s85 offen lds
    v_lshlrev_b32 v52, 16, v45
    v_and_b32 v53, 0xffff0000, v45
    v_add_f32 v242, v242, v52
    v_add_f32 v243, v243, v53
    v_fmac_f32 v244, v52, v52
    v_fmac_f32 v245, v53, v53
    s_add_u32 m0, s80, 24576
    s_add_u32 s85, s73, 128
    buffer_load_dwordx4 v215, s[36:39], s85 offen lds
    v_lshlrev_b32 v52, 16, v46
    v_and_b32 v53, 0xffff0000, v46
    v_add_f32 v242, v242, v52
    v_add_f32 v243, v243, v53
    v_fmac_f32 v244, v52, v52
    v_fmac_f32 v245, v53, v53
    s_add_u32 m0, s80, 25600
    s_add_u32 s85, s73, 128
    buffer_load_dwordx4 v216, s[36:39], s85 offen lds
    v_lshlrev_b32 v52, 16, v47
    v_and_b32 v53, 0xffff0000, v47
    v_add_f32 v242, v242, v52
    v_add_f32 v243, v243, v53
    v_fmac_f32 v244, v52, v52
    v_fmac_f32 v245, v53, v53
    s_mov_b64 exec, s[86:87]
    s_add_u32 m0, s80, 32768
    s_nop 0
    buffer_load_dwordx4 v217, s[32:35], s74 offen lds
    s_mov_b64 exec, -1
    s_not_b64 exec, s[86:87]
    s_add_u32 m0, s80, 32768
    s_nop 0
    buffer_load_dwordx4 v217, s[36:39], s74 offen lds
    s_mov_b64 exec, -1
    s_mov_b64 exec, s[86:87]
    s_add_u32 m0, s80, 33792
    s_nop 0
    buffer_load_dwordx4 v218, s[32:35], s74 offen lds
    s_mov_b64 exec, -1
    s_not_b64 exec, s[86:87]
    s_add_u32 m0, s80, 33792
    s_nop 0
    buffer_load_dwordx4 v218, s[36:39], s74 offen lds
    s_mov_b64 exec, -1
    s_add_u32 m0, s81, 119808
    s_add_u32 s85, s88, 8192
    buffer_load_dwordx4 v219, s[40:43], s85 offen lds
    s_waitcnt vmcnt(18) lgkmcnt(0)
    s_barrier
    s_add_u32 s67, s63, 5
    s_and_b32 s67, s67, 7
    s_lshl_b32 s71, s67, 7
    s_add_u32 s71, s71, s76
    s_mul_i32 s68, s67, 229376
    s_add_u32 s73, s68, s78
    s_add_u32 s74, s68, s79
    s_add_u32 m0, s81, 98304
    s_nop 0
    buffer_load_dwordx4 v208, s[24:27], s71 offen lds
    v_add_f32 v242, v242, v243
    v_add_f32 v243, v244, v245
    s_nop 1
    s_add_u32 m0, s81, 99328
    s_nop 0
    buffer_load_dwordx4 v209, s[24:27], s71 offen lds
    v_add_f32_dpp v242, v242, v242 quad_perm:[1,0,3,2] row_mask:0xf bank_mask:0xf
    v_add_f32_dpp v243, v243, v243 quad_perm:[1,0,3,2] row_mask:0xf bank_mask:0xf
    s_nop 0
    s_add_u32 m0, s81, 100352
    s_nop 0
    buffer_load_dwordx4 v210, s[24:27], s71 offen lds
    v_add_f32_dpp v242, v242, v242 quad_perm:[2,3,0,1] row_mask:0xf bank_mask:0xf
    v_add_f32_dpp v243, v243, v243 quad_perm:[2,3,0,1] row_mask:0xf bank_mask:0xf
    s_nop 0
    s_add_u32 m0, s81, 101376
    s_nop 0
    buffer_load_dwordx4 v211, s[24:27], s71 offen lds
    v_add_f32_dpp v242, v242, v242 row_half_mirror row_mask:0xf bank_mask:0xf
    v_add_f32_dpp v243, v243, v243 row_half_mirror row_mask:0xf bank_mask:0xf
    s_nop 0
    s_add_u32 m0, s80, 49152
    s_nop 0
    buffer_load_dwordx4 v215, s[32:35], s73 offen lds
    s_mov_b32 exec_lo, 0x01010101
    s_mov_b32 exec_hi, 0x01010101
    buffer_store_dwordx2 v[242:243], v62, s[48:51], 0 offen sc1
    s_mov_b64 exec, -1
    s_add_u32 m0, s80, 50176
    s_nop 0
    buffer_load_dwordx4 v216, s[32:35], s73 offen lds
    s_add_u32 m0, s80, 57344
    s_nop 0
    buffer_load_dwordx4 v215, s[36:39], s73 offen lds
    s_add_u32 m0, s80, 58368
    s_nop 0
    buffer_load_dwordx4 v216, s[36:39], s73 offen lds
    s_waitcnt vmcnt(17) lgkmcnt(0)
    s_barrier
    s_add_u32 m0, s80, 65536
    s_add_u32 s85, s73, 128
    buffer_load_dwordx4 v215, s[32:35], s85 offen lds
    s_add_u32 m0, s80, 66560
    s_add_u32 s85, s73, 128
    buffer_load_dwordx4 v216, s[32:35], s85 offen lds
    s_add_u32 m0, s80, 73728
    s_add_u32 s85, s73, 128
    buffer_load_dwordx4 v215, s[36:39], s85 offen lds
    s_add_u32 m0, s80, 74752
    s_add_u32 s85, s73, 128
    buffer_load_dwordx4 v216, s[36:39], s85 offen lds
    s_mov_b64 exec, s[86:87]
    s_add_u32 m0, s80, 40960
    s_nop 0
    buffer_load_dwordx4 v217, s[32:35], s74 offen lds
    s_mov_b64 exec, -1
    s_not_b64 exec, s[86:87]
    s_add_u32 m0, s80, 40960
    s_nop 0
    buffer_load_dwordx4 v217, s[36:39], s74 offen lds
    s_mov_b64 exec, -1
    s_mov_b64 exec, s[86:87]
    s_add_u32 m0, s80, 41984
    s_nop 0
    buffer_load_dwordx4 v218, s[32:35], s74 offen lds
    s_mov_b64 exec, -1
    s_not_b64 exec, s[86:87]
    s_add_u32 m0, s80, 41984
    s_nop 0
    buffer_load_dwordx4 v218, s[36:39], s74 offen lds
    s_mov_b64 exec, -1
    s_add_u32 m0, s81, 120832
    s_add_u32 s85, s88, 16384
    buffer_load_dwordx4 v219, s[40:43], s85 offen lds
    s_waitcnt vmcnt(18) lgkmcnt(0)
    s_barrier
    s_add_u32 s67, s63, 6
    s_and_b32 s67, s67, 7
    s_lshl_b32 s71, s67, 7
    s_add_u32 s71, s71, s76
    s_mul_i32 s68, s67, 229376
    s_add_u32 s73, s68, s78
    s_add_u32 s74, s68, s79
    s_add_u32 m0, s81, 81920
    s_nop 0
    buffer_load_dwordx4 v208, s[24:27], s71 offen lds
    buffer_load_dword v61, v60, s[56:59], 0 offen sc1
    s_add_u32 m0, s81, 82944
    s_nop 0
    buffer_load_dwordx4 v209, s[24:27], s71 offen lds
    s_add_u32 m0, s81, 83968
    s_nop 0
    buffer_load_dwordx4 v210, s[24:27], s71 offen lds
    s_add_u32 m0, s81, 84992
    s_nop 0
    buffer_load_dwordx4 v211, s[24:27], s71 offen lds
    s_add_u32 m0, s80, 0
    s_nop 0
    buffer_load_dwordx4 v215, s[32:35], s73 offen lds
    s_add_u32 m0, s80, 1024
    s_nop 0
    buffer_load_dwordx4 v216, s[32:35], s73 offen lds
    s_add_u32 m0, s80, 8192
    s_nop 0
    buffer_load_dwordx4 v215, s[36:39], s73 offen lds
    s_add_u32 m0, s80, 9216
    s_nop 0
    buffer_load_dwordx4 v216, s[36:39], s73 offen lds
    s_waitcnt vmcnt(18) lgkmcnt(0)
    s_barrier
    s_add_u32 m0, s80, 16384
    s_add_u32 s85, s73, 128
    buffer_load_dwordx4 v215, s[32:35], s85 offen lds
    s_add_u32 m0, s80, 17408
    s_add_u32 s85, s73, 128
    buffer_load_dwordx4 v216, s[32:35], s85 offen lds
    s_add_u32 m0, s80, 24576
    s_add_u32 s85, s73, 128
    buffer_load_dwordx4 v215, s[36:39], s85 offen lds
    s_add_u32 m0, s80, 25600
    s_add_u32 s85, s73, 128
    buffer_load_dwordx4 v216, s[36:39], s85 offen lds
    s_mov_b64 exec, s[86:87]
    s_add_u32 m0, s80, 32768
    s_nop 0
    buffer_load_dwordx4 v217, s[32:35], s74 offen lds
    s_mov_b64 exec, -1
    s_not_b64 exec, s[86:87]
    s_add_u32 m0, s80, 32768
    s_nop 0
    buffer_load_dwordx4 v217, s[36:39], s74 offen lds
    s_mov_b64 exec, -1
    s_mov_b64 exec, s[86:87]
    s_add_u32 m0, s80, 33792
    s_nop 0
    buffer_load_dwordx4 v218, s[32:35], s74 offen lds
    s_mov_b64 exec, -1
    s_not_b64 exec, s[86:87]
    s_add_u32 m0, s80, 33792
    s_nop 0
    buffer_load_dwordx4 v218, s[36:39], s74 offen lds
    s_mov_b64 exec, -1
    s_add_u32 m0, s81, 121856
    s_add_u32 s85, s88, 24576
    buffer_load_dwordx4 v219, s[40:43], s85 offen lds
    s_waitcnt vmcnt(19) lgkmcnt(0)
    s_barrier
    s_add_u32 s67, s63, 7
    s_and_b32 s67, s67, 7
    s_lshl_b32 s71, s67, 7
    s_add_u32 s71, s71, s76
    s_mul_i32 s68, s67, 229376
    s_add_u32 s73, s68, s78
    s_add_u32 s74, s68, s79
    s_add_u32 m0, s81, 98304
    s_nop 0
    buffer_load_dwordx4 v208, s[24:27], s71 offen lds
    s_waitcnt vmcnt(17)
    v_cmp_gt_u32 vcc, 128, v61
    s_mov_b32 s98, 0
    s_nop 2
    s_cmp_eq_u64 vcc, 0
    s_cbranch_scc1 L_hB_cnt_done
L_hB_cnt:
    s_sleep 4
    buffer_load_dword v61, v60, s[56:59], 0 offen sc1
    s_waitcnt vmcnt(0)
    v_cmp_gt_u32 vcc, 128, v61
    s_nop 3
    s_cmp_eq_u64 vcc, 0
    s_cbranch_scc1 L_hB_cnt_done
    s_add_u32 s98, s98, 1
    s_cmp_lt_u32 s98, 0x40000
    s_cbranch_scc1 L_hB_cnt
L_hB_cnt_done:
    s_add_u32 m0, s81, 99328
    s_nop 0
    buffer_load_dwordx4 v209, s[24:27], s71 offen lds
    s_add_u32 m0, s81, 100352
    s_nop 0
    buffer_load_dwordx4 v210, s[24:27], s71 offen lds
    s_add_u32 m0, s81, 101376
    s_nop 0
    buffer_load_dwordx4 v211, s[24:27], s71 offen lds
    s_add_u32 m0, s80, 49152
    s_nop 0
    buffer_load_dwordx4 v215, s[32:35], s73 offen lds
    s_add_u32 m0, s80, 50176
    s_nop 0
    buffer_load_dwordx4 v216, s[32:35], s73 offen lds
    s_add_u32 m0, s80, 57344
    s_nop 0
    buffer_load_dwordx4 v215, s[36:39], s73 offen lds
    s_add_u32 m0, s80, 58368
    s_nop 0
    buffer_load_dwordx4 v216, s[36:39], s73 offen lds
    s_waitcnt vmcnt(17) lgkmcnt(0)
    s_barrier
    s_add_u32 m0, s80, 65536
    s_add_u32 s85, s73, 128
    buffer_load_dwordx4 v215, s[32:35], s85 offen lds
    s_add_u32 m0, s80, 66560
    s_add_u32 s85, s73, 128
    buffer_load_dwordx4 v216, s[32:35], s85 offen lds
    s_add_u32 m0, s80, 73728
    s_add_u32 s85, s73, 128
    buffer_load_dwordx4 v215, s[36:39], s85 offen lds
    s_add_u32 m0, s80, 74752
    s_add_u32 s85, s73, 128
    buffer_load_dwordx4 v216, s[36:39], s85 offen lds
    s_mov_b64 exec, s[86:87]
    s_add_u32 m0, s80, 40960
    s_nop 0
    buffer_load_dwordx4 v217, s[32:35], s74 offen lds
    s_mov_b64 exec, -1
    s_not_b64 exec, s[86:87]
    s_add_u32 m0, s80, 40960
    s_nop 0
    buffer_load_dwordx4 v217, s[36:39], s74 offen lds
    s_mov_b64 exec, -1
    s_mov_b64 exec, s[86:87]
    s_add_u32 m0, s80, 41984
    s_nop 0
    buffer_load_dwordx4 v218, s[32:35], s74 offen lds
    s_mov_b64 exec, -1
    s_not_b64 exec, s[86:87]
    s_add_u32 m0, s80, 41984
    s_nop 0
    buffer_load_dwordx4 v218, s[36:39], s74 offen lds
    s_mov_b64 exec, -1
    s_add_u32 m0, s81, 135168
    s_add_u32 s85, s89, 0
    buffer_load_dwordx4 v219, s[40:43], s85 offen lds
    s_waitcnt vmcnt(18) lgkmcnt(0)
    s_barrier
    s_waitcnt vmcnt(17)
    ds_read_b64_tr_b16 v[64:65], v220 offset:0
    ds_read_b64_tr_b16 v[66:67], v220 offset:2048
    ds_read_b64_tr_b16 v[68:69], v221 offset:0
    ds_read_b64_tr_b16 v[70:71], v221 offset:2048
    ds_read_b64_tr_b16 v[72:73], v222 offset:0
    ds_read_b64_tr_b16 v[74:75], v222 offset:2048
    ds_read_b64_tr_b16 v[76:77], v223 offset:0
    ds_read_b64_tr_b16 v[78:79], v223 offset:2048
    s_waitcnt lgkmcnt(0)
    s_add_u32 m0, s81, 136192
    s_add_u32 s85, s89, 8192
    buffer_load_dwordx4 v219, s[40:43], s85 offen lds
    buffer_load_dwordx2 v[32:33], v58, s[48:51], 0 offen offset:0 sc1
    buffer_load_dwordx2 v[40:41], v59, s[48:51], 0 offen offset:0 sc1
    buffer_load_dwordx2 v[34:35], v58, s[48:51], 0 offen offset:1024 sc1
    buffer_load_dwordx2 v[42:43], v59, s[48:51], 0 offen offset:1280 sc1
    buffer_load_dwordx2 v[36:37], v58, s[48:51], 0 offen offset:2048 sc1
    buffer_load_dwordx2 v[44:45], v59, s[48:51], 0 offen offset:2560 sc1
    buffer_load_dwordx2 v[38:39], v58, s[48:51], 0 offen offset:3072 sc1
    buffer_load_dwordx2 v[46:47], v59, s[48:51], 0 offen offset:3840 sc1
    s_add_u32 m0, s81, 137216
    s_add_u32 s85, s89, 16384
    buffer_load_dwordx4 v219, s[40:43], s85 offen lds
    s_add_u32 m0, s81, 138240
    s_add_u32 s85, s89, 24576
    buffer_load_dwordx4 v219, s[40:43], s85 offen lds
    s_add_u32 m0, s81, 118784
    s_add_u32 s85, s90, 0
    buffer_load_dwordx4 v219, s[40:43], s85 offen lds
    s_add_u32 m0, s81, 119808
    s_add_u32 s85, s90, 8192
    buffer_load_dwordx4 v219, s[40:43], s85 offen lds
    s_add_u32 m0, s81, 120832
    s_add_u32 s85, s90, 16384
    buffer_load_dwordx4 v219, s[40:43], s85 offen lds
    s_add_u32 m0, s81, 121856
    s_add_u32 s85, s90, 24576
    buffer_load_dwordx4 v219, s[40:43], s85 offen lds
    s_add_u32 m0, s81, 0
    s_add_u32 s85, s88, 4294311936
    buffer_load_dwordx4 v219, s[40:43], s85 offen lds
    s_add_u32 m0, s81, 1024
    s_add_u32 s85, s88, 4294320128
    buffer_load_dwordx4 v219, s[40:43], s85 offen lds
    s_add_u32 m0, s81, 2048
    s_add_u32 s85, s88, 4294328320
    buffer_load_dwordx4 v219, s[40:43], s85 offen lds
    s_waitcnt vmcnt(27) lgkmcnt(0)
    s_barrier
    s_add_u32 m0, s81, 3072
    s_add_u32 s85, s88, 4294336512
    buffer_load_dwordx4 v219, s[40:43], s85 offen lds
    s_add_u32 m0, s81, 81920
    s_add_u32 s85, s89, 4294311936
    buffer_load_dwordx4 v219, s[40:43], s85 offen lds
    s_add_u32 m0, s81, 82944
    s_add_u32 s85, s89, 4294320128
    buffer_load_dwordx4 v219, s[40:43], s85 offen lds
    s_add_u32 m0, s81, 83968
    s_add_u32 s85, s89, 4294328320
    buffer_load_dwordx4 v219, s[40:43], s85 offen lds
    s_add_u32 m0, s81, 84992
    s_add_u32 s85, s89, 4294336512
    buffer_load_dwordx4 v219, s[40:43], s85 offen lds
    s_add_u32 m0, s81, 16384
    s_add_u32 s85, s90, 4294311936
    buffer_load_dwordx4 v219, s[40:43], s85 offen lds
    s_add_u32 m0, s81, 17408
    s_add_u32 s85, s90, 4294320128
    buffer_load_dwordx4 v219, s[40:43], s85 offen lds
    s_waitcnt vmcnt(26) lgkmcnt(0)
    s_barrier
    s_add_u32 m0, s81, 18432
    s_add_u32 s85, s90, 4294328320
    buffer_load_dwordx4 v219, s[40:43], s85 offen lds
    s_waitcnt vmcnt(17)
    v_max3_u32 v52, v32, v33, v34
    v_max3_u32 v53, v35, v36, v37
    v_max3_u32 v52, v52, v38, v39
    v_max3_u32 v53, v53, v40, v41
    v_max3_u32 v52, v52, v42, v43
    v_max3_u32 v53, v53, v44, v45
    v_max3_u32 v52, v52, v46, v47
    v_max_u32 v52, v52, v53
    v_cmp_eq_u32 vcc, -1, v52
    s_mov_b32 s98, 0
    s_nop 2
    s_cmp_eq_u64 vcc, 0
    s_cbranch_scc1 L_hB_gf_ok
L_hB_gf:
    s_sleep 2
    buffer_load_dwordx2 v[32:33], v58, s[48:51], 0 offen offset:0 sc1
    buffer_load_dwordx2 v[40:41], v59, s[48:51], 0 offen offset:0 sc1
    buffer_load_dwordx2 v[34:35], v58, s[48:51], 0 offen offset:1024 sc1
    buffer_load_dwordx2 v[42:43], v59, s[48:51], 0 offen offset:1280 sc1
    buffer_load_dwordx2 v[36:37], v58, s[48:51], 0 offen offset:2048 sc1
    buffer_load_dwordx2 v[44:45], v59, s[48:51], 0 offen offset:2560 sc1
    buffer_load_dwordx2 v[38:39], v58, s[48:51], 0 offen offset:3072 sc1
    buffer_load_dwordx2 v[46:47], v59, s[48:51], 0 offen offset:3840 sc1
    s_waitcnt vmcnt(0)
    v_max3_u32 v52, v32, v33, v34
    v_max3_u32 v53, v35, v36, v37
    v_max3_u32 v52, v52, v38, v39
    v_max3_u32 v53, v53, v40, v41
    v_max3_u32 v52, v52, v42, v43
    v_max3_u32 v53, v53, v44, v45
    v_max3_u32 v52, v52, v46, v47
    v_max_u32 v52, v52, v53
    v_cmp_eq_u32 vcc, -1, v52
    s_nop 3
    s_cmp_eq_u64 vcc, 0
    s_cbranch_scc1 L_hB_gf_ok
    s_add_u32 s98, s98, 1
    s_cmp_lt_u32 s98, 0x40000
    s_cbranch_scc1 L_hB_gf
L_hB_gf_ok:
    s_add_u32 m0, s81, 19456
    s_add_u32 s85, s90, 4294336512
    buffer_load_dwordx4 v219, s[40:43], s85 offen lds
    v_add_f32 v32, v32, v34
    v_add_f32 v36, v36, v38
    v_add_f32 v33, v33, v35
    v_add_f32 v37, v37, v39
    v_add_f32 v40, v40, v42
    v_add_f32 v44, v44, v46
    v_add_f32 v41, v41, v43
    v_add_f32 v45, v45, v47
    v_add_f32 v32, v32, v36
    v_add_f32 v33, v33, v37
    v_add_f32 v40, v40, v44
    v_add_f32 v41, v41, v45
    s_waitcnt vmcnt(16)
    ds_read_b64_tr_b16 v[80:81], v220 offset:16384
    ds_read_b64_tr_b16 v[82:83], v220 offset:18432
    ds_read_b64_tr_b16 v[84:85], v221 offset:16384
    ds_read_b64_tr_b16 v[86:87], v221 offset:18432
    ds_read_b64_tr_b16 v[88:89], v222 offset:16384
    ds_read_b64_tr_b16 v[90:91], v222 offset:18432
    ds_read_b64_tr_b16 v[92:93], v223 offset:16384
    ds_read_b64_tr_b16 v[94:95], v223 offset:18432
    s_waitcnt lgkmcnt(0)
    s_add_u32 m0, s81, 135168
    s_add_u32 s85, s91, 0
    buffer_load_dwordx4 v219, s[40:43], s85 offen lds
    v_mul_f32 v32, 0x3b000000, v32
    v_mul_f32 v33, 0x3b000000, v33
    ds_write_b64 v231, v[40:41]
    v_fma_f32 v33, -v32, v32, v33
    v_max_f32 v33, 0, v33
    v_add_f32 v33, 0x3727c5ac, v33
    s_add_u32 m0, s81, 136192
    s_add_u32 s85, s91, 8192
    buffer_load_dwordx4 v219, s[40:43], s85 offen lds
    v_rsq_f32 v33, v33
    ds_write_b32 v230, v32
    ds_write_b32 v230, v33 offset:576
    s_add_u32 m0, s81, 137216
    s_add_u32 s85, s91, 16384
    buffer_load_dwordx4 v219, s[40:43], s85 offen lds
    s_add_u32 m0, s81, 138240
    s_add_u32 s85, s91, 24576
    buffer_load_dwordx4 v219, s[40:43], s85 offen lds
    s_add_u32 m0, s81, 49152
    s_add_u32 s85, s91, 4294311936
    buffer_load_dwordx4 v219, s[40:43], s85 offen lds
    s_add_u32 m0, s81, 50176
    s_add_u32 s85, s91, 4294320128
    buffer_load_dwordx4 v219, s[40:43], s85 offen lds
    s_add_u32 m0, s81, 51200
    s_add_u32 s85, s91, 4294328320
    buffer_load_dwordx4 v219, s[40:43], s85 offen lds
    s_add_u32 m0, s81, 52224
    s_add_u32 s85, s91, 4294336512
    buffer_load_dwordx4 v219, s[40:43], s85 offen lds
    s_add_u32 m0, s81, 98304
    s_add_u32 s85, s92, 4294311936
    buffer_load_dwordx4 v219, s[40:43], s85 offen lds
    s_waitcnt lgkmcnt(0)
    s_barrier
    s_setprio 0
    s_mov_b32 s67, 4294914048
    v_add_u32 v246, s67, v220
    v_add_u32 v247, s67, v221
    v_add_u32 v248, s67, v222
    v_add_u32 v249, s67, v223
    s_mov_b32 s67, 4294848512
    v_add_u32 v242, s67, v220
    v_add_u32 v243, s67, v221
    v_add_u32 v244, s67, v222
    v_add_u32 v245, s67, v223
    s_add_u32 m0, s81, 99328
    s_add_u32 s85, s92, 4294320128
    buffer_load_dwordx4 v219, s[40:43], s85 offen lds
    s_add_u32 m0, s81, 100352
    s_add_u32 s85, s92, 4294328320
    buffer_load_dwordx4 v219, s[40:43], s85 offen lds
    s_add_u32 m0, s81, 101376
    s_add_u32 s85, s92, 4294336512
    buffer_load_dwordx4 v219, s[40:43], s85 offen lds
    s_waitcnt vmcnt(24)
    ds_read_b64_tr_b16 v[96:97], v220 offset:0
    ds_read_b64_tr_b16 v[98:99], v220 offset:2048
    ds_read_b64_tr_b16 v[100:101], v221 offset:0
    ds_read_b64_tr_b16 v[102:103], v221 offset:2048
    ds_read_b64_tr_b16 v[104:105], v222 offset:0
    ds_read_b64_tr_b16 v[106:107], v222 offset:2048
    ds_read_b64_tr_b16 v[108:109], v223 offset:0
    ds_read_b64_tr_b16 v[110:111], v223 offset:2048
    s_waitcnt lgkmcnt(0)
    s_add_u32 m0, s81, 118784
    s_add_u32 s85, s92, 0
    buffer_load_dwordx4 v219, s[40:43], s85 offen lds
    s_add_u32 m0, s81, 119808
    s_add_u32 s85, s92, 8192
    buffer_load_dwordx4 v219, s[40:43], s85 offen lds
    s_add_u32 m0, s81, 120832
    s_add_u32 s85, s92, 16384
    buffer_load_dwordx4 v219, s[40:43], s85 offen lds
    s_add_u32 m0, s81, 121856
    s_add_u32 s85, s92, 24576
    buffer_load_dwordx4 v219, s[40:43], s85 offen lds
    s_waitcnt vmcnt(12)
    ds_read_b64_tr_b16 v[112:113], v220 offset:16384
    ds_read_b64_tr_b16 v[114:115], v220 offset:18432
    ds_read_b64_tr_b16 v[116:117], v221 offset:16384
    ds_read_b64_tr_b16 v[118:119], v221 offset:18432
    ds_read_b64_tr_b16 v[120:121], v222 offset:16384
    ds_read_b64_tr_b16 v[122:123], v222 offset:18432
    ds_read_b64_tr_b16 v[124:125], v223 offset:16384
    ds_read_b64_tr_b16 v[126:127], v223 offset:18432
    s_waitcnt vmcnt(4) lgkmcnt(0)
    s_barrier
    s_waitcnt vmcnt(0)
    ds_read_b64_tr_b16 v[128:129], v220 offset:0
    ds_read_b64_tr_b16 v[130:131], v220 offset:2048
    ds_read_b64_tr_b16 v[132:133], v221 offset:0
    ds_read_b64_tr_b16 v[134:135], v221 offset:2048
    ds_read_b64_tr_b16 v[136:137], v222 offset:0
    ds_read_b64_tr_b16 v[138:139], v222 offset:2048
    ds_read_b64_tr_b16 v[140:141], v223 offset:0
    ds_read_b64_tr_b16 v[142:143], v223 offset:2048
    s_add_u32 s76, s81, 32768
    s_add_u32 s77, s81, 65536
    s_add_u32 s78, s81, 118784
    s_add_u32 s79, s81, 135168
    v_mov_b32 v253, v233
    v_mov_b32 v252, v219
    s_waitcnt lgkmcnt(0)
    s_barrier
L_P2D:
    s_add_u32 m0, s76, 0
    s_add_u32 s85, s93, 0
    buffer_load_dwordx4 v252, s[40:43], s85 offen lds
    s_add_u32 m0, s76, 1024
    s_add_u32 s85, s93, 8192
    buffer_load_dwordx4 v252, s[40:43], s85 offen lds
    s_add_u32 m0, s76, 2048
    s_add_u32 s85, s93, 16384
    buffer_load_dwordx4 v252, s[40:43], s85 offen lds
    s_add_u32 m0, s76, 3072
    s_add_u32 s85, s93, 24576
    buffer_load_dwordx4 v252, s[40:43], s85 offen lds
    s_add_u32 m0, s77, 0
    s_add_u32 s85, s94, 0
    buffer_load_dwordx4 v252, s[40:43], s85 offen lds
    s_add_u32 m0, s77, 1024
    s_add_u32 s85, s94, 8192
    buffer_load_dwordx4 v252, s[40:43], s85 offen lds
    s_add_u32 m0, s77, 2048
    s_add_u32 s85, s94, 16384
    buffer_load_dwordx4 v252, s[40:43], s85 offen lds
    s_add_u32 m0, s77, 3072
    s_add_u32 s85, s94, 24576
    buffer_load_dwordx4 v252, s[40:43], s85 offen lds
    s_add_u32 m0, s78, 0
    s_add_u32 s85, s95, 0
    buffer_load_dwordx4 v252, s[44:47], s85 offen lds
    s_add_u32 m0, s78, 1024
    s_add_u32 s85, s95, 8192
    buffer_load_dwordx4 v252, s[44:47], s85 offen lds
    s_add_u32 m0, s78, 2048
    s_add_u32 s85, s95, 16384
    buffer_load_dwordx4 v252, s[44:47], s85 offen lds
    s_add_u32 m0, s78, 3072
    s_add_u32 s85, s95, 24576
    buffer_load_dwordx4 v252, s[44:47], s85 offen lds
    buffer_load_dwordx2 v[0:1], off, s[48:51], s100 offset:1024 sc1
    s_mul_i32 s75, s64, 368640
    s_lshr_b32 s88, s88, 15
    s_mul_i32 s88, s88, 5120
    s_add_u32 s88, s88, s75
    s_lshr_b32 s89, s89, 15
    s_mul_i32 s89, s89, 5120
    s_add_u32 s89, s89, s75
    s_lshr_b32 s90, s90, 15
    s_mul_i32 s90, s90, 5120
    s_add_u32 s90, s90, s75
    s_lshr_b32 s91, s91, 15
    s_mul_i32 s91, s91, 5120
    s_add_u32 s91, s91, s75
    s_lshr_b32 s92, s92, 15
    s_mul_i32 s92, s92, 5120
    s_add_u32 s92, s92, s75
    s_lshr_b32 s71, s93, 15
    s_mul_i32 s71, s71, 5120
    s_add_u32 s71, s71, s75
    s_lshr_b32 s72, s94, 15
    s_mul_i32 s72, s72, 5120
    s_add_u32 s72, s72, s75
    s_lshr_b32 s73, s95, 15
    s_mul_i32 s73, s73, 5120
    s_add_u32 s73, s73, s75
    s_add_u32 s73, s73, 286720
    s_lshr_b32 s74, s96, 15
    s_mul_i32 s74, s74, 5120
    s_add_u32 s74, s74, s75
    s_add_u32 s74, s74, 286720
    s_mov_b32 s67, 0
    v_lshrrev_b32 v192, 2, v253
    v_and_b32 v193, 3, v253
    v_lshlrev_b32 v194, 7, v192
    v_lshl_add_u32 v194, v193, 3, v194
    v_add_u32 v194, s67, v194
    v_bfe_u32 v192, v192, 1, 2
    v_xor_b32 v193, 0, v192
    v_lshl_add_u32 v204, v193, 5, v194
    v_xor_b32 v193, 1, v192
    v_lshl_add_u32 v205, v193, 5, v194
    v_xor_b32 v193, 2, v192
    v_lshl_add_u32 v206, v193, 5, v194
    v_xor_b32 v193, 3, v192
    v_lshl_add_u32 v207, v193, 5, v194
    v_lshrrev_b32 v208, 3, v253
    v_and_b32 v209, 7, v253
    v_lshlrev_b32 v209, 4, v209
    v_add_u32 v210, 0, v208
    v_mul_u32_u24 v211, 37, v210
    v_lshrrev_b32 v211, 8, v211
    v_add_u32 v210, v210, v211
    v_and_b32 v211, 7, v210
    v_cmp_lt_u32 vcc, 2, v211
    s_nop 1
    v_addc_co_u32 v210, vcc, 0, v210, vcc
    v_lshl_add_u32 v248, v210, 7, v209
    v_add_u32 v210, 8, v208
    v_mul_u32_u24 v211, 37, v210
    v_lshrrev_b32 v211, 8, v211
    v_add_u32 v210, v210, v211
    v_and_b32 v211, 7, v210
    v_cmp_lt_u32 vcc, 2, v211
    s_nop 1
    v_addc_co_u32 v210, vcc, 0, v210, vcc
    v_lshl_add_u32 v249, v210, 7, v209
    v_add_u32 v210, 16, v208
    v_mul_u32_u24 v211, 37, v210
    v_lshrrev_b32 v211, 8, v211
    v_add_u32 v210, v210, v211
    v_and_b32 v211, 7, v210
    v_cmp_lt_u32 vcc, 2, v211
    s_nop 1
    v_addc_co_u32 v210, vcc, 0, v210, vcc
    v_lshl_add_u32 v250, v210, 7, v209
    v_add_u32 v210, 24, v208
    v_mul_u32_u24 v211, 37, v210
    v_lshrrev_b32 v211, 8, v211
    v_add_u32 v210, v210, v211
    v_and_b32 v211, 7, v210
    v_cmp_lt_u32 vcc, 2, v211
    s_nop 1
    v_addc_co_u32 v210, vcc, 0, v210, vcc
    v_lshl_add_u32 v251, v210, 7, v209
    v_and_b32 v254, 15, v253
    v_lshrrev_b32 v255, 4, v253
    v_lshlrev_b32 v254, 8, v254
    v_and_b32 v253, 7, v253
    v_xor_b32 v255, v255, v253
    v_lshl_add_u32 v254, v255, 4, v254
    s_waitcnt vmcnt(0)
    v_and_b32 v0, v0, v1
    s_nop 0
    v_readfirstlane_b32 s70, v0
    s_cmp_eq_u32 s70, 1
    s_cbranch_scc1 L_pollBD_ok
    s_mov_b32 s98, 0
L_pollBD:
    s_sleep 1
    buffer_load_dwordx2 v[0:1], off, s[48:51], s100 offset:1024 sc1
    s_waitcnt vmcnt(0)
    v_and_b32 v0, v0, v1
    s_nop 0
    v_readfirstlane_b32 s70, v0
    s_cmp_eq_u32 s70, 1
    s_cbranch_scc1 L_pollBD_ok
    s_add_u32 s98, s98, 1
    s_cmp_lt_u32 s98, 0x40000
    s_cbranch_scc1 L_pollBD
L_pollBD_ok:
    buffer_load_dwordx4 v[208:211], v248, s[48:51], s88 offen sc1
    buffer_load_dwordx4 v[212:215], v248, s[48:51], s89 offen sc1
    buffer_load_dwordx4 v[216:219], v249, s[48:51], s88 offen sc1
    buffer_load_dwordx4 v[220:223], v249, s[48:51], s89 offen sc1
    buffer_load_dwordx4 v[224:227], v250, s[48:51], s88 offen sc1
    buffer_load_dwordx4 v[228:231], v250, s[48:51], s89 offen sc1
    buffer_load_dwordx4 v[232:235], v251, s[48:51], s88 offen sc1
    buffer_load_dwordx4 v[236:239], v251, s[48:51], s89 offen sc1
    buffer_load_dwordx4 v[240:243], v248, s[48:51], s90 offen sc1
    buffer_load_dwordx4 v[244:247], v248, s[48:51], s91 offen sc1
    s_waitcnt vmcnt(8)
    v_mfma_f32_16x16x32_bf16 v[0:3], v[64:67], v[208:211], 0
    v_add_u32 v200, s76, v204
    v_add_u32 v201, s76, v205
    v_mfma_f32_16x16x32_bf16 v[0:3], v[80:83], v[212:215], v[0:3]
    v_add_u32 v202, s76, v206
    v_add_u32 v203, s76, v207
    v_mfma_f32_16x16x32_bf16 v[16:19], v[68:71], v[208:211], 0
    ds_read_b64_tr_b16 v[144:145], v200 offset:0
    ds_read_b64_tr_b16 v[146:147], v200 offset:2048
    v_mfma_f32_16x16x32_bf16 v[16:19], v[84:87], v[212:215], v[16:19]
    ds_read_b64_tr_b16 v[148:149], v201 offset:0
    ds_read_b64_tr_b16 v[150:151], v201 offset:2048
    v_mfma_f32_16x16x32_bf16 v[32:35], v[72:75], v[208:211], 0
    ds_read_b64_tr_b16 v[152:153], v202 offset:0
    ds_read_b64_tr_b16 v[154:155], v202 offset:2048
    v_mfma_f32_16x16x32_bf16 v[32:35], v[88:91], v[212:215], v[32:35]
    ds_read_b64_tr_b16 v[156:157], v203 offset:0
    ds_read_b64_tr_b16 v[158:159], v203 offset:2048
    v_mfma_f32_16x16x32_bf16 v[48:51], v[76:79], v[208:211], 0
    v_mfma_f32_16x16x32_bf16 v[48:51], v[92:95], v[212:215], v[48:51]
    buffer_load_dwordx4 v[208:211], v249, s[48:51], s90 offen sc1
    buffer_load_dwordx4 v[212:215], v249, s[48:51], s91 offen sc1
    s_add_u32 m0, s79, 0
    s_add_u32 s85, s96, 0
    buffer_load_dwordx4 v252, s[44:47], s85 offen lds
    s_add_u32 m0, s79, 1024
    s_add_u32 s85, s96, 8192
    buffer_load_dwordx4 v252, s[44:47], s85 offen lds
    s_waitcnt vmcnt(10)
    v_mfma_f32_16x16x32_bf16 v[4:7], v[64:67], v[216:219], 0
    v_add_u32 v200, s77, v204
    v_add_u32 v201, s77, v205
    v_mfma_f32_16x16x32_bf16 v[4:7], v[80:83], v[220:223], v[4:7]
    v_add_u32 v202, s77, v206
    v_add_u32 v203, s77, v207
    v_mfma_f32_16x16x32_bf16 v[20:23], v[68:71], v[216:219], 0
    ds_read_b64_tr_b16 v[160:161], v200 offset:0
    ds_read_b64_tr_b16 v[162:163], v200 offset:2048
    v_mfma_f32_16x16x32_bf16 v[20:23], v[84:87], v[220:223], v[20:23]
    ds_read_b64_tr_b16 v[164:165], v201 offset:0
    ds_read_b64_tr_b16 v[166:167], v201 offset:2048
    v_mfma_f32_16x16x32_bf16 v[36:39], v[72:75], v[216:219], 0
    ds_read_b64_tr_b16 v[168:169], v202 offset:0
    ds_read_b64_tr_b16 v[170:171], v202 offset:2048
    v_mfma_f32_16x16x32_bf16 v[36:39], v[88:91], v[220:223], v[36:39]
    ds_read_b64_tr_b16 v[172:173], v203 offset:0
    ds_read_b64_tr_b16 v[174:175], v203 offset:2048
    v_mfma_f32_16x16x32_bf16 v[52:55], v[76:79], v[216:219], 0
    v_mfma_f32_16x16x32_bf16 v[52:55], v[92:95], v[220:223], v[52:55]
    buffer_load_dwordx4 v[216:219], v250, s[48:51], s90 offen sc1
    buffer_load_dwordx4 v[220:223], v250, s[48:51], s91 offen sc1
    s_add_u32 m0, s79, 2048
    s_add_u32 s85, s96, 16384
    buffer_load_dwordx4 v252, s[44:47], s85 offen lds
    s_add_u32 m0, s79, 3072
    s_add_u32 s85, s96, 24576
    buffer_load_dwordx4 v252, s[44:47], s85 offen lds
    s_waitcnt vmcnt(12)
    v_mfma_f32_16x16x32_bf16 v[8:11], v[64:67], v[224:227], 0
    v_add_u32 v200, s78, v204
    v_add_u32 v201, s78, v205
    v_mfma_f32_16x16x32_bf16 v[8:11], v[80:83], v[228:231], v[8:11]
    v_add_u32 v202, s78, v206
    v_add_u32 v203, s78, v207
    v_mfma_f32_16x16x32_bf16 v[24:27], v[68:71], v[224:227], 0
    ds_read_b64_tr_b16 v[176:177], v200 offset:0
    ds_read_b64_tr_b16 v[178:179], v200 offset:2048
    v_mfma_f32_16x16x32_bf16 v[24:27], v[84:87], v[228:231], v[24:27]
    ds_read_b64_tr_b16 v[180:181], v201 offset:0
    ds_read_b64_tr_b16 v[182:183], v201 offset:2048
    v_mfma_f32_16x16x32_bf16 v[40:43], v[72:75], v[224:227], 0
    ds_read_b64_tr_b16 v[184:185], v202 offset:0
    ds_read_b64_tr_b16 v[186:187], v202 offset:2048
    v_mfma_f32_16x16x32_bf16 v[40:43], v[88:91], v[228:231], v[40:43]
    ds_read_b64_tr_b16 v[188:189], v203 offset:0
    ds_read_b64_tr_b16 v[190:191], v203 offset:2048
    v_mfma_f32_16x16x32_bf16 v[56:59], v[76:79], v[224:227], 0
    v_mfma_f32_16x16x32_bf16 v[56:59], v[92:95], v[228:231], v[56:59]
    buffer_load_dwordx4 v[224:227], v251, s[48:51], s90 offen sc1
    buffer_load_dwordx4 v[228:231], v251, s[48:51], s91 offen sc1
    s_waitcnt vmcnt(12)
    v_mfma_f32_16x16x32_bf16 v[12:15], v[64:67], v[232:235], 0
    v_mfma_f32_16x16x32_bf16 v[12:15], v[80:83], v[236:239], v[12:15]
    v_mfma_f32_16x16x32_bf16 v[28:31], v[68:71], v[232:235], 0
    v_mfma_f32_16x16x32_bf16 v[28:31], v[84:87], v[236:239], v[28:31]
    v_mfma_f32_16x16x32_bf16 v[44:47], v[72:75], v[232:235], 0
    v_mfma_f32_16x16x32_bf16 v[44:47], v[88:91], v[236:239], v[44:47]
    v_mfma_f32_16x16x32_bf16 v[60:63], v[76:79], v[232:235], 0
    v_mfma_f32_16x16x32_bf16 v[60:63], v[92:95], v[236:239], v[60:63]
    buffer_load_dwordx4 v[232:235], v248, s[48:51], s92 offen sc1
    buffer_load_dwordx4 v[236:239], v249, s[48:51], s92 offen sc1
    s_waitcnt vmcnt(12)
    v_mfma_f32_16x16x32_bf16 v[0:3], v[96:99], v[240:243], v[0:3]
    v_mfma_f32_16x16x32_bf16 v[0:3], v[112:115], v[244:247], v[0:3]
    v_mfma_f32_16x16x32_bf16 v[16:19], v[100:103], v[240:243], v[16:19]
    v_mfma_f32_16x16x32_bf16 v[16:19], v[116:119], v[244:247], v[16:19]
    v_mfma_f32_16x16x32_bf16 v[32:35], v[104:107], v[240:243], v[32:35]
    v_mfma_f32_16x16x32_bf16 v[32:35], v[120:123], v[244:247], v[32:35]
    v_mfma_f32_16x16x32_bf16 v[48:51], v[108:111], v[240:243], v[48:51]
    v_mfma_f32_16x16x32_bf16 v[48:51], v[124:127], v[244:247], v[48:51]
    buffer_load_dwordx4 v[240:243], v250, s[48:51], s92 offen sc1
    buffer_load_dwordx4 v[244:247], v251, s[48:51], s92 offen sc1
    s_waitcnt vmcnt(12)
    buffer_load_dword v253, off, s[48:51], s100 offset:0 sc1
    buffer_load_dword v255, off, s[48:51], s100 offset:4 sc1
    v_mfma_f32_16x16x32_bf16 v[4:7], v[96:99], v[208:211], v[4:7]
    v_mfma_f32_16x16x32_bf16 v[4:7], v[112:115], v[212:215], v[4:7]
    v_mfma_f32_16x16x32_bf16 v[20:23], v[100:103], v[208:211], v[20:23]
    v_mfma_f32_16x16x32_bf16 v[20:23], v[116:119], v[212:215], v[20:23]
    v_mfma_f32_16x16x32_bf16 v[36:39], v[104:107], v[208:211], v[36:39]
    v_mfma_f32_16x16x32_bf16 v[36:39], v[120:123], v[212:215], v[36:39]
    v_mfma_f32_16x16x32_bf16 v[52:55], v[108:111], v[208:211], v[52:55]
    v_mfma_f32_16x16x32_bf16 v[52:55], v[124:127], v[212:215], v[52:55]
    s_waitcnt vmcnt(10)
    v_mfma_f32_16x16x32_bf16 v[8:11], v[96:99], v[216:219], v[8:11]
    v_mfma_f32_16x16x32_bf16 v[8:11], v[112:115], v[220:223], v[8:11]
    v_mfma_f32_16x16x32_bf16 v[24:27], v[100:103], v[216:219], v[24:27]
    v_mfma_f32_16x16x32_bf16 v[24:27], v[116:119], v[220:223], v[24:27]
    v_mfma_f32_16x16x32_bf16 v[40:43], v[104:107], v[216:219], v[40:43]
    v_mfma_f32_16x16x32_bf16 v[40:43], v[120:123], v[220:223], v[40:43]
    v_mfma_f32_16x16x32_bf16 v[56:59], v[108:111], v[216:219], v[56:59]
    v_mfma_f32_16x16x32_bf16 v[56:59], v[124:127], v[220:223], v[56:59]
    s_waitcnt vmcnt(6)
    v_mfma_f32_16x16x32_bf16 v[12:15], v[96:99], v[224:227], v[12:15]
    v_add_u32 v200, s79, v204
    v_add_u32 v201, s79, v205
    v_mfma_f32_16x16x32_bf16 v[12:15], v[112:115], v[228:231], v[12:15]
    v_add_u32 v202, s79, v206
    v_add_u32 v203, s79, v207
    v_mfma_f32_16x16x32_bf16 v[28:31], v[100:103], v[224:227], v[28:31]
    ds_read_b64_tr_b16 v[192:193], v200 offset:0
    ds_read_b64_tr_b16 v[194:195], v200 offset:2048
    v_mfma_f32_16x16x32_bf16 v[28:31], v[116:119], v[228:231], v[28:31]
    ds_read_b64_tr_b16 v[196:197], v201 offset:0
    ds_read_b64_tr_b16 v[198:199], v201 offset:2048
    v_mfma_f32_16x16x32_bf16 v[44:47], v[104:107], v[224:227], v[44:47]
    ds_read_b64_tr_b16 v[204:205], v203 offset:0
    ds_read_b64_tr_b16 v[206:207], v203 offset:2048
    v_mfma_f32_16x16x32_bf16 v[44:47], v[120:123], v[228:231], v[44:47]
    ds_read_b64_tr_b16 v[200:201], v202 offset:0
    ds_read_b64_tr_b16 v[202:203], v202 offset:2048
    v_mfma_f32_16x16x32_bf16 v[60:63], v[108:111], v[224:227], v[60:63]
    v_mfma_f32_16x16x32_bf16 v[60:63], v[124:127], v[228:231], v[60:63]
    s_waitcnt vmcnt(0)
    v_and_b32 v253, v253, v255
    s_nop 0
    v_readfirstlane_b32 s70, v253
    s_cmp_eq_u32 s70, 1
    s_cbranch_scc1 L_pollAD_ok
    s_mov_b32 s98, 0
L_pollAD:
    s_sleep 1
    buffer_load_dword v253, off, s[48:51], s100 offset:0 sc1
    buffer_load_dword v255, off, s[48:51], s100 offset:4 sc1
    s_waitcnt vmcnt(0)
    v_and_b32 v253, v253, v255
    s_nop 0
    v_readfirstlane_b32 s70, v253
    s_cmp_eq_u32 s70, 1
    s_cbranch_scc1 L_pollAD_ok
    s_add_u32 s98, s98, 1
    s_cmp_lt_u32 s98, 0x40000
    s_cbranch_scc1 L_pollAD
L_pollAD_ok:
    buffer_load_dwordx4 v[208:211], v248, s[48:51], s71 offen sc1
    buffer_load_dwordx4 v[212:215], v248, s[48:51], s72 offen sc1
    buffer_load_dwordx4 v[216:219], v249, s[48:51], s71 offen sc1
    buffer_load_dwordx4 v[220:223], v249, s[48:51], s72 offen sc1
    buffer_load_dwordx4 v[224:227], v248, s[48:51], s73 offen sc1
    buffer_load_dwordx4 v[228:231], v248, s[48:51], s74 offen sc1
    s_waitcnt vmcnt(11)
    v_mfma_f32_16x16x32_bf16 v[0:3], v[128:131], v[232:235], v[0:3]
    v_mfma_f32_16x16x32_bf16 v[16:19], v[132:135], v[232:235], v[16:19]
    v_mfma_f32_16x16x32_bf16 v[32:35], v[136:139], v[232:235], v[32:35]
    v_mfma_f32_16x16x32_bf16 v[48:51], v[140:143], v[232:235], v[48:51]
    buffer_load_dwordx4 v[232:235], v249, s[48:51], s73 offen sc1
    s_waitcnt vmcnt(11)
    v_mfma_f32_16x16x32_bf16 v[4:7], v[128:131], v[236:239], v[4:7]
    v_mfma_f32_16x16x32_bf16 v[20:23], v[132:135], v[236:239], v[20:23]
    v_mfma_f32_16x16x32_bf16 v[36:39], v[136:139], v[236:239], v[36:39]
    v_mfma_f32_16x16x32_bf16 v[52:55], v[140:143], v[236:239], v[52:55]
    buffer_load_dwordx4 v[236:239], v249, s[48:51], s74 offen sc1
    s_waitcnt vmcnt(11)
    v_mfma_f32_16x16x32_bf16 v[8:11], v[128:131], v[240:243], v[8:11]
    v_mfma_f32_16x16x32_bf16 v[24:27], v[132:135], v[240:243], v[24:27]
    v_mfma_f32_16x16x32_bf16 v[40:43], v[136:139], v[240:243], v[40:43]
    v_mfma_f32_16x16x32_bf16 v[56:59], v[140:143], v[240:243], v[56:59]
    buffer_load_dwordx4 v[240:243], v250, s[48:51], s71 offen sc1
    s_waitcnt vmcnt(11)
    v_mfma_f32_16x16x32_bf16 v[12:15], v[128:131], v[244:247], v[12:15]
    v_mfma_f32_16x16x32_bf16 v[28:31], v[132:135], v[244:247], v[28:31]
    v_mfma_f32_16x16x32_bf16 v[44:47], v[136:139], v[244:247], v[44:47]
    v_mfma_f32_16x16x32_bf16 v[60:63], v[140:143], v[244:247], v[60:63]
    buffer_load_dwordx4 v[244:247], v250, s[48:51], s72 offen sc1
    s_waitcnt vmcnt(8)
    s_waitcnt lgkmcnt(0)
    v_mfma_f32_16x16x32_bf16 v[0:3], v[144:147], v[208:211], v[0:3]
    v_mfma_f32_16x16x32_bf16 v[0:3], v[160:163], v[212:215], v[0:3]
    v_mfma_f32_16x16x32_bf16 v[16:19], v[148:151], v[208:211], v[16:19]
    v_mfma_f32_16x16x32_bf16 v[16:19], v[164:167], v[212:215], v[16:19]
    v_mfma_f32_16x16x32_bf16 v[32:35], v[152:155], v[208:211], v[32:35]
    v_mfma_f32_16x16x32_bf16 v[32:35], v[168:171], v[212:215], v[32:35]
    v_mfma_f32_16x16x32_bf16 v[48:51], v[156:159], v[208:211], v[48:51]
    v_mfma_f32_16x16x32_bf16 v[48:51], v[172:175], v[212:215], v[48:51]
    buffer_load_dwordx4 v[208:211], v251, s[48:51], s71 offen sc1
    buffer_load_dwordx4 v[212:215], v251, s[48:51], s72 offen sc1
    s_waitcnt vmcnt(8)
    v_mfma_f32_16x16x32_bf16 v[4:7], v[144:147], v[216:219], v[4:7]
    v_mfma_f32_16x16x32_bf16 v[4:7], v[160:163], v[220:223], v[4:7]
    v_mfma_f32_16x16x32_bf16 v[20:23], v[148:151], v[216:219], v[20:23]
    v_mfma_f32_16x16x32_bf16 v[20:23], v[164:167], v[220:223], v[20:23]
    v_mfma_f32_16x16x32_bf16 v[36:39], v[152:155], v[216:219], v[36:39]
    v_mfma_f32_16x16x32_bf16 v[36:39], v[168:171], v[220:223], v[36:39]
    v_mfma_f32_16x16x32_bf16 v[52:55], v[156:159], v[216:219], v[52:55]
    v_mfma_f32_16x16x32_bf16 v[52:55], v[172:175], v[220:223], v[52:55]
    buffer_load_dwordx4 v[216:219], v250, s[48:51], s73 offen sc1
    buffer_load_dwordx4 v[220:223], v250, s[48:51], s74 offen sc1
    v_mbcnt_lo_u32_b32 v64, -1, 0
    v_mbcnt_hi_u32_b32 v64, -1, v64
    v_and_b32 v66, 7, v64
    v_lshrrev_b32 v71, 3, v64
    s_lshl_b32 s68, s60, 3
    v_add_u32 v72, s68, v71
    v_and_b32 v75, 15, v72
    v_bfe_u32 v74, v72, 4, 1
    v_lshl_add_u32 v73, v75, 1, v74
    v_and_b32 v74, 32, v72
    v_add_u32 v73, v73, v74
    v_lshlrev_b32 v73, 10, v73
    v_lshl_add_u32 v73, v66, 4, v73
    s_lshl_b32 s69, s64, 16
    s_lshl_b32 s68, s65, 7
    s_add_u32 s69, s69, s68
    s_lshr_b32 s67, s60, 1
    s_mov_b32 s88, 0
    s_cmp_eq_u32 s67, 1
    s_cselect_b32 s88, 81920, s88
    s_cmp_eq_u32 s67, 2
    s_cselect_b32 s88, 16384, s88
    s_cmp_eq_u32 s67, 3
    s_cselect_b32 s88, 49152, s88
    s_mov_b32 s89, 32768
    s_cmp_eq_u32 s67, 1
    s_cselect_b32 s89, 65536, s89
    s_cmp_eq_u32 s67, 2
    s_cselect_b32 s89, 118784, s89
    s_cmp_eq_u32 s67, 3
    s_cselect_b32 s89, 135168, s89
    v_lshlrev_b32 v74, 1, v66
    v_xor_b32 v74, v74, v71
    v_lshlrev_b32 v80, 8, v75
    v_lshl_add_u32 v80, v74, 4, v80
    v_add_u32 v81, s88, v80
    v_add_u32 v83, s89, v80
    v_xor_b32 v82, 16, v81
    v_xor_b32 v84, 16, v83
    s_waitcnt vmcnt(8)
    v_mfma_f32_16x16x32_bf16 v[0:3], v[176:179], v[224:227], v[0:3]
    v_mfma_f32_16x16x32_bf16 v[0:3], v[192:195], v[228:231], v[0:3]
    v_mfma_f32_16x16x32_bf16 v[16:19], v[180:183], v[224:227], v[16:19]
    v_mfma_f32_16x16x32_bf16 v[16:19], v[196:199], v[228:231], v[16:19]
    v_mfma_f32_16x16x32_bf16 v[32:35], v[184:187], v[224:227], v[32:35]
    v_mfma_f32_16x16x32_bf16 v[32:35], v[200:203], v[228:231], v[32:35]
    v_mfma_f32_16x16x32_bf16 v[48:51], v[188:191], v[224:227], v[48:51]
    v_mfma_f32_16x16x32_bf16 v[48:51], v[204:207], v[228:231], v[48:51]
    buffer_load_dwordx4 v[224:227], v251, s[48:51], s73 offen sc1
    buffer_load_dwordx4 v[228:231], v251, s[48:51], s74 offen sc1
    s_waitcnt vmcnt(8)
    v_mfma_f32_16x16x32_bf16 v[4:7], v[176:179], v[232:235], v[4:7]
    v_mfma_f32_16x16x32_bf16 v[4:7], v[192:195], v[236:239], v[4:7]
    v_mfma_f32_16x16x32_bf16 v[20:23], v[180:183], v[232:235], v[20:23]
    v_mfma_f32_16x16x32_bf16 v[20:23], v[196:199], v[236:239], v[20:23]
    v_mfma_f32_16x16x32_bf16 v[36:39], v[184:187], v[232:235], v[36:39]
    v_mfma_f32_16x16x32_bf16 v[36:39], v[200:203], v[236:239], v[36:39]
    v_mfma_f32_16x16x32_bf16 v[52:55], v[188:191], v[232:235], v[52:55]
    v_mfma_f32_16x16x32_bf16 v[52:55], v[204:207], v[236:239], v[52:55]
    s_waitcnt vmcnt(6)
    v_mfma_f32_16x16x32_bf16 v[8:11], v[144:147], v[240:243], v[8:11]
    v_mfma_f32_16x16x32_bf16 v[8:11], v[160:163], v[244:247], v[8:11]
    v_mfma_f32_16x16x32_bf16 v[24:27], v[148:151], v[240:243], v[24:27]
    v_mfma_f32_16x16x32_bf16 v[24:27], v[164:167], v[244:247], v[24:27]
    v_mfma_f32_16x16x32_bf16 v[40:43], v[152:155], v[240:243], v[40:43]
    v_mfma_f32_16x16x32_bf16 v[40:43], v[168:171], v[244:247], v[40:43]
    v_mfma_f32_16x16x32_bf16 v[56:59], v[156:159], v[240:243], v[56:59]
    v_mfma_f32_16x16x32_bf16 v[56:59], v[172:175], v[244:247], v[56:59]
    v_add_u32 v253, s76, v254
    v_xor_b32 v255, 64, v253
    ds_write_b128 v253, v[0:3] offset:0
    ds_write_b128 v255, v[16:19] offset:0
    ds_write_b128 v253, v[32:35] offset:128
    ds_write_b128 v255, v[48:51] offset:128
    s_waitcnt vmcnt(4)
    v_mfma_f32_16x16x32_bf16 v[12:15], v[144:147], v[208:211], v[12:15]
    v_mfma_f32_16x16x32_bf16 v[12:15], v[160:163], v[212:215], v[12:15]
    v_mfma_f32_16x16x32_bf16 v[28:31], v[148:151], v[208:211], v[28:31]
    v_mfma_f32_16x16x32_bf16 v[28:31], v[164:167], v[212:215], v[28:31]
    v_mfma_f32_16x16x32_bf16 v[44:47], v[152:155], v[208:211], v[44:47]
    v_mfma_f32_16x16x32_bf16 v[44:47], v[168:171], v[212:215], v[44:47]
    v_mfma_f32_16x16x32_bf16 v[60:63], v[156:159], v[208:211], v[60:63]
    v_mfma_f32_16x16x32_bf16 v[60:63], v[172:175], v[212:215], v[60:63]
    v_add_u32 v253, s77, v254
    v_xor_b32 v255, 64, v253
    ds_write_b128 v253, v[4:7] offset:0
    ds_write_b128 v255, v[20:23] offset:0
    ds_write_b128 v253, v[36:39] offset:128
    ds_write_b128 v255, v[52:55] offset:128
    s_waitcnt lgkmcnt(0)
    s_barrier
    s_waitcnt vmcnt(2)
    v_mfma_f32_16x16x32_bf16 v[8:11], v[176:179], v[216:219], v[8:11]
    v_mfma_f32_16x16x32_bf16 v[8:11], v[192:195], v[220:223], v[8:11]
    v_mfma_f32_16x16x32_bf16 v[24:27], v[180:183], v[216:219], v[24:27]
    v_mfma_f32_16x16x32_bf16 v[24:27], v[196:199], v[220:223], v[24:27]
    v_mfma_f32_16x16x32_bf16 v[40:43], v[184:187], v[216:219], v[40:43]
    v_mfma_f32_16x16x32_bf16 v[40:43], v[200:203], v[220:223], v[40:43]
    v_mfma_f32_16x16x32_bf16 v[56:59], v[188:191], v[216:219], v[56:59]
    v_mfma_f32_16x16x32_bf16 v[56:59], v[204:207], v[220:223], v[56:59]
    s_waitcnt vmcnt(0)
    v_mfma_f32_16x16x32_bf16 v[12:15], v[176:179], v[224:227], v[12:15]
    v_mfma_f32_16x16x32_bf16 v[12:15], v[192:195], v[228:231], v[12:15]
    v_mfma_f32_16x16x32_bf16 v[28:31], v[180:183], v[224:227], v[28:31]
    v_mfma_f32_16x16x32_bf16 v[28:31], v[196:199], v[228:231], v[28:31]
    v_mfma_f32_16x16x32_bf16 v[44:47], v[184:187], v[224:227], v[44:47]
    v_mfma_f32_16x16x32_bf16 v[44:47], v[200:203], v[228:231], v[44:47]
    v_mfma_f32_16x16x32_bf16 v[60:63], v[188:191], v[224:227], v[60:63]
    v_mfma_f32_16x16x32_bf16 v[60:63], v[204:207], v[228:231], v[60:63]
    s_branch L_P2T
L_C:
    s_mov_b32 s26, 2097152
    s_mov_b32 s27, 0x20000
    s_load_dwordx2 s[44:45], s[0:1], 16
    s_load_dwordx2 s[40:41], s[0:1], 48
    s_load_dwordx2 s[52:53], s[0:1], 56
    s_load_dwordx2 s[56:57], s[0:1], 64
    s_load_dwordx2 s[48:49], s[0:1], 72
    s_and_b32 s67, s2, 7
    s_lshr_b32 s68, s2, 3
    s_lshr_b32 s70, s68, 4
    s_lshl_b32 s70, s70, 1
    s_and_b32 s69, s68, 1
    s_add_u32 s69, s69, s70
    s_lshl_b32 s64, s67, 2
    s_add_u32 s64, s64, s69
    s_bfe_u32 s65, s68, 0x30001
    s_add_u32 s83, s81, 118784
    s_and_b32 s84, s63, 1
    s_lshl_b32 s84, s84, 1
    s_lshr_b32 s70, s61, 3
    s_add_u32 s97, s84, s70
    s_lshr_b32 s70, s62, 3
    s_add_u32 s84, s84, s70
    s_mov_b32 s42, 1835008
    s_mov_b32 s43, 0x20000
    s_mov_b32 s46, 524288
    s_mov_b32 s47, 0x20000
    s_mov_b32 s50, 268435456
    s_mov_b32 s51, 0x20000
    s_mov_b32 s54, 2097152
    s_mov_b32 s55, 0x20000
    s_mov_b32 s58, 256
    s_mov_b32 s59, 0x20000
    s_waitcnt lgkmcnt(0)
    s_cmp_lg_u32 s60, 0
    s_cbranch_scc1 L_c_noclr
    v_mov_b32 v248, -1
    v_mov_b32 v249, -1
    v_mov_b32 v250, 0
    v_lshlrev_b32 v251, 2, v0
    v_lshlrev_b32 v252, 3, v0
    s_lshl_b32 s69, s61, 12
    s_lshr_b32 s70, s63, 1
    s_lshl_b32 s70, s70, 10
    s_add_u32 s69, s69, s70
    s_lshl_b32 s70, s84, 8
    s_add_u32 s69, s69, s70
    s_add_u32 s69, s69, 16842752
    s_mov_b32 exec_hi, 0
    buffer_store_dwordx2 v[248:249], v252, s[48:51], s69 offen sc1
    s_mov_b64 exec, -1
    s_add_u32 s69, s97, 1
    s_cmp_eq_u32 s97, 0
    s_cselect_b32 s69, 0, s69
    s_lshl_b32 s69, s69, 8
    s_lshr_b32 s70, s63, 1
    s_mul_i32 s70, s70, 1280
    s_add_u32 s69, s69, s70
    s_lshl_b32 s70, s62, 13
    s_add_u32 s69, s69, s70
    s_add_u32 s69, s69, 16908288
    buffer_store_dword v248, v251, s[48:51], s69 offen sc1
    s_cmp_lg_u32 s97, 0
    s_cbranch_scc1 L_c_clr1
    buffer_store_dword v248, v251, s[48:51], s69 offen offset:256 sc1
L_c_clr1:
    s_lshl_b32 s69, s61, 4
    s_add_u32 s69, s69, s62
    s_lshl_b32 s69, s69, 7
    s_add_u32 s69, s69, 16777216
    s_mov_b64 exec, 15
    buffer_store_dword v250, v251, s[48:51], s69 offen sc1
    s_mov_b64 exec, -1
L_c_noclr:
    s_and_b32 s67, s60, 1
    s_lshl_b32 s67, s67, 1
    s_lshr_b32 s68, s60, 1
    s_lshl_b32 s68, s68, 13
    s_add_u32 s68, s68, 81920
    v_lshrrev_b32 v4, 4, v0
    v_bfe_u32 v5, v0, 2, 2
    v_and_b32 v6, 3, v0
    v_lshl_add_u32 v7, v4, 3, v5
    v_lshlrev_b32 v7, 7, v7
    v_lshl_add_u32 v7, v6, 3, v7
    v_lshrrev_b32 v14, 1, v5
    v_and_b32 v15, 1, v4
    v_lshl_add_u32 v14, v15, 1, v14
    v_xor_b32 v14, s67, v14
    v_lshl_add_u32 v224, v14, 5, v7
    v_xor_b32 v14, 1, v14
    v_lshl_add_u32 v225, v14, 5, v7
    v_add_u32 v226, 40960, v224
    v_add_u32 v227, 40960, v225
    v_and_b32 v5, 15, v0
    v_lshrrev_b32 v6, 1, v5
    v_xor_b32 v6, v6, v4
    v_lshl_add_u32 v7, v5, 7, s68
    v_lshl_add_u32 v228, v6, 4, v7
    v_xor_b32 v6, 4, v6
    v_lshl_add_u32 v229, v6, 4, v7
    v_mov_b32 v230, v0
    s_lshr_b32 s67, s64, 1
    s_lshl_b32 s67, s67, 4
    s_add_u32 s67, s67, s60
    s_lshl_b32 s67, s67, 7
    s_and_b32 s68, s64, 1
    s_lshl_b32 s68, s68, 3
    s_add_u32 s67, s67, s68
    s_add_u32 s100, s67, 16777216
    s_add_u32 s99, s64, s65
    s_mul_i32 s67, s99, 52
    s_lshr_b32 s67, s67, 8
    s_mul_i32 s67, s67, 5
    s_sub_u32 s67, s99, s67
    s_mul_i32 s68, s60, 5
    s_add_u32 s68, s68, 16
    s_lshl_b32 s70, s65, 7
    s_add_u32 s69, s67, 0
    s_cmp_ge_u32 s69, 5
    s_cselect_b32 s88, 5, 0
    s_sub_u32 s69, s69, s88
    s_add_u32 s69, s69, s68
    s_lshl_b32 s69, s69, 15
    s_add_u32 s88, s69, s70
    s_add_u32 s69, s67, 1
    s_cmp_ge_u32 s69, 5
    s_cselect_b32 s89, 5, 0
    s_sub_u32 s69, s69, s89
    s_add_u32 s69, s69, s68
    s_lshl_b32 s69, s69, 15
    s_add_u32 s89, s69, s70
    s_add_u32 s69, s67, 2
    s_cmp_ge_u32 s69, 5
    s_cselect_b32 s90, 5, 0
    s_sub_u32 s69, s69, s90
    s_add_u32 s69, s69, s68
    s_lshl_b32 s69, s69, 15
    s_add_u32 s90, s69, s70
    s_add_u32 s69, s67, 3
    s_cmp_ge_u32 s69, 5
    s_cselect_b32 s91, 5, 0
    s_sub_u32 s69, s69, s91
    s_add_u32 s69, s69, s68
    s_lshl_b32 s69, s69, 15
    s_add_u32 s91, s69, s70
    s_add_u32 s69, s67, 4
    s_cmp_ge_u32 s69, 5
    s_cselect_b32 s92, 5, 0
    s_sub_u32 s69, s69, s92
    s_add_u32 s69, s69, s68
    s_lshl_b32 s69, s69, 15
    s_add_u32 s92, s69, s70
    s_and_b32 s67, s99, 1
    s_lshl_b32 s68, s60, 1
    s_xor_b32 s69, s67, 0
    s_add_u32 s69, s69, s68
    s_lshl_b32 s69, s69, 15
    s_add_u32 s93, s69, s70
    s_mov_b32 s95, s93
    s_xor_b32 s69, s67, 1
    s_add_u32 s69, s69, s68
    s_lshl_b32 s69, s69, 15
    s_add_u32 s94, s69, s70
    s_mov_b32 s96, s94
    v_lshlrev_b32 v8, 2, v4
    v_sub_u32 v8, v5, v8
    v_mov_b32 v9, 0xff800000
    v_mov_b32 v10, 0
    v_subrev_u32 v11, 0, v8
    v_cmp_gt_u32 vcc, 8, v11
    v_add_u32 v11, 8, v11
    s_nop 0
    v_cndmask_b32 v236, v9, v10, vcc
    v_cmp_gt_i32 vcc, 0, v11
    s_nop 1
    v_cndmask_b32 v240, v9, v10, vcc
    v_subrev_u32 v11, 1, v8
    v_cmp_gt_u32 vcc, 8, v11
    v_add_u32 v11, 8, v11
    s_nop 0
    v_cndmask_b32 v237, v9, v10, vcc
    v_cmp_gt_i32 vcc, 0, v11
    s_nop 1
    v_cndmask_b32 v241, v9, v10, vcc
    v_subrev_u32 v11, 2, v8
    v_cmp_gt_u32 vcc, 8, v11
    v_add_u32 v11, 8, v11
    s_nop 0
    v_cndmask_b32 v238, v9, v10, vcc
    v_cmp_gt_i32 vcc, 0, v11
    s_nop 1
    v_cndmask_b32 v242, v9, v10, vcc
    v_subrev_u32 v11, 3, v8
    v_cmp_gt_u32 vcc, 8, v11
    v_add_u32 v11, 8, v11
    s_nop 0
    v_cndmask_b32 v239, v9, v10, vcc
    v_cmp_gt_i32 vcc, 0, v11
    s_nop 1
    v_cndmask_b32 v243, v9, v10, vcc
    s_lshr_b32 s69, s60, 1
    s_or_b32 s69, s61, s69
    s_cmp_eq_u32 s69, 0
    s_cselect_b64 vcc, -1, 0
    v_cndmask_b32 v244, v240, v9, vcc
    v_cndmask_b32 v245, v241, v9, vcc
    v_cndmask_b32 v246, v242, v9, vcc
    v_cndmask_b32 v247, v243, v9, vcc
    s_cmp_lg_u32 s60, 0
    s_cbranch_scc1 L_c_nocnt
    v_mov_b32 v222, 1
    v_mov_b32 v223, 0
    s_and_b32 s69, s2, 1
    s_lshl_b32 s69, s69, 7
    s_mov_b64 exec, 1
    s_waitcnt vmcnt(0)
    buffer_atomic_add v222, v223, s[56:59], s69 offen sc1
    s_mov_b64 exec, -1
L_c_nocnt:
    s_lshl_b32 s67, s61, 4
    s_add_u32 s67, s67, s62
    s_mul_i32 s68, s67, 7168
    s_mul_i32 s69, s60, 2432
    s_add_u32 s68, s68, s69
    s_lshl_b32 s67, s67, 11
    s_cmp_eq_u32 s60, 3
    s_cselect_b32 s67, s67, s68
    s_cselect_b32 s76, s44, s40
    s_cselect_b32 s77, s45, s41
    s_cselect_b32 s78, s46, s42
    s_mov_b32 s79, 0x20000
    s_cselect_b32 s86, 16, 19
    s_bfm_b64 s[86:87], s86, 0
    v_lshl_add_u32 v253, v230, 7, s67
    v_lshrrev_b32 v8, 3, v230
    v_and_b32 v9, 7, v230
    v_lshlrev_b32 v9, 4, v9
    v_add_u32 v10, 0, v8
    v_mul_u32_u24 v11, 37, v10
    v_lshrrev_b32 v11, 8, v11
    v_add_u32 v10, v10, v11
    v_and_b32 v11, 7, v10
    v_cmp_lt_u32 vcc, 2, v11
    s_nop 1
    v_addc_co_u32 v10, vcc, 0, v10, vcc
    v_lshl_add_u32 v248, v10, 7, v9
    v_add_u32 v10, 8, v8
    v_mul_u32_u24 v11, 37, v10
    v_lshrrev_b32 v11, 8, v11
    v_add_u32 v10, v10, v11
    v_and_b32 v11, 7, v10
    v_cmp_lt_u32 vcc, 2, v11
    s_nop 1
    v_addc_co_u32 v10, vcc, 0, v10, vcc
    v_lshl_add_u32 v249, v10, 7, v9
    v_add_u32 v10, 16, v8
    v_mul_u32_u24 v11, 37, v10
    v_lshrrev_b32 v11, 8, v11
    v_add_u32 v10, v10, v11
    v_and_b32 v11, 7, v10
    v_cmp_lt_u32 vcc, 2, v11
    s_nop 1
    v_addc_co_u32 v10, vcc, 0, v10, vcc
    v_lshl_add_u32 v250, v10, 7, v9
    v_add_u32 v10, 24, v8
    v_mul_u32_u24 v11, 37, v10
    v_lshrrev_b32 v11, 8, v11
    v_add_u32 v10, v10, v11
    v_and_b32 v11, 7, v10
    v_cmp_lt_u32 vcc, 2, v11
    s_nop 1
    v_addc_co_u32 v10, vcc, 0, v10, vcc
    v_lshl_add_u32 v251, v10, 7, v9
    s_cmp_ge_u32 s62, 8
    s_cbranch_scc1 L_CB
    v_and_b32 v8, 15, v230
    v_lshrrev_b32 v9, 4, v230
    s_lshr_b32 s67, s60, 1
    s_and_b32 s68, s60, 1
    s_lshl_b32 s69, s67, 8
    s_add_u32 s69, s69, 152832
    v_lshl_add_u32 v231, v8, 2, s69
    v_lshl_add_u32 v232, v9, 4, s69
    s_lshl_b32 s69, s68, 7
    s_add_u32 s69, s69, 151552
    v_lshl_add_u32 v233, v9, 4, s69
    v_lshl_add_u32 v234, v8, 2, s69
    s_lshl_b32 s75, s61, 1
    s_add_u32 s75, s75, s67
    s_mul_i32 s75, s75, 368640
    v_and_b32 v235, 7, v8
    v_lshl_add_u32 v235, v9, 3, v235
    v_lshlrev_b32 v235, 3, v235
    v_and_b32 v252, 1, v9
    v_lshl_add_u32 v252, v252, 4, v8
    v_lshlrev_b32 v252, 3, v252
    s_lshl_b32 s69, s68, 11
    s_add_u32 s69, s69, 153984
    v_add_u32 v235, s69, v235
    v_add_u32 v252, s69, v252
    s_lshl_b32 s69, s62, 1
    s_add_u32 s69, s69, s68
    s_mul_i32 s69, s69, 5120
    s_add_u32 s71, s69, s75
    s_add_u32 s72, s71, 286720
    s_lshl_b32 s73, s67, 12
    v_mov_b32 v0, 0
    v_mov_b32 v1, 0
    v_mov_b32 v2, 0
    v_mov_b32 v3, 0
    v_mov_b32 v4, 0
    v_mov_b32 v5, 0
    v_mov_b32 v6, 0
    v_mov_b32 v7, 0
    v_mov_b32 v8, 0
    v_mov_b32 v9, 0
    v_mov_b32 v10, 0
    v_mov_b32 v11, 0
    v_mov_b32 v12, 0
    v_mov_b32 v13, 0
    v_mov_b32 v14, 0
    v_mov_b32 v15, 0
    v_mov_b32 v16, 0
    v_mov_b32 v17, 0
    v_mov_b32 v18, 0
    v_mov_b32 v19, 0
    v_mov_b32 v20, 0
    v_mov_b32 v21, 0
    v_mov_b32 v22, 0
    v_mov_b32 v23, 0
    v_mov_b32 v24, 0
    v_mov_b32 v25, 0
    v_mov_b32 v26, 0
    v_mov_b32 v27, 0
    v_mov_b32 v28, 0
    v_mov_b32 v29, 0
    v_mov_b32 v30, 0
    v_mov_b32 v31, 0
    v_mov_b32 v32, 0
    v_mov_b32 v33, 0
    v_mov_b32 v34, 0
    v_mov_b32 v35, 0
    v_mov_b32 v36, 0
    v_mov_b32 v37, 0
    v_mov_b32 v38, 0
    v_mov_b32 v39, 0
    v_mov_b32 v40, 0
    v_mov_b32 v41, 0
    v_mov_b32 v42, 0
    v_mov_b32 v43, 0
    v_mov_b32 v44, 0
    v_mov_b32 v45, 0
    v_mov_b32 v46, 0
    v_mov_b32 v47, 0
    v_mov_b32 v48, 0
    v_mov_b32 v49, 0
    v_mov_b32 v50, 0
    v_mov_b32 v51, 0
    v_mov_b32 v52, 0
    v_mov_b32 v53, 0
    v_mov_b32 v54, 0
    v_mov_b32 v55, 0
    v_mov_b32 v56, 0
    v_mov_b32 v57, 0
    v_mov_b32 v58, 0
    v_mov_b32 v59, 0
    v_mov_b32 v60, 0
    v_mov_b32 v61, 0
    v_mov_b32 v62, 0
    v_mov_b32 v63, 0
    v_mov_b32 v64, 0
    v_mov_b32 v65, 0
    v_mov_b32 v66, 0
    v_mov_b32 v67, 0
    v_mov_b32 v68, 0
    v_mov_b32 v69, 0
    v_mov_b32 v70, 0
    v_mov_b32 v71, 0
    v_mov_b32 v72, 0
    v_mov_b32 v73, 0
    v_mov_b32 v74, 0
    v_mov_b32 v75, 0
    v_mov_b32 v76, 0
    v_mov_b32 v77, 0
    v_mov_b32 v78, 0
    v_mov_b32 v79, 0
    v_mov_b32 v80, 0
    v_mov_b32 v81, 0
    v_mov_b32 v82, 0
    v_mov_b32 v83, 0
    v_mov_b32 v84, 0
    v_mov_b32 v85, 0
    v_mov_b32 v86, 0
    v_mov_b32 v87, 0
    v_mov_b32 v88, 0
    v_mov_b32 v89, 0
    v_mov_b32 v90, 0
    v_mov_b32 v91, 0
    v_mov_b32 v92, 0
    v_mov_b32 v93, 0
    v_mov_b32 v94, 0
    v_mov_b32 v95, 0
    v_mov_b32 v96, 0
    v_mov_b32 v97, 0
    v_mov_b32 v98, 0
    v_mov_b32 v99, 0
    v_mov_b32 v100, 0
    v_mov_b32 v101, 0
    v_mov_b32 v102, 0
    v_mov_b32 v103, 0
    v_mov_b32 v104, 0
    v_mov_b32 v105, 0
    v_mov_b32 v106, 0
    v_mov_b32 v107, 0
    v_mov_b32 v108, 0
    v_mov_b32 v109, 0
    v_mov_b32 v110, 0
    v_mov_b32 v111, 0
    v_mov_b32 v112, 0
    v_mov_b32 v113, 0
    v_mov_b32 v114, 0
    v_mov_b32 v115, 0
    v_mov_b32 v116, 0
    v_mov_b32 v117, 0
    v_mov_b32 v118, 0
    v_mov_b32 v119, 0
    v_mov_b32 v120, 0
    v_mov_b32 v121, 0
    v_mov_b32 v122, 0
    v_mov_b32 v123, 0
    v_mov_b32 v124, 0
    v_mov_b32 v125, 0
    v_mov_b32 v126, 0
    v_mov_b32 v127, 0
    v_mov_b32 v128, 0
    v_mov_b32 v129, 0
    v_mov_b32 v130, 0
    v_mov_b32 v131, 0
    v_mov_b32 v132, 0
    v_mov_b32 v133, 0
    v_mov_b32 v134, 0
    v_mov_b32 v135, 0
    v_mov_b32 v136, 0
    v_mov_b32 v137, 0
    v_mov_b32 v138, 0
    v_mov_b32 v139, 0
    v_mov_b32 v140, 0
    v_mov_b32 v141, 0
    v_mov_b32 v142, 0
    v_mov_b32 v143, 0
    v_mov_b32 v144, 0
    v_mov_b32 v145, 0
    v_mov_b32 v146, 0
    v_mov_b32 v147, 0
    v_mov_b32 v148, 0
    v_mov_b32 v149, 0
    v_mov_b32 v150, 0
    v_mov_b32 v151, 0
    v_mov_b32 v152, 0
    v_mov_b32 v153, 0
    v_mov_b32 v154, 0
    v_mov_b32 v155, 0
    v_mov_b32 v156, 0
    v_mov_b32 v157, 0
    v_mov_b32 v158, 0
    v_mov_b32 v159, 0
    s_barrier
    ds_read_b64_tr_b16 v[192:193], v224 offset:0
    ds_read_b64_tr_b16 v[194:195], v224 offset:512
    ds_read_b64_tr_b16 v[196:197], v224 offset:4096
    ds_read_b64_tr_b16 v[198:199], v224 offset:4608
    ds_read_b128 v[160:163], v228 offset:0
    ds_read_b128 v[164:167], v229 offset:0
    ds_read_b64_tr_b16 v[200:201], v225 offset:0
    ds_read_b64_tr_b16 v[202:203], v225 offset:512
    ds_read_b64_tr_b16 v[204:205], v225 offset:4096
    ds_read_b64_tr_b16 v[206:207], v225 offset:4608
    ds_read_b128 v[168:171], v228 offset:2048
    ds_read_b128 v[172:175], v229 offset:2048
    ds_read_b128 v[176:179], v228 offset:4096
    ds_read_b128 v[180:183], v229 offset:4096
    ds_read_b128 v[184:187], v228 offset:6144
    ds_read_b128 v[188:191], v229 offset:6144
    s_mov_b32 s98, 0
    .p2alignl 3, 0xBF800000
L_ckA:
    s_waitcnt lgkmcnt(6)
    v_mfma_f32_16x16x32_bf16 v[0:3], v[192:195], v[160:163], v[0:3]
    ds_read_b64_tr_b16 v[208:209], v224 offset:8192
    v_mfma_f32_16x16x32_bf16 v[0:3], v[196:199], v[164:167], v[0:3]
    ds_read_b64_tr_b16 v[210:211], v224 offset:8704
    v_mfma_f32_16x16x32_bf16 v[16:19], v[200:203], v[160:163], v[16:19]
    ds_read_b64_tr_b16 v[212:213], v224 offset:12288
    v_mfma_f32_16x16x32_bf16 v[16:19], v[204:207], v[164:167], v[16:19]
    ds_read_b64_tr_b16 v[214:215], v224 offset:12800
    s_waitcnt lgkmcnt(8)
    v_mfma_f32_16x16x32_bf16 v[4:7], v[192:195], v[168:171], v[4:7]
    ds_read_b64_tr_b16 v[216:217], v225 offset:8192
    v_mfma_f32_16x16x32_bf16 v[4:7], v[196:199], v[172:175], v[4:7]
    ds_read_b64_tr_b16 v[218:219], v225 offset:8704
    v_mfma_f32_16x16x32_bf16 v[20:23], v[200:203], v[168:171], v[20:23]
    ds_read_b64_tr_b16 v[220:221], v225 offset:12288
    v_mfma_f32_16x16x32_bf16 v[20:23], v[204:207], v[172:175], v[20:23]
    ds_read_b64_tr_b16 v[222:223], v225 offset:12800
    s_waitcnt lgkmcnt(10)
    v_mfma_f32_16x16x32_bf16 v[8:11], v[192:195], v[176:179], v[8:11]
    v_mfma_f32_16x16x32_bf16 v[8:11], v[196:199], v[180:183], v[8:11]
    v_mfma_f32_16x16x32_bf16 v[24:27], v[200:203], v[176:179], v[24:27]
    v_mfma_f32_16x16x32_bf16 v[24:27], v[204:207], v[180:183], v[24:27]
    s_waitcnt lgkmcnt(8)
    v_mfma_f32_16x16x32_bf16 v[12:15], v[192:195], v[184:187], v[12:15]
    v_mfma_f32_16x16x32_bf16 v[12:15], v[196:199], v[188:191], v[12:15]
    v_mfma_f32_16x16x32_bf16 v[28:31], v[200:203], v[184:187], v[28:31]
    v_mfma_f32_16x16x32_bf16 v[28:31], v[204:207], v[188:191], v[28:31]
    s_waitcnt lgkmcnt(0)
    s_barrier
    v_mfma_f32_16x16x32_bf16 v[32:35], v[208:211], v[160:163], v[32:35]
    ds_read_b64_tr_b16 v[192:193], v224 offset:16384
    v_mfma_f32_16x16x32_bf16 v[32:35], v[212:215], v[164:167], v[32:35]
    ds_read_b64_tr_b16 v[194:195], v224 offset:16896
    v_mfma_f32_16x16x32_bf16 v[48:51], v[216:219], v[160:163], v[48:51]
    ds_read_b64_tr_b16 v[196:197], v224 offset:20480
    v_mfma_f32_16x16x32_bf16 v[48:51], v[220:223], v[164:167], v[48:51]
    ds_read_b64_tr_b16 v[198:199], v224 offset:20992
    v_mfma_f32_16x16x32_bf16 v[36:39], v[208:211], v[168:171], v[36:39]
    ds_read_b64_tr_b16 v[200:201], v225 offset:16384
    v_mfma_f32_16x16x32_bf16 v[36:39], v[212:215], v[172:175], v[36:39]
    ds_read_b64_tr_b16 v[202:203], v225 offset:16896
    v_mfma_f32_16x16x32_bf16 v[52:55], v[216:219], v[168:171], v[52:55]
    ds_read_b64_tr_b16 v[204:205], v225 offset:20480
    v_mfma_f32_16x16x32_bf16 v[52:55], v[220:223], v[172:175], v[52:55]
    ds_read_b64_tr_b16 v[206:207], v225 offset:20992
    v_mfma_f32_16x16x32_bf16 v[40:43], v[208:211], v[176:179], v[40:43]
    v_mfma_f32_16x16x32_bf16 v[40:43], v[212:215], v[180:183], v[40:43]
    v_mfma_f32_16x16x32_bf16 v[56:59], v[216:219], v[176:179], v[56:59]
    v_mfma_f32_16x16x32_bf16 v[56:59], v[220:223], v[180:183], v[56:59]
    v_mfma_f32_16x16x32_bf16 v[44:47], v[208:211], v[184:187], v[44:47]
    v_mfma_f32_16x16x32_bf16 v[44:47], v[212:215], v[188:191], v[44:47]
    v_mfma_f32_16x16x32_bf16 v[60:63], v[216:219], v[184:187], v[60:63]
    v_mfma_f32_16x16x32_bf16 v[60:63], v[220:223], v[188:191], v[60:63]
    s_waitcnt lgkmcnt(0)
    v_mfma_f32_16x16x32_bf16 v[64:67], v[192:195], v[160:163], v[64:67]
    ds_read_b64_tr_b16 v[208:209], v224 offset:24576
    v_mfma_f32_16x16x32_bf16 v[64:67], v[196:199], v[164:167], v[64:67]
    ds_read_b64_tr_b16 v[210:211], v224 offset:25088
    v_mfma_f32_16x16x32_bf16 v[80:83], v[200:203], v[160:163], v[80:83]
    ds_read_b64_tr_b16 v[212:213], v224 offset:28672
    v_mfma_f32_16x16x32_bf16 v[80:83], v[204:207], v[164:167], v[80:83]
    ds_read_b64_tr_b16 v[214:215], v224 offset:29184
    v_mfma_f32_16x16x32_bf16 v[68:71], v[192:195], v[168:171], v[68:71]
    ds_read_b64_tr_b16 v[216:217], v225 offset:24576
    v_mfma_f32_16x16x32_bf16 v[68:71], v[196:199], v[172:175], v[68:71]
    ds_read_b64_tr_b16 v[218:219], v225 offset:25088
    v_mfma_f32_16x16x32_bf16 v[84:87], v[200:203], v[168:171], v[84:87]
    ds_read_b64_tr_b16 v[220:221], v225 offset:28672
    v_mfma_f32_16x16x32_bf16 v[84:87], v[204:207], v[172:175], v[84:87]
    ds_read_b64_tr_b16 v[222:223], v225 offset:29184
    v_mfma_f32_16x16x32_bf16 v[72:75], v[192:195], v[176:179], v[72:75]
    v_mfma_f32_16x16x32_bf16 v[72:75], v[196:199], v[180:183], v[72:75]
    v_mfma_f32_16x16x32_bf16 v[88:91], v[200:203], v[176:179], v[88:91]
    v_mfma_f32_16x16x32_bf16 v[88:91], v[204:207], v[180:183], v[88:91]
    v_mfma_f32_16x16x32_bf16 v[76:79], v[192:195], v[184:187], v[76:79]
    v_mfma_f32_16x16x32_bf16 v[76:79], v[196:199], v[188:191], v[76:79]
    v_mfma_f32_16x16x32_bf16 v[92:95], v[200:203], v[184:187], v[92:95]
    v_mfma_f32_16x16x32_bf16 v[92:95], v[204:207], v[188:191], v[92:95]
    s_waitcnt lgkmcnt(0)
    v_mfma_f32_16x16x32_bf16 v[96:99], v[160:163], v[208:211], v[96:99]
    ds_read_b64_tr_b16 v[192:193], v224 offset:32768
    v_mfma_f32_16x16x32_bf16 v[96:99], v[164:167], v[212:215], v[96:99]
    ds_read_b64_tr_b16 v[194:195], v224 offset:33280
    v_mfma_f32_16x16x32_bf16 v[112:115], v[160:163], v[216:219], v[112:115]
    ds_read_b64_tr_b16 v[196:197], v224 offset:36864
    v_mfma_f32_16x16x32_bf16 v[112:115], v[164:167], v[220:223], v[112:115]
    ds_read_b64_tr_b16 v[198:199], v224 offset:37376
    v_mfma_f32_16x16x32_bf16 v[100:103], v[168:171], v[208:211], v[100:103]
    ds_read_b64_tr_b16 v[200:201], v225 offset:32768
    v_mfma_f32_16x16x32_bf16 v[100:103], v[172:175], v[212:215], v[100:103]
    ds_read_b64_tr_b16 v[202:203], v225 offset:33280
    v_mfma_f32_16x16x32_bf16 v[116:119], v[168:171], v[216:219], v[116:119]
    ds_read_b64_tr_b16 v[204:205], v225 offset:36864
    v_mfma_f32_16x16x32_bf16 v[116:119], v[172:175], v[220:223], v[116:119]
    ds_read_b64_tr_b16 v[206:207], v225 offset:37376
    v_mfma_f32_16x16x32_bf16 v[104:107], v[176:179], v[208:211], v[104:107]
    v_mfma_f32_16x16x32_bf16 v[104:107], v[180:183], v[212:215], v[104:107]
    v_mfma_f32_16x16x32_bf16 v[120:123], v[176:179], v[216:219], v[120:123]
    v_mfma_f32_16x16x32_bf16 v[120:123], v[180:183], v[220:223], v[120:123]
    v_mfma_f32_16x16x32_bf16 v[108:111], v[184:187], v[208:211], v[108:111]
    v_mfma_f32_16x16x32_bf16 v[108:111], v[188:191], v[212:215], v[108:111]
    v_mfma_f32_16x16x32_bf16 v[124:127], v[184:187], v[216:219], v[124:127]
    v_mfma_f32_16x16x32_bf16 v[124:127], v[188:191], v[220:223], v[124:127]
    s_waitcnt lgkmcnt(0)
    s_barrier
    v_mfma_f32_16x16x32_bf16 v[128:131], v[192:195], v[160:163], v[128:131]
    ds_read_b64_tr_b16 v[208:209], v226 offset:8192
    v_mfma_f32_16x16x32_bf16 v[128:131], v[196:199], v[164:167], v[128:131]
    ds_read_b64_tr_b16 v[210:211], v226 offset:8704
    v_mfma_f32_16x16x32_bf16 v[144:147], v[200:203], v[160:163], v[144:147]
    ds_read_b64_tr_b16 v[212:213], v226 offset:12288
    v_mfma_f32_16x16x32_bf16 v[144:147], v[204:207], v[164:167], v[144:147]
    ds_read_b64_tr_b16 v[214:215], v226 offset:12800
    ds_read_b128 v[160:163], v228 offset:16384
    ds_read_b128 v[164:167], v229 offset:16384
    v_mfma_f32_16x16x32_bf16 v[132:135], v[192:195], v[168:171], v[132:135]
    ds_read_b64_tr_b16 v[216:217], v227 offset:8192
    v_mfma_f32_16x16x32_bf16 v[132:135], v[196:199], v[172:175], v[132:135]
    ds_read_b64_tr_b16 v[218:219], v227 offset:8704
    v_mfma_f32_16x16x32_bf16 v[148:151], v[200:203], v[168:171], v[148:151]
    ds_read_b64_tr_b16 v[220:221], v227 offset:12288
    v_mfma_f32_16x16x32_bf16 v[148:151], v[204:207], v[172:175], v[148:151]
    ds_read_b64_tr_b16 v[222:223], v227 offset:12800
    ds_read_b128 v[168:171], v228 offset:18432
    ds_read_b128 v[172:175], v229 offset:18432
    v_mfma_f32_16x16x32_bf16 v[136:139], v[192:195], v[176:179], v[136:139]
    v_mfma_f32_16x16x32_bf16 v[136:139], v[196:199], v[180:183], v[136:139]
    v_mfma_f32_16x16x32_bf16 v[152:155], v[200:203], v[176:179], v[152:155]
    v_mfma_f32_16x16x32_bf16 v[152:155], v[204:207], v[180:183], v[152:155]
    ds_read_b128 v[176:179], v228 offset:20480
    ds_read_b128 v[180:183], v229 offset:20480
    v_mfma_f32_16x16x32_bf16 v[140:143], v[192:195], v[184:187], v[140:143]
    v_mfma_f32_16x16x32_bf16 v[140:143], v[196:199], v[188:191], v[140:143]
    v_mfma_f32_16x16x32_bf16 v[156:159], v[200:203], v[184:187], v[156:159]
    v_mfma_f32_16x16x32_bf16 v[156:159], v[204:207], v[188:191], v[156:159]
    ds_read_b128 v[184:187], v228 offset:22528
    ds_read_b128 v[188:191], v229 offset:22528
    s_waitcnt lgkmcnt(6)
    v_mfma_f32_16x16x32_bf16 v[0:3], v[208:211], v[160:163], v[0:3]
    ds_read_b64_tr_b16 v[192:193], v226 offset:16384
    v_mfma_f32_16x16x32_bf16 v[0:3], v[212:215], v[164:167], v[0:3]
    ds_read_b64_tr_b16 v[194:195], v226 offset:16896
    v_mfma_f32_16x16x32_bf16 v[16:19], v[216:219], v[160:163], v[16:19]
    ds_read_b64_tr_b16 v[196:197], v226 offset:20480
    v_mfma_f32_16x16x32_bf16 v[16:19], v[220:223], v[164:167], v[16:19]
    ds_read_b64_tr_b16 v[198:199], v226 offset:20992
    s_waitcnt lgkmcnt(8)
    v_mfma_f32_16x16x32_bf16 v[4:7], v[208:211], v[168:171], v[4:7]
    ds_read_b64_tr_b16 v[200:201], v227 offset:16384
    v_mfma_f32_16x16x32_bf16 v[4:7], v[212:215], v[172:175], v[4:7]
    ds_read_b64_tr_b16 v[202:203], v227 offset:16896
    v_mfma_f32_16x16x32_bf16 v[20:23], v[216:219], v[168:171], v[20:23]
    ds_read_b64_tr_b16 v[204:205], v227 offset:20480
    v_mfma_f32_16x16x32_bf16 v[20:23], v[220:223], v[172:175], v[20:23]
    ds_read_b64_tr_b16 v[206:207], v227 offset:20992
    s_waitcnt lgkmcnt(10)
    v_mfma_f32_16x16x32_bf16 v[8:11], v[208:211], v[176:179], v[8:11]
    v_mfma_f32_16x16x32_bf16 v[8:11], v[212:215], v[180:183], v[8:11]
    v_mfma_f32_16x16x32_bf16 v[24:27], v[216:219], v[176:179], v[24:27]
    v_mfma_f32_16x16x32_bf16 v[24:27], v[220:223], v[180:183], v[24:27]
    s_waitcnt lgkmcnt(8)
    v_mfma_f32_16x16x32_bf16 v[12:15], v[208:211], v[184:187], v[12:15]
    v_mfma_f32_16x16x32_bf16 v[12:15], v[212:215], v[188:191], v[12:15]
    v_mfma_f32_16x16x32_bf16 v[28:31], v[216:219], v[184:187], v[28:31]
    v_mfma_f32_16x16x32_bf16 v[28:31], v[220:223], v[188:191], v[28:31]
    s_waitcnt lgkmcnt(0)
    s_barrier
    v_mfma_f32_16x16x32_bf16 v[32:35], v[192:195], v[160:163], v[32:35]
    ds_read_b64_tr_b16 v[208:209], v226 offset:24576
    v_mfma_f32_16x16x32_bf16 v[32:35], v[196:199], v[164:167], v[32:35]
    ds_read_b64_tr_b16 v[210:211], v226 offset:25088
    v_mfma_f32_16x16x32_bf16 v[48:51], v[200:203], v[160:163], v[48:51]
    ds_read_b64_tr_b16 v[212:213], v226 offset:28672
    v_mfma_f32_16x16x32_bf16 v[48:51], v[204:207], v[164:167], v[48:51]
    ds_read_b64_tr_b16 v[214:215], v226 offset:29184
    v_mfma_f32_16x16x32_bf16 v[36:39], v[192:195], v[168:171], v[36:39]
    ds_read_b64_tr_b16 v[216:217], v227 offset:24576
    v_mfma_f32_16x16x32_bf16 v[36:39], v[196:199], v[172:175], v[36:39]
    ds_read_b64_tr_b16 v[218:219], v227 offset:25088
    v_mfma_f32_16x16x32_bf16 v[52:55], v[200:203], v[168:171], v[52:55]
    ds_read_b64_tr_b16 v[220:221], v227 offset:28672
    v_mfma_f32_16x16x32_bf16 v[52:55], v[204:207], v[172:175], v[52:55]
    ds_read_b64_tr_b16 v[222:223], v227 offset:29184
    v_mfma_f32_16x16x32_bf16 v[40:43], v[192:195], v[176:179], v[40:43]
    v_mfma_f32_16x16x32_bf16 v[40:43], v[196:199], v[180:183], v[40:43]
    v_mfma_f32_16x16x32_bf16 v[56:59], v[200:203], v[176:179], v[56:59]
    v_mfma_f32_16x16x32_bf16 v[56:59], v[204:207], v[180:183], v[56:59]
    v_mfma_f32_16x16x32_bf16 v[44:47], v[192:195], v[184:187], v[44:47]
    v_mfma_f32_16x16x32_bf16 v[44:47], v[196:199], v[188:191], v[44:47]
    v_mfma_f32_16x16x32_bf16 v[60:63], v[200:203], v[184:187], v[60:63]
    v_mfma_f32_16x16x32_bf16 v[60:63], v[204:207], v[188:191], v[60:63]
    s_waitcnt lgkmcnt(0)
    s_cmp_lg_u32 s98, 0
    s_cbranch_scc1 L_ckA_nt
    s_mov_b64 exec, s[86:87]
    buffer_load_dword v253, v253, s[76:79], 0 offen
    s_mov_b64 exec, -1
    s_nop 0
L_ckA_nt:
    v_mfma_f32_16x16x32_bf16 v[64:67], v[208:211], v[160:163], v[64:67]
    ds_read_b64_tr_b16 v[192:193], v226 offset:32768
    v_mfma_f32_16x16x32_bf16 v[64:67], v[212:215], v[164:167], v[64:67]
    ds_read_b64_tr_b16 v[194:195], v226 offset:33280
    v_mfma_f32_16x16x32_bf16 v[80:83], v[216:219], v[160:163], v[80:83]
    ds_read_b64_tr_b16 v[196:197], v226 offset:36864
    v_mfma_f32_16x16x32_bf16 v[80:83], v[220:223], v[164:167], v[80:83]
    ds_read_b64_tr_b16 v[198:199], v226 offset:37376
    v_mfma_f32_16x16x32_bf16 v[68:71], v[208:211], v[168:171], v[68:71]
    ds_read_b64_tr_b16 v[200:201], v227 offset:32768
    v_mfma_f32_16x16x32_bf16 v[68:71], v[212:215], v[172:175], v[68:71]
    ds_read_b64_tr_b16 v[202:203], v227 offset:33280
    v_mfma_f32_16x16x32_bf16 v[84:87], v[216:219], v[168:171], v[84:87]
    ds_read_b64_tr_b16 v[204:205], v227 offset:36864
    v_mfma_f32_16x16x32_bf16 v[84:87], v[220:223], v[172:175], v[84:87]
    ds_read_b64_tr_b16 v[206:207], v227 offset:37376
    v_mfma_f32_16x16x32_bf16 v[72:75], v[208:211], v[176:179], v[72:75]
    v_mfma_f32_16x16x32_bf16 v[72:75], v[212:215], v[180:183], v[72:75]
    v_mfma_f32_16x16x32_bf16 v[88:91], v[216:219], v[176:179], v[88:91]
    v_mfma_f32_16x16x32_bf16 v[88:91], v[220:223], v[180:183], v[88:91]
    v_mfma_f32_16x16x32_bf16 v[76:79], v[208:211], v[184:187], v[76:79]
    v_mfma_f32_16x16x32_bf16 v[76:79], v[212:215], v[188:191], v[76:79]
    v_mfma_f32_16x16x32_bf16 v[92:95], v[216:219], v[184:187], v[92:95]
    v_mfma_f32_16x16x32_bf16 v[92:95], v[220:223], v[188:191], v[92:95]
    s_waitcnt lgkmcnt(0)
    v_mfma_f32_16x16x32_bf16 v[96:99], v[160:163], v[192:195], v[96:99]
    ds_read_b64_tr_b16 v[208:209], v226 offset:0
    v_mfma_f32_16x16x32_bf16 v[96:99], v[164:167], v[196:199], v[96:99]
    ds_read_b64_tr_b16 v[210:211], v226 offset:512
    v_mfma_f32_16x16x32_bf16 v[112:115], v[160:163], v[200:203], v[112:115]
    ds_read_b64_tr_b16 v[212:213], v226 offset:4096
    v_mfma_f32_16x16x32_bf16 v[112:115], v[164:167], v[204:207], v[112:115]
    ds_read_b64_tr_b16 v[214:215], v226 offset:4608
    v_mfma_f32_16x16x32_bf16 v[100:103], v[168:171], v[192:195], v[100:103]
    ds_read_b64_tr_b16 v[216:217], v227 offset:0
    v_mfma_f32_16x16x32_bf16 v[100:103], v[172:175], v[196:199], v[100:103]
    ds_read_b64_tr_b16 v[218:219], v227 offset:512
    v_mfma_f32_16x16x32_bf16 v[116:119], v[168:171], v[200:203], v[116:119]
    ds_read_b64_tr_b16 v[220:221], v227 offset:4096
    v_mfma_f32_16x16x32_bf16 v[116:119], v[172:175], v[204:207], v[116:119]
    ds_read_b64_tr_b16 v[222:223], v227 offset:4608
    v_mfma_f32_16x16x32_bf16 v[104:107], v[176:179], v[192:195], v[104:107]
    v_mfma_f32_16x16x32_bf16 v[104:107], v[180:183], v[196:199], v[104:107]
    v_mfma_f32_16x16x32_bf16 v[120:123], v[176:179], v[200:203], v[120:123]
    v_mfma_f32_16x16x32_bf16 v[120:123], v[180:183], v[204:207], v[120:123]
    v_mfma_f32_16x16x32_bf16 v[108:111], v[184:187], v[192:195], v[108:111]
    v_mfma_f32_16x16x32_bf16 v[108:111], v[188:191], v[196:199], v[108:111]
    v_mfma_f32_16x16x32_bf16 v[124:127], v[184:187], v[200:203], v[124:127]
    v_mfma_f32_16x16x32_bf16 v[124:127], v[188:191], v[204:207], v[124:127]
    s_waitcnt lgkmcnt(0)
    s_barrier
    s_cmp_eq_u32 s98, 3
    s_cbranch_scc1 L_ckA_last
    v_mfma_f32_16x16x32_bf16 v[128:131], v[208:211], v[160:163], v[128:131]
    ds_read_b64_tr_b16 v[192:193], v224 offset:0
    v_mfma_f32_16x16x32_bf16 v[128:131], v[212:215], v[164:167], v[128:131]
    ds_read_b64_tr_b16 v[194:195], v224 offset:512
    v_mfma_f32_16x16x32_bf16 v[144:147], v[216:219], v[160:163], v[144:147]
    ds_read_b64_tr_b16 v[196:197], v224 offset:4096
    v_mfma_f32_16x16x32_bf16 v[144:147], v[220:223], v[164:167], v[144:147]
    ds_read_b64_tr_b16 v[198:199], v224 offset:4608
    ds_read_b128 v[160:163], v228 offset:0
    ds_read_b128 v[164:167], v229 offset:0
    v_mfma_f32_16x16x32_bf16 v[132:135], v[208:211], v[168:171], v[132:135]
    ds_read_b64_tr_b16 v[200:201], v225 offset:0
    v_mfma_f32_16x16x32_bf16 v[132:135], v[212:215], v[172:175], v[132:135]
    ds_read_b64_tr_b16 v[202:203], v225 offset:512
    v_mfma_f32_16x16x32_bf16 v[148:151], v[216:219], v[168:171], v[148:151]
    ds_read_b64_tr_b16 v[204:205], v225 offset:4096
    v_mfma_f32_16x16x32_bf16 v[148:151], v[220:223], v[172:175], v[148:151]
    ds_read_b64_tr_b16 v[206:207], v225 offset:4608
    ds_read_b128 v[168:171], v228 offset:2048
    ds_read_b128 v[172:175], v229 offset:2048
    v_mfma_f32_16x16x32_bf16 v[136:139], v[208:211], v[176:179], v[136:139]
    v_mfma_f32_16x16x32_bf16 v[136:139], v[212:215], v[180:183], v[136:139]
    v_mfma_f32_16x16x32_bf16 v[152:155], v[216:219], v[176:179], v[152:155]
    v_mfma_f32_16x16x32_bf16 v[152:155], v[220:223], v[180:183], v[152:155]
    ds_read_b128 v[176:179], v228 offset:4096
    ds_read_b128 v[180:183], v229 offset:4096
    v_mfma_f32_16x16x32_bf16 v[140:143], v[208:211], v[184:187], v[140:143]
    v_mfma_f32_16x16x32_bf16 v[140:143], v[212:215], v[188:191], v[140:143]
    v_mfma_f32_16x16x32_bf16 v[156:159], v[216:219], v[184:187], v[156:159]
    v_mfma_f32_16x16x32_bf16 v[156:159], v[220:223], v[188:191], v[156:159]
    ds_read_b128 v[184:187], v228 offset:6144
    ds_read_b128 v[188:191], v229 offset:6144
    s_add_u32 s98, s98, 1
    s_branch L_ckA
    .p2alignl 3, 0xBF800000
L_ckA_last:
    v_mfma_f32_16x16x32_bf16 v[128:131], v[208:211], v[160:163], v[128:131]
    ds_read2_b32 v[254:255], v234 offset0:192 offset1:208
    v_mfma_f32_16x16x32_bf16 v[128:131], v[212:215], v[164:167], v[128:131]
    ds_read_b128 v[192:195], v232 offset:128
    v_mfma_f32_16x16x32_bf16 v[144:147], v[216:219], v[160:163], v[144:147]
    ds_read_b128 v[196:199], v232 offset:704
    v_mfma_f32_16x16x32_bf16 v[144:147], v[220:223], v[164:167], v[144:147]
    ds_read_b128 v[200:203], v232 offset:192
    ds_read_b128 v[204:207], v232 offset:768
    ds_read2_b32 v[160:161], v231 offset0:0 offset1:144
    ds_read2_b32 v[162:163], v231 offset0:16 offset1:160
    ds_read2_b32 v[164:165], v231 offset0:32 offset1:176
    ds_read2_b32 v[166:167], v231 offset0:48 offset1:192
    v_mfma_f32_16x16x32_bf16 v[132:135], v[208:211], v[168:171], v[132:135]
    v_mfma_f32_16x16x32_bf16 v[132:135], v[212:215], v[172:175], v[132:135]
    v_mfma_f32_16x16x32_bf16 v[148:151], v[216:219], v[168:171], v[148:151]
    v_mfma_f32_16x16x32_bf16 v[148:151], v[220:223], v[172:175], v[148:151]
    ds_read_b128 v[168:171], v233 offset:512
    ds_read_b128 v[172:175], v233 offset:576
    v_mfma_f32_16x16x32_bf16 v[136:139], v[208:211], v[176:179], v[136:139]
    v_mfma_f32_16x16x32_bf16 v[136:139], v[212:215], v[180:183], v[136:139]
    v_mfma_f32_16x16x32_bf16 v[152:155], v[216:219], v[176:179], v[152:155]
    v_mfma_f32_16x16x32_bf16 v[152:155], v[220:223], v[180:183], v[152:155]
    ds_read_b128 v[176:179], v233 offset:0
    ds_read_b128 v[180:183], v233 offset:64
    v_mfma_f32_16x16x32_bf16 v[140:143], v[208:211], v[184:187], v[140:143]
    v_mfma_f32_16x16x32_bf16 v[140:143], v[212:215], v[188:191], v[140:143]
    v_mfma_f32_16x16x32_bf16 v[156:159], v[216:219], v[184:187], v[156:159]
    v_mfma_f32_16x16x32_bf16 v[156:159], v[220:223], v[188:191], v[156:159]
    ds_read_b128 v[184:187], v232 offset:0
    ds_read_b128 v[188:191], v232 offset:576
    s_waitcnt lgkmcnt(10)
    .p2alignl 3, 0xBF800000
    v_pk_fma_f32 v[104:105], v[192:193], v[254:255], v[104:105] op_sel:[0,0,0] op_sel_hi:[1,0,1] neg_lo:[0,1,0] neg_hi:[0,1,0]
    v_pk_fma_f32 v[106:107], v[194:195], v[254:255], v[106:107] op_sel:[0,0,0] op_sel_hi:[1,0,1] neg_lo:[0,1,0] neg_hi:[0,1,0]
    v_pk_mul_f32 v[104:105], v[104:105], v[196:197]
    v_pk_mul_f32 v[106:107], v[106:107], v[198:199]
    v_cvt_pk_bf16_f32 v208, v104, v105
    v_cvt_pk_bf16_f32 v209, v106, v107
    v_pk_fma_f32 v[120:121], v[192:193], v[254:255], v[120:121] op_sel:[0,1,0] op_sel_hi:[1,1,1] neg_lo:[0,1,0] neg_hi:[0,1,0]
    v_pk_fma_f32 v[122:123], v[194:195], v[254:255], v[122:123] op_sel:[0,1,0] op_sel_hi:[1,1,1] neg_lo:[0,1,0] neg_hi:[0,1,0]
    v_pk_mul_f32 v[120:121], v[120:121], v[196:197]
    v_pk_mul_f32 v[122:123], v[122:123], v[198:199]
    v_cvt_pk_bf16_f32 v220, v120, v121
    v_cvt_pk_bf16_f32 v221, v122, v123
    ds_read_b128 v[192:195], v232 offset:64
    ds_read_b128 v[196:199], v232 offset:640
    v_pk_fma_f32 v[108:109], v[200:201], v[254:255], v[108:109] op_sel:[0,0,0] op_sel_hi:[1,0,1] neg_lo:[0,1,0] neg_hi:[0,1,0]
    v_pk_fma_f32 v[110:111], v[202:203], v[254:255], v[110:111] op_sel:[0,0,0] op_sel_hi:[1,0,1] neg_lo:[0,1,0] neg_hi:[0,1,0]
    v_pk_mul_f32 v[108:109], v[108:109], v[204:205]
    v_pk_mul_f32 v[110:111], v[110:111], v[206:207]
    v_cvt_pk_bf16_f32 v214, v108, v109
    v_cvt_pk_bf16_f32 v215, v110, v111
    v_pk_fma_f32 v[124:125], v[200:201], v[254:255], v[124:125] op_sel:[0,1,0] op_sel_hi:[1,1,1] neg_lo:[0,1,0] neg_hi:[0,1,0]
    v_pk_fma_f32 v[126:127], v[202:203], v[254:255], v[126:127] op_sel:[0,1,0] op_sel_hi:[1,1,1] neg_lo:[0,1,0] neg_hi:[0,1,0]
    v_pk_mul_f32 v[124:125], v[124:125], v[204:205]
    v_pk_mul_f32 v[126:127], v[126:127], v[206:207]
    v_cvt_pk_bf16_f32 v226, v124, v125
    v_cvt_pk_bf16_f32 v227, v126, v127
    s_waitcnt lgkmcnt(6)
    s_nop 0
    v_pk_fma_f32 v[72:73], v[168:169], v[164:165], v[72:73] op_sel:[0,0,0] op_sel_hi:[1,0,1] neg_lo:[0,1,0] neg_hi:[0,1,0]
    v_pk_fma_f32 v[74:75], v[170:171], v[164:165], v[74:75] op_sel:[0,0,0] op_sel_hi:[1,0,1] neg_lo:[0,1,0] neg_hi:[0,1,0]
    v_pk_mul_f32 v[72:73], v[72:73], v[164:165] op_sel:[0,1] op_sel_hi:[1,1]
    v_pk_mul_f32 v[74:75], v[74:75], v[164:165] op_sel:[0,1] op_sel_hi:[1,1]
    v_cvt_pk_bf16_f32 v72, v72, v73
    v_cvt_pk_bf16_f32 v73, v74, v75
    v_pk_fma_f32 v[88:89], v[172:173], v[164:165], v[88:89] op_sel:[0,0,0] op_sel_hi:[1,0,1] neg_lo:[0,1,0] neg_hi:[0,1,0]
    v_pk_fma_f32 v[90:91], v[174:175], v[164:165], v[90:91] op_sel:[0,0,0] op_sel_hi:[1,0,1] neg_lo:[0,1,0] neg_hi:[0,1,0]
    v_pk_mul_f32 v[88:89], v[88:89], v[164:165] op_sel:[0,1] op_sel_hi:[1,1]
    v_pk_mul_f32 v[90:91], v[90:91], v[164:165] op_sel:[0,1] op_sel_hi:[1,1]
    v_cvt_pk_bf16_f32 v88, v88, v89
    v_cvt_pk_bf16_f32 v89, v90, v91
    v_pk_fma_f32 v[76:77], v[168:169], v[166:167], v[76:77] op_sel:[0,0,0] op_sel_hi:[1,0,1] neg_lo:[0,1,0] neg_hi:[0,1,0]
    v_pk_fma_f32 v[78:79], v[170:171], v[166:167], v[78:79] op_sel:[0,0,0] op_sel_hi:[1,0,1] neg_lo:[0,1,0] neg_hi:[0,1,0]
    v_pk_mul_f32 v[76:77], v[76:77], v[166:167] op_sel:[0,1] op_sel_hi:[1,1]
    v_pk_mul_f32 v[78:79], v[78:79], v[166:167] op_sel:[0,1] op_sel_hi:[1,1]
    v_cvt_pk_bf16_f32 v76, v76, v77
    v_cvt_pk_bf16_f32 v77, v78, v79
    v_pk_fma_f32 v[92:93], v[172:173], v[166:167], v[92:93] op_sel:[0,0,0] op_sel_hi:[1,0,1] neg_lo:[0,1,0] neg_hi:[0,1,0]
    v_pk_fma_f32 v[94:95], v[174:175], v[166:167], v[94:95] op_sel:[0,0,0] op_sel_hi:[1,0,1] neg_lo:[0,1,0] neg_hi:[0,1,0]
    v_pk_mul_f32 v[92:93], v[92:93], v[166:167] op_sel:[0,1] op_sel_hi:[1,1]
    v_pk_mul_f32 v[94:95], v[94:95], v[166:167] op_sel:[0,1] op_sel_hi:[1,1]
    v_cvt_pk_bf16_f32 v92, v92, v93
    v_cvt_pk_bf16_f32 v93, v94, v95
    s_cmp_ge_u32 s60, 2
    s_cbranch_scc1 L_a_noexp
    s_mov_b32 exec_lo, 0xff00ff00
    s_mov_b32 exec_hi, 0xff00ff00
    ds_write_b64 v235, v[72:73] offset:4096
    ds_write_b64 v235, v[76:77] offset:4608
    ds_write_b64 v235, v[88:89] offset:5120
    ds_write_b64 v235, v[92:93] offset:5632
    s_mov_b32 exec_lo, 0
    s_mov_b32 exec_hi, -1
    ds_write_b64 v252, v[208:209] offset:4352
    ds_write_b64 v252, v[214:215] offset:4864
    ds_write_b64 v252, v[220:221] offset:5376
    ds_write_b64 v252, v[226:227] offset:5888
    s_mov_b64 exec, -1
L_a_noexp:
    .p2alignl 3, 0xBF800000
    v_pk_fma_f32 v[64:65], v[168:169], v[160:161], v[64:65] op_sel:[0,0,0] op_sel_hi:[1,0,1] neg_lo:[0,1,0] neg_hi:[0,1,0]
    v_pk_fma_f32 v[66:67], v[170:171], v[160:161], v[66:67] op_sel:[0,0,0] op_sel_hi:[1,0,1] neg_lo:[0,1,0] neg_hi:[0,1,0]
    v_pk_mul_f32 v[64:65], v[64:65], v[160:161] op_sel:[0,1] op_sel_hi:[1,1]
    v_pk_mul_f32 v[66:67], v[66:67], v[160:161] op_sel:[0,1] op_sel_hi:[1,1]
    v_cvt_pk_bf16_f32 v64, v64, v65
    v_cvt_pk_bf16_f32 v65, v66, v67
    v_pk_fma_f32 v[80:81], v[172:173], v[160:161], v[80:81] op_sel:[0,0,0] op_sel_hi:[1,0,1] neg_lo:[0,1,0] neg_hi:[0,1,0]
    v_pk_fma_f32 v[82:83], v[174:175], v[160:161], v[82:83] op_sel:[0,0,0] op_sel_hi:[1,0,1] neg_lo:[0,1,0] neg_hi:[0,1,0]
    v_pk_mul_f32 v[80:81], v[80:81], v[160:161] op_sel:[0,1] op_sel_hi:[1,1]
    v_pk_mul_f32 v[82:83], v[82:83], v[160:161] op_sel:[0,1] op_sel_hi:[1,1]
    v_cvt_pk_bf16_f32 v80, v80, v81
    v_cvt_pk_bf16_f32 v81, v82, v83
    v_pk_fma_f32 v[68:69], v[168:169], v[162:163], v[68:69] op_sel:[0,0,0] op_sel_hi:[1,0,1] neg_lo:[0,1,0] neg_hi:[0,1,0]
    v_pk_fma_f32 v[70:71], v[170:171], v[162:163], v[70:71] op_sel:[0,0,0] op_sel_hi:[1,0,1] neg_lo:[0,1,0] neg_hi:[0,1,0]
    v_pk_mul_f32 v[68:69], v[68:69], v[162:163] op_sel:[0,1] op_sel_hi:[1,1]
    v_pk_mul_f32 v[70:71], v[70:71], v[162:163] op_sel:[0,1] op_sel_hi:[1,1]
    v_cvt_pk_bf16_f32 v68, v68, v69
    v_cvt_pk_bf16_f32 v69, v70, v71
    v_pk_fma_f32 v[84:85], v[172:173], v[162:163], v[84:85] op_sel:[0,0,0] op_sel_hi:[1,0,1] neg_lo:[0,1,0] neg_hi:[0,1,0]
    v_pk_fma_f32 v[86:87], v[174:175], v[162:163], v[86:87] op_sel:[0,0,0] op_sel_hi:[1,0,1] neg_lo:[0,1,0] neg_hi:[0,1,0]
    v_pk_mul_f32 v[84:85], v[84:85], v[162:163] op_sel:[0,1] op_sel_hi:[1,1]
    v_pk_mul_f32 v[86:87], v[86:87], v[162:163] op_sel:[0,1] op_sel_hi:[1,1]
    v_cvt_pk_bf16_f32 v84, v84, v85
    v_cvt_pk_bf16_f32 v85, v86, v87
    s_waitcnt lgkmcnt(0)
    s_nop 0
    v_pk_fma_f32 v[96:97], v[184:185], v[254:255], v[96:97] op_sel:[0,0,0] op_sel_hi:[1,0,1] neg_lo:[0,1,0] neg_hi:[0,1,0]
    v_pk_fma_f32 v[98:99], v[186:187], v[254:255], v[98:99] op_sel:[0,0,0] op_sel_hi:[1,0,1] neg_lo:[0,1,0] neg_hi:[0,1,0]
    v_pk_mul_f32 v[96:97], v[96:97], v[188:189]
    v_pk_mul_f32 v[98:99], v[98:99], v[190:191]
    v_cvt_pk_bf16_f32 v206, v96, v97
    v_cvt_pk_bf16_f32 v207, v98, v99
    v_pk_fma_f32 v[112:113], v[184:185], v[254:255], v[112:113] op_sel:[0,1,0] op_sel_hi:[1,1,1] neg_lo:[0,1,0] neg_hi:[0,1,0]
    v_pk_fma_f32 v[114:115], v[186:187], v[254:255], v[114:115] op_sel:[0,1,0] op_sel_hi:[1,1,1] neg_lo:[0,1,0] neg_hi:[0,1,0]
    v_pk_mul_f32 v[112:113], v[112:113], v[188:189]
    v_pk_mul_f32 v[114:115], v[114:115], v[190:191]
    v_cvt_pk_bf16_f32 v218, v112, v113
    v_cvt_pk_bf16_f32 v219, v114, v115
    v_pk_fma_f32 v[100:101], v[192:193], v[254:255], v[100:101] op_sel:[0,0,0] op_sel_hi:[1,0,1] neg_lo:[0,1,0] neg_hi:[0,1,0]
    v_pk_fma_f32 v[102:103], v[194:195], v[254:255], v[102:103] op_sel:[0,0,0] op_sel_hi:[1,0,1] neg_lo:[0,1,0] neg_hi:[0,1,0]
    v_pk_mul_f32 v[100:101], v[100:101], v[196:197]
    v_pk_mul_f32 v[102:103], v[102:103], v[198:199]
    v_cvt_pk_bf16_f32 v212, v100, v101
    v_cvt_pk_bf16_f32 v213, v102, v103
    v_pk_fma_f32 v[116:117], v[192:193], v[254:255], v[116:117] op_sel:[0,1,0] op_sel_hi:[1,1,1] neg_lo:[0,1,0] neg_hi:[0,1,0]
    v_pk_fma_f32 v[118:119], v[194:195], v[254:255], v[118:119] op_sel:[0,1,0] op_sel_hi:[1,1,1] neg_lo:[0,1,0] neg_hi:[0,1,0]
    v_pk_mul_f32 v[116:117], v[116:117], v[196:197]
    v_pk_mul_f32 v[118:119], v[118:119], v[198:199]
    v_cvt_pk_bf16_f32 v224, v116, v117
    v_cvt_pk_bf16_f32 v225, v118, v119
    ds_read_b128 v[184:187], v233 offset:256
    ds_read_b128 v[188:191], v233 offset:320
    ds_read_b128 v[192:195], v233 offset:1024
    ds_read_b128 v[196:199], v233 offset:1088
    v_mul_f32 v228, 0x3eb8aa3b, v161
    v_mul_f32 v229, 0x3eb8aa3b, v163
    v_mul_f32 v232, 0x3eb8aa3b, v165
    v_mul_f32 v233, 0x3eb8aa3b, v167
    v_add_u32 v235, s73, v235
    v_add_u32 v252, s73, v252
    v_pk_fma_f32 v[8:9], v[176:177], v[164:165], v[8:9] op_sel:[0,0,0] op_sel_hi:[1,0,1] neg_lo:[0,1,0] neg_hi:[0,1,0]
    v_pk_fma_f32 v[10:11], v[178:179], v[164:165], v[10:11] op_sel:[0,0,0] op_sel_hi:[1,0,1] neg_lo:[0,1,0] neg_hi:[0,1,0]
    v_pk_mul_f32 v[8:9], v[8:9], v[232:233] op_sel:[0,0] op_sel_hi:[1,0]
    v_pk_mul_f32 v[10:11], v[10:11], v[232:233] op_sel:[0,0] op_sel_hi:[1,0]
    v_cvt_pk_bf16_f32 v8, v8, v9
    v_cvt_pk_bf16_f32 v9, v10, v11
    v_pk_fma_f32 v[24:25], v[180:181], v[164:165], v[24:25] op_sel:[0,0,0] op_sel_hi:[1,0,1] neg_lo:[0,1,0] neg_hi:[0,1,0]
    v_pk_fma_f32 v[26:27], v[182:183], v[164:165], v[26:27] op_sel:[0,0,0] op_sel_hi:[1,0,1] neg_lo:[0,1,0] neg_hi:[0,1,0]
    v_pk_mul_f32 v[24:25], v[24:25], v[232:233] op_sel:[0,0] op_sel_hi:[1,0]
    v_pk_mul_f32 v[26:27], v[26:27], v[232:233] op_sel:[0,0] op_sel_hi:[1,0]
    v_cvt_pk_bf16_f32 v24, v24, v25
    v_cvt_pk_bf16_f32 v25, v26, v27
    v_pk_fma_f32 v[12:13], v[176:177], v[166:167], v[12:13] op_sel:[0,0,0] op_sel_hi:[1,0,1] neg_lo:[0,1,0] neg_hi:[0,1,0]
    v_pk_fma_f32 v[14:15], v[178:179], v[166:167], v[14:15] op_sel:[0,0,0] op_sel_hi:[1,0,1] neg_lo:[0,1,0] neg_hi:[0,1,0]
    v_pk_mul_f32 v[12:13], v[12:13], v[232:233] op_sel:[0,1] op_sel_hi:[1,1]
    v_pk_mul_f32 v[14:15], v[14:15], v[232:233] op_sel:[0,1] op_sel_hi:[1,1]
    v_cvt_pk_bf16_f32 v12, v12, v13
    v_cvt_pk_bf16_f32 v13, v14, v15
    v_pk_fma_f32 v[28:29], v[180:181], v[166:167], v[28:29] op_sel:[0,0,0] op_sel_hi:[1,0,1] neg_lo:[0,1,0] neg_hi:[0,1,0]
    v_pk_fma_f32 v[30:31], v[182:183], v[166:167], v[30:31] op_sel:[0,0,0] op_sel_hi:[1,0,1] neg_lo:[0,1,0] neg_hi:[0,1,0]
    v_pk_mul_f32 v[28:29], v[28:29], v[232:233] op_sel:[0,1] op_sel_hi:[1,1]
    v_pk_mul_f32 v[30:31], v[30:31], v[232:233] op_sel:[0,1] op_sel_hi:[1,1]
    v_cvt_pk_bf16_f32 v28, v28, v29
    v_cvt_pk_bf16_f32 v29, v30, v31
    v_pk_fma_f32 v[0:1], v[176:177], v[160:161], v[0:1] op_sel:[0,0,0] op_sel_hi:[1,0,1] neg_lo:[0,1,0] neg_hi:[0,1,0]
    v_pk_fma_f32 v[2:3], v[178:179], v[160:161], v[2:3] op_sel:[0,0,0] op_sel_hi:[1,0,1] neg_lo:[0,1,0] neg_hi:[0,1,0]
    v_pk_mul_f32 v[0:1], v[0:1], v[228:229] op_sel:[0,0] op_sel_hi:[1,0]
    v_pk_mul_f32 v[2:3], v[2:3], v[228:229] op_sel:[0,0] op_sel_hi:[1,0]
    v_cvt_pk_bf16_f32 v0, v0, v1
    v_cvt_pk_bf16_f32 v1, v2, v3
    v_pk_fma_f32 v[16:17], v[180:181], v[160:161], v[16:17] op_sel:[0,0,0] op_sel_hi:[1,0,1] neg_lo:[0,1,0] neg_hi:[0,1,0]
    v_pk_fma_f32 v[18:19], v[182:183], v[160:161], v[18:19] op_sel:[0,0,0] op_sel_hi:[1,0,1] neg_lo:[0,1,0] neg_hi:[0,1,0]
    v_pk_mul_f32 v[16:17], v[16:17], v[228:229] op_sel:[0,0] op_sel_hi:[1,0]
    v_pk_mul_f32 v[18:19], v[18:19], v[228:229] op_sel:[0,0] op_sel_hi:[1,0]
    v_cvt_pk_bf16_f32 v16, v16, v17
    v_cvt_pk_bf16_f32 v17, v18, v19
    v_pk_fma_f32 v[4:5], v[176:177], v[162:163], v[4:5] op_sel:[0,0,0] op_sel_hi:[1,0,1] neg_lo:[0,1,0] neg_hi:[0,1,0]
    v_pk_fma_f32 v[6:7], v[178:179], v[162:163], v[6:7] op_sel:[0,0,0] op_sel_hi:[1,0,1] neg_lo:[0,1,0] neg_hi:[0,1,0]
    v_pk_mul_f32 v[4:5], v[4:5], v[228:229] op_sel:[0,1] op_sel_hi:[1,1]
    v_pk_mul_f32 v[6:7], v[6:7], v[228:229] op_sel:[0,1] op_sel_hi:[1,1]
    v_cvt_pk_bf16_f32 v4, v4, v5
    v_cvt_pk_bf16_f32 v5, v6, v7
    v_pk_fma_f32 v[20:21], v[180:181], v[162:163], v[20:21] op_sel:[0,0,0] op_sel_hi:[1,0,1] neg_lo:[0,1,0] neg_hi:[0,1,0]
    v_pk_fma_f32 v[22:23], v[182:183], v[162:163], v[22:23] op_sel:[0,0,0] op_sel_hi:[1,0,1] neg_lo:[0,1,0] neg_hi:[0,1,0]
    v_pk_mul_f32 v[20:21], v[20:21], v[228:229] op_sel:[0,1] op_sel_hi:[1,1]
    v_pk_mul_f32 v[22:23], v[22:23], v[228:229] op_sel:[0,1] op_sel_hi:[1,1]
    v_cvt_pk_bf16_f32 v20, v20, v21
    v_cvt_pk_bf16_f32 v21, v22, v23
    v_mul_f32 v161, v161, v161
    v_mul_f32 v163, v163, v163
    v_mul_f32 v165, v165, v165
    v_mul_f32 v167, v167, v167
    v_mfma_f32_16x16x16_bf16 v[96:99], v[64:65], v[8:9], v[240:243]
    v_mfma_f32_16x16x16_bf16 v[100:103], v[72:73], v[8:9], v[236:239]
    v_mfma_f32_16x16x16_bf16 v[104:107], v[80:81], v[24:25], v[240:243]
    v_mfma_f32_16x16x16_bf16 v[108:111], v[88:89], v[24:25], v[236:239]
    v_mfma_f32_16x16x16_bf16 v[112:115], v[68:69], v[12:13], v[240:243]
    v_mfma_f32_16x16x16_bf16 v[116:119], v[76:77], v[12:13], v[236:239]
    v_mfma_f32_16x16x16_bf16 v[120:123], v[84:85], v[28:29], v[240:243]
    v_mfma_f32_16x16x16_bf16 v[124:127], v[92:93], v[28:29], v[236:239]
    s_waitcnt lgkmcnt(0)
    v_pk_fma_f32 v[32:33], v[184:185], v[160:161], v[32:33] op_sel:[0,0,0] op_sel_hi:[1,0,1] neg_lo:[0,1,0] neg_hi:[0,1,0]
    v_pk_fma_f32 v[34:35], v[186:187], v[160:161], v[34:35] op_sel:[0,0,0] op_sel_hi:[1,0,1] neg_lo:[0,1,0] neg_hi:[0,1,0]
    v_pk_fma_f32 v[128:129], v[192:193], v[160:161], v[128:129] op_sel:[0,0,0] op_sel_hi:[1,0,1] neg_lo:[0,1,0] neg_hi:[0,1,0]
    v_pk_fma_f32 v[130:131], v[194:195], v[160:161], v[130:131] op_sel:[0,0,0] op_sel_hi:[1,0,1] neg_lo:[0,1,0] neg_hi:[0,1,0]
    v_max_f32 v32, 0, v32
    v_max_f32 v33, 0, v33
    v_max_f32 v34, 0, v34
    v_max_f32 v35, 0, v35
    v_pk_mul_f32 v[128:129], v[128:129], v[160:161] op_sel:[0,1] op_sel_hi:[1,1]
    v_pk_mul_f32 v[130:131], v[130:131], v[160:161] op_sel:[0,1] op_sel_hi:[1,1]
    v_pk_mul_f32 v[32:33], v[32:33], v[128:129]
    v_pk_mul_f32 v[34:35], v[34:35], v[130:131]
    v_cvt_pk_bf16_f32 v168, v32, v33
    v_cvt_pk_bf16_f32 v169, v34, v35
    v_pk_fma_f32 v[48:49], v[188:189], v[160:161], v[48:49] op_sel:[0,0,0] op_sel_hi:[1,0,1] neg_lo:[0,1,0] neg_hi:[0,1,0]
    v_pk_fma_f32 v[50:51], v[190:191], v[160:161], v[50:51] op_sel:[0,0,0] op_sel_hi:[1,0,1] neg_lo:[0,1,0] neg_hi:[0,1,0]
    v_pk_fma_f32 v[144:145], v[196:197], v[160:161], v[144:145] op_sel:[0,0,0] op_sel_hi:[1,0,1] neg_lo:[0,1,0] neg_hi:[0,1,0]
    v_pk_fma_f32 v[146:147], v[198:199], v[160:161], v[146:147] op_sel:[0,0,0] op_sel_hi:[1,0,1] neg_lo:[0,1,0] neg_hi:[0,1,0]
    v_max_f32 v48, 0, v48
    v_max_f32 v49, 0, v49
    v_max_f32 v50, 0, v50
    v_max_f32 v51, 0, v51
    v_pk_mul_f32 v[144:145], v[144:145], v[160:161] op_sel:[0,1] op_sel_hi:[1,1]
    v_pk_mul_f32 v[146:147], v[146:147], v[160:161] op_sel:[0,1] op_sel_hi:[1,1]
    v_pk_mul_f32 v[48:49], v[48:49], v[144:145]
    v_pk_mul_f32 v[50:51], v[50:51], v[146:147]
    v_cvt_pk_bf16_f32 v170, v48, v49
    v_cvt_pk_bf16_f32 v171, v50, v51
    buffer_store_dwordx4 v[168:171], v248, s[48:51], s71 offen sc1
    v_pk_fma_f32 v[36:37], v[184:185], v[162:163], v[36:37] op_sel:[0,0,0] op_sel_hi:[1,0,1] neg_lo:[0,1,0] neg_hi:[0,1,0]
    v_pk_fma_f32 v[38:39], v[186:187], v[162:163], v[38:39] op_sel:[0,0,0] op_sel_hi:[1,0,1] neg_lo:[0,1,0] neg_hi:[0,1,0]
    v_pk_fma_f32 v[132:133], v[192:193], v[162:163], v[132:133] op_sel:[0,0,0] op_sel_hi:[1,0,1] neg_lo:[0,1,0] neg_hi:[0,1,0]
    v_pk_fma_f32 v[134:135], v[194:195], v[162:163], v[134:135] op_sel:[0,0,0] op_sel_hi:[1,0,1] neg_lo:[0,1,0] neg_hi:[0,1,0]
    v_max_f32 v36, 0, v36
    v_max_f32 v37, 0, v37
    v_max_f32 v38, 0, v38
    v_max_f32 v39, 0, v39
    v_pk_mul_f32 v[132:133], v[132:133], v[162:163] op_sel:[0,1] op_sel_hi:[1,1]
    v_pk_mul_f32 v[134:135], v[134:135], v[162:163] op_sel:[0,1] op_sel_hi:[1,1]
    v_pk_mul_f32 v[36:37], v[36:37], v[132:133]
    v_pk_mul_f32 v[38:39], v[38:39], v[134:135]
    v_cvt_pk_bf16_f32 v172, v36, v37
    v_cvt_pk_bf16_f32 v173, v38, v39
    v_pk_fma_f32 v[52:53], v[188:189], v[162:163], v[52:53] op_sel:[0,0,0] op_sel_hi:[1,0,1] neg_lo:[0,1,0] neg_hi:[0,1,0]
    v_pk_fma_f32 v[54:55], v[190:191], v[162:163], v[54:55] op_sel:[0,0,0] op_sel_hi:[1,0,1] neg_lo:[0,1,0] neg_hi:[0,1,0]
    v_pk_fma_f32 v[148:149], v[196:197], v[162:163], v[148:149] op_sel:[0,0,0] op_sel_hi:[1,0,1] neg_lo:[0,1,0] neg_hi:[0,1,0]
    v_pk_fma_f32 v[150:151], v[198:199], v[162:163], v[150:151] op_sel:[0,0,0] op_sel_hi:[1,0,1] neg_lo:[0,1,0] neg_hi:[0,1,0]
    v_max_f32 v52, 0, v52
    v_max_f32 v53, 0, v53
    v_max_f32 v54, 0, v54
    v_max_f32 v55, 0, v55
    v_pk_mul_f32 v[148:149], v[148:149], v[162:163] op_sel:[0,1] op_sel_hi:[1,1]
    v_pk_mul_f32 v[150:151], v[150:151], v[162:163] op_sel:[0,1] op_sel_hi:[1,1]
    v_pk_mul_f32 v[52:53], v[52:53], v[148:149]
    v_pk_mul_f32 v[54:55], v[54:55], v[150:151]
    v_cvt_pk_bf16_f32 v174, v52, v53
    v_cvt_pk_bf16_f32 v175, v54, v55
    buffer_store_dwordx4 v[172:175], v249, s[48:51], s71 offen sc1
    v_pk_fma_f32 v[40:41], v[184:185], v[164:165], v[40:41] op_sel:[0,0,0] op_sel_hi:[1,0,1] neg_lo:[0,1,0] neg_hi:[0,1,0]
    v_pk_fma_f32 v[42:43], v[186:187], v[164:165], v[42:43] op_sel:[0,0,0] op_sel_hi:[1,0,1] neg_lo:[0,1,0] neg_hi:[0,1,0]
    v_pk_fma_f32 v[136:137], v[192:193], v[164:165], v[136:137] op_sel:[0,0,0] op_sel_hi:[1,0,1] neg_lo:[0,1,0] neg_hi:[0,1,0]
    v_pk_fma_f32 v[138:139], v[194:195], v[164:165], v[138:139] op_sel:[0,0,0] op_sel_hi:[1,0,1] neg_lo:[0,1,0] neg_hi:[0,1,0]
    v_max_f32 v40, 0, v40
    v_max_f32 v41, 0, v41
    v_max_f32 v42, 0, v42
    v_max_f32 v43, 0, v43
    v_pk_mul_f32 v[136:137], v[136:137], v[164:165] op_sel:[0,1] op_sel_hi:[1,1]
    v_pk_mul_f32 v[138:139], v[138:139], v[164:165] op_sel:[0,1] op_sel_hi:[1,1]
    v_pk_mul_f32 v[40:41], v[40:41], v[136:137]
    v_pk_mul_f32 v[42:43], v[42:43], v[138:139]
    v_cvt_pk_bf16_f32 v168, v40, v41
    v_cvt_pk_bf16_f32 v169, v42, v43
    v_pk_fma_f32 v[56:57], v[188:189], v[164:165], v[56:57] op_sel:[0,0,0] op_sel_hi:[1,0,1] neg_lo:[0,1,0] neg_hi:[0,1,0]
    v_pk_fma_f32 v[58:59], v[190:191], v[164:165], v[58:59] op_sel:[0,0,0] op_sel_hi:[1,0,1] neg_lo:[0,1,0] neg_hi:[0,1,0]
    v_pk_fma_f32 v[152:153], v[196:197], v[164:165], v[152:153] op_sel:[0,0,0] op_sel_hi:[1,0,1] neg_lo:[0,1,0] neg_hi:[0,1,0]
    v_pk_fma_f32 v[154:155], v[198:199], v[164:165], v[154:155] op_sel:[0,0,0] op_sel_hi:[1,0,1] neg_lo:[0,1,0] neg_hi:[0,1,0]
    v_max_f32 v56, 0, v56
    v_max_f32 v57, 0, v57
    v_max_f32 v58, 0, v58
    v_max_f32 v59, 0, v59
    v_pk_mul_f32 v[152:153], v[152:153], v[164:165] op_sel:[0,1] op_sel_hi:[1,1]
    v_pk_mul_f32 v[154:155], v[154:155], v[164:165] op_sel:[0,1] op_sel_hi:[1,1]
    v_pk_mul_f32 v[56:57], v[56:57], v[152:153]
    v_pk_mul_f32 v[58:59], v[58:59], v[154:155]
    v_cvt_pk_bf16_f32 v170, v56, v57
    v_cvt_pk_bf16_f32 v171, v58, v59
    buffer_store_dwordx4 v[168:171], v250, s[48:51], s71 offen sc1
    v_pk_fma_f32 v[44:45], v[184:185], v[166:167], v[44:45] op_sel:[0,0,0] op_sel_hi:[1,0,1] neg_lo:[0,1,0] neg_hi:[0,1,0]
    v_pk_fma_f32 v[46:47], v[186:187], v[166:167], v[46:47] op_sel:[0,0,0] op_sel_hi:[1,0,1] neg_lo:[0,1,0] neg_hi:[0,1,0]
    v_pk_fma_f32 v[140:141], v[192:193], v[166:167], v[140:141] op_sel:[0,0,0] op_sel_hi:[1,0,1] neg_lo:[0,1,0] neg_hi:[0,1,0]
    v_pk_fma_f32 v[142:143], v[194:195], v[166:167], v[142:143] op_sel:[0,0,0] op_sel_hi:[1,0,1] neg_lo:[0,1,0] neg_hi:[0,1,0]
    v_max_f32 v44, 0, v44
    v_max_f32 v45, 0, v45
    v_max_f32 v46, 0, v46
    v_max_f32 v47, 0, v47
    v_pk_mul_f32 v[140:141], v[140:141], v[166:167] op_sel:[0,1] op_sel_hi:[1,1]
    v_pk_mul_f32 v[142:143], v[142:143], v[166:167] op_sel:[0,1] op_sel_hi:[1,1]
    v_pk_mul_f32 v[44:45], v[44:45], v[140:141]
    v_pk_mul_f32 v[46:47], v[46:47], v[142:143]
    v_cvt_pk_bf16_f32 v172, v44, v45
    v_cvt_pk_bf16_f32 v173, v46, v47
    v_pk_fma_f32 v[60:61], v[188:189], v[166:167], v[60:61] op_sel:[0,0,0] op_sel_hi:[1,0,1] neg_lo:[0,1,0] neg_hi:[0,1,0]
    v_pk_fma_f32 v[62:63], v[190:191], v[166:167], v[62:63] op_sel:[0,0,0] op_sel_hi:[1,0,1] neg_lo:[0,1,0] neg_hi:[0,1,0]
    v_pk_fma_f32 v[156:157], v[196:197], v[166:167], v[156:157] op_sel:[0,0,0] op_sel_hi:[1,0,1] neg_lo:[0,1,0] neg_hi:[0,1,0]
    v_pk_fma_f32 v[158:159], v[198:199], v[166:167], v[158:159] op_sel:[0,0,0] op_sel_hi:[1,0,1] neg_lo:[0,1,0] neg_hi:[0,1,0]
    v_max_f32 v60, 0, v60
    v_max_f32 v61, 0, v61
    v_max_f32 v62, 0, v62
    v_max_f32 v63, 0, v63
    v_pk_mul_f32 v[156:157], v[156:157], v[166:167] op_sel:[0,1] op_sel_hi:[1,1]
    v_pk_mul_f32 v[158:159], v[158:159], v[166:167] op_sel:[0,1] op_sel_hi:[1,1]
    v_pk_mul_f32 v[60:61], v[60:61], v[156:157]
    v_pk_mul_f32 v[62:63], v[62:63], v[158:159]
    v_cvt_pk_bf16_f32 v174, v60, v61
    v_cvt_pk_bf16_f32 v175, v62, v63
    buffer_store_dwordx4 v[172:175], v251, s[48:51], s71 offen sc1
    v_mov_b32 v160, 0x3f803f80
    v_mov_b32 v161, 0x3f803f80
    v_mov_b32 v162, 0x3f803f80
    v_mov_b32 v163, 0x3f803f80
    s_barrier
    ds_read_b64 v[184:185], v235 offset:0
    ds_read_b64 v[204:205], v252 offset:256
    ds_read_b64 v[186:187], v235 offset:512
    ds_read_b64 v[210:211], v252 offset:768
    ds_read_b64 v[188:189], v235 offset:1024
    ds_read_b64 v[216:217], v252 offset:1280
    ds_read_b64 v[190:191], v235 offset:1536
    ds_read_b64 v[222:223], v252 offset:1792
    v_max3_f32 v136, v96, v97, v98
    v_max3_f32 v138, v104, v105, v106
    v_max3_f32 v140, v112, v113, v114
    v_max3_f32 v142, v120, v121, v122
    v_max3_f32 v137, v99, v100, v101
    v_max3_f32 v139, v107, v108, v109
    v_max3_f32 v141, v115, v116, v117
    v_max3_f32 v143, v123, v124, v125
    v_max3_f32 v136, v136, v102, v103
    v_max3_f32 v138, v138, v110, v111
    v_max3_f32 v140, v140, v118, v119
    v_max3_f32 v142, v142, v126, v127
    v_max_f32 v136, v136, v137
    v_max_f32 v138, v138, v139
    v_max_f32 v140, v140, v141
    v_max_f32 v142, v142, v143
    v_mov_b32 v137, v136
    v_mov_b32 v139, v138
    v_mov_b32 v141, v140
    v_mov_b32 v143, v142
    s_nop 0
    v_permlane32_swap_b32 v136, v137
    v_permlane32_swap_b32 v138, v139
    v_permlane32_swap_b32 v140, v141
    v_permlane32_swap_b32 v142, v143
    v_max_f32 v136, v136, v137
    v_max_f32 v138, v138, v139
    v_max_f32 v140, v140, v141
    v_max_f32 v142, v142, v143
    v_mov_b32 v137, v136
    v_mov_b32 v139, v138
    v_mov_b32 v141, v140
    v_mov_b32 v143, v142
    s_nop 0
    v_permlane16_swap_b32 v136, v137
    v_permlane16_swap_b32 v138, v139
    v_permlane16_swap_b32 v140, v141
    v_permlane16_swap_b32 v142, v143
    v_max_f32 v136, v136, v137
    v_max_f32 v138, v138, v139
    v_max_f32 v140, v140, v141
    v_max_f32 v142, v142, v143
    v_pk_add_f32 v[96:97], v[96:97], v[136:137] op_sel_hi:[1,0] neg_lo:[0,1] neg_hi:[0,1]
    v_pk_add_f32 v[98:99], v[98:99], v[136:137] op_sel_hi:[1,0] neg_lo:[0,1] neg_hi:[0,1]
    v_pk_add_f32 v[100:101], v[100:101], v[136:137] op_sel_hi:[1,0] neg_lo:[0,1] neg_hi:[0,1]
    v_pk_add_f32 v[102:103], v[102:103], v[136:137] op_sel_hi:[1,0] neg_lo:[0,1] neg_hi:[0,1]
    v_pk_add_f32 v[104:105], v[104:105], v[138:139] op_sel_hi:[1,0] neg_lo:[0,1] neg_hi:[0,1]
    v_pk_add_f32 v[106:107], v[106:107], v[138:139] op_sel_hi:[1,0] neg_lo:[0,1] neg_hi:[0,1]
    v_pk_add_f32 v[108:109], v[108:109], v[138:139] op_sel_hi:[1,0] neg_lo:[0,1] neg_hi:[0,1]
    v_pk_add_f32 v[110:111], v[110:111], v[138:139] op_sel_hi:[1,0] neg_lo:[0,1] neg_hi:[0,1]
    v_pk_add_f32 v[112:113], v[112:113], v[140:141] op_sel_hi:[1,0] neg_lo:[0,1] neg_hi:[0,1]
    v_pk_add_f32 v[114:115], v[114:115], v[140:141] op_sel_hi:[1,0] neg_lo:[0,1] neg_hi:[0,1]
    v_pk_add_f32 v[116:117], v[116:117], v[140:141] op_sel_hi:[1,0] neg_lo:[0,1] neg_hi:[0,1]
    v_pk_add_f32 v[118:119], v[118:119], v[140:141] op_sel_hi:[1,0] neg_lo:[0,1] neg_hi:[0,1]
    v_pk_add_f32 v[120:121], v[120:121], v[142:143] op_sel_hi:[1,0] neg_lo:[0,1] neg_hi:[0,1]
    v_pk_add_f32 v[122:123], v[122:123], v[142:143] op_sel_hi:[1,0] neg_lo:[0,1] neg_hi:[0,1]
    v_pk_add_f32 v[124:125], v[124:125], v[142:143] op_sel_hi:[1,0] neg_lo:[0,1] neg_hi:[0,1]
    v_pk_add_f32 v[126:127], v[126:127], v[142:143] op_sel_hi:[1,0] neg_lo:[0,1] neg_hi:[0,1]
    v_exp_f32 v96, v96
    s_waitcnt lgkmcnt(0)
    v_mfma_f32_16x16x16_bf16 v[32:35], v[184:185], v[0:1], v[244:247]
    v_exp_f32 v97, v97
    v_exp_f32 v98, v98
    v_exp_f32 v99, v99
    v_mfma_f32_16x16x16_bf16 v[36:39], v[64:65], v[0:1], v[236:239]
    v_exp_f32 v100, v100
    v_exp_f32 v101, v101
    v_exp_f32 v102, v102
    v_mfma_f32_16x16x16_bf16 v[40:43], v[188:189], v[16:17], v[244:247]
    v_exp_f32 v103, v103
    v_exp_f32 v104, v104
    v_exp_f32 v105, v105
    v_mfma_f32_16x16x16_bf16 v[44:47], v[80:81], v[16:17], v[236:239]
    v_exp_f32 v106, v106
    v_exp_f32 v107, v107
    v_exp_f32 v108, v108
    v_mfma_f32_16x16x16_bf16 v[48:51], v[186:187], v[4:5], v[244:247]
    v_exp_f32 v109, v109
    v_exp_f32 v110, v110
    v_exp_f32 v111, v111
    v_mfma_f32_16x16x16_bf16 v[52:55], v[68:69], v[4:5], v[236:239]
    v_exp_f32 v112, v112
    v_exp_f32 v113, v113
    v_exp_f32 v114, v114
    v_mfma_f32_16x16x16_bf16 v[56:59], v[190:191], v[20:21], v[244:247]
    v_exp_f32 v115, v115
    v_exp_f32 v116, v116
    v_exp_f32 v117, v117
    v_mfma_f32_16x16x16_bf16 v[60:63], v[84:85], v[20:21], v[236:239]
    v_exp_f32 v118, v118
    v_exp_f32 v119, v119
    v_exp_f32 v120, v120
    v_exp_f32 v121, v121
    v_exp_f32 v122, v122
    v_exp_f32 v123, v123
    v_exp_f32 v124, v124
    v_exp_f32 v125, v125
    v_exp_f32 v126, v126
    v_exp_f32 v127, v127
    v_cvt_pk_bf16_f32 v144, v96, v97
    v_cvt_pk_bf16_f32 v145, v98, v99
    v_cvt_pk_bf16_f32 v146, v100, v101
    v_cvt_pk_bf16_f32 v147, v102, v103
    v_cvt_pk_bf16_f32 v148, v104, v105
    v_cvt_pk_bf16_f32 v149, v106, v107
    v_cvt_pk_bf16_f32 v150, v108, v109
    v_cvt_pk_bf16_f32 v151, v110, v111
    v_cvt_pk_bf16_f32 v152, v112, v113
    v_cvt_pk_bf16_f32 v153, v114, v115
    v_cvt_pk_bf16_f32 v154, v116, v117
    v_cvt_pk_bf16_f32 v155, v118, v119
    v_cvt_pk_bf16_f32 v156, v120, v121
    v_cvt_pk_bf16_f32 v157, v122, v123
    v_cvt_pk_bf16_f32 v158, v124, v125
    v_cvt_pk_bf16_f32 v159, v126, v127
    v_max3_f32 v128, v32, v33, v34
    v_max3_f32 v130, v40, v41, v42
    v_max3_f32 v132, v48, v49, v50
    v_max3_f32 v134, v56, v57, v58
    v_max3_f32 v129, v35, v36, v37
    v_max3_f32 v131, v43, v44, v45
    v_max3_f32 v133, v51, v52, v53
    v_max3_f32 v135, v59, v60, v61
    v_max3_f32 v128, v128, v38, v39
    v_max3_f32 v130, v130, v46, v47
    v_max3_f32 v132, v132, v54, v55
    v_max3_f32 v134, v134, v62, v63
    v_max_f32 v128, v128, v129
    v_max_f32 v130, v130, v131
    v_max_f32 v132, v132, v133
    v_max_f32 v134, v134, v135
    v_mov_b32 v129, v128
    v_mov_b32 v131, v130
    v_mov_b32 v133, v132
    v_mov_b32 v135, v134
    s_nop 0
    v_permlane32_swap_b32 v128, v129
    v_permlane32_swap_b32 v130, v131
    v_permlane32_swap_b32 v132, v133
    v_permlane32_swap_b32 v134, v135
    v_max_f32 v128, v128, v129
    v_max_f32 v130, v130, v131
    v_max_f32 v132, v132, v133
    v_max_f32 v134, v134, v135
    v_mov_b32 v129, v128
    v_mov_b32 v131, v130
    v_mov_b32 v133, v132
    v_mov_b32 v135, v134
    s_nop 0
    v_permlane16_swap_b32 v128, v129
    v_permlane16_swap_b32 v130, v131
    v_permlane16_swap_b32 v132, v133
    v_permlane16_swap_b32 v134, v135
    v_max_f32 v128, v128, v129
    v_max_f32 v130, v130, v131
    v_max_f32 v132, v132, v133
    v_max_f32 v134, v134, v135
    v_pk_add_f32 v[32:33], v[32:33], v[128:129] op_sel_hi:[1,0] neg_lo:[0,1] neg_hi:[0,1]
    v_pk_add_f32 v[34:35], v[34:35], v[128:129] op_sel_hi:[1,0] neg_lo:[0,1] neg_hi:[0,1]
    v_pk_add_f32 v[36:37], v[36:37], v[128:129] op_sel_hi:[1,0] neg_lo:[0,1] neg_hi:[0,1]
    v_pk_add_f32 v[38:39], v[38:39], v[128:129] op_sel_hi:[1,0] neg_lo:[0,1] neg_hi:[0,1]
    v_pk_add_f32 v[40:41], v[40:41], v[130:131] op_sel_hi:[1,0] neg_lo:[0,1] neg_hi:[0,1]
    v_pk_add_f32 v[42:43], v[42:43], v[130:131] op_sel_hi:[1,0] neg_lo:[0,1] neg_hi:[0,1]
    v_pk_add_f32 v[44:45], v[44:45], v[130:131] op_sel_hi:[1,0] neg_lo:[0,1] neg_hi:[0,1]
    v_pk_add_f32 v[46:47], v[46:47], v[130:131] op_sel_hi:[1,0] neg_lo:[0,1] neg_hi:[0,1]
    v_pk_add_f32 v[48:49], v[48:49], v[132:133] op_sel_hi:[1,0] neg_lo:[0,1] neg_hi:[0,1]
    v_pk_add_f32 v[50:51], v[50:51], v[132:133] op_sel_hi:[1,0] neg_lo:[0,1] neg_hi:[0,1]
    v_pk_add_f32 v[52:53], v[52:53], v[132:133] op_sel_hi:[1,0] neg_lo:[0,1] neg_hi:[0,1]
    v_pk_add_f32 v[54:55], v[54:55], v[132:133] op_sel_hi:[1,0] neg_lo:[0,1] neg_hi:[0,1]
    v_pk_add_f32 v[56:57], v[56:57], v[134:135] op_sel_hi:[1,0] neg_lo:[0,1] neg_hi:[0,1]
    v_pk_add_f32 v[58:59], v[58:59], v[134:135] op_sel_hi:[1,0] neg_lo:[0,1] neg_hi:[0,1]
    v_pk_add_f32 v[60:61], v[60:61], v[134:135] op_sel_hi:[1,0] neg_lo:[0,1] neg_hi:[0,1]
    v_pk_add_f32 v[62:63], v[62:63], v[134:135] op_sel_hi:[1,0] neg_lo:[0,1] neg_hi:[0,1]
    v_exp_f32 v32, v32
    v_mfma_f32_16x16x32_bf16 v[96:99], v[206:209], v[144:147], 0
    v_exp_f32 v33, v33
    v_exp_f32 v34, v34
    v_exp_f32 v35, v35
    v_mfma_f32_16x16x32_bf16 v[100:103], v[160:163], v[144:147], 0
    v_exp_f32 v36, v36
    v_exp_f32 v37, v37
    v_exp_f32 v38, v38
    v_mfma_f32_16x16x32_bf16 v[104:107], v[218:221], v[148:151], 0
    v_exp_f32 v39, v39
    v_exp_f32 v40, v40
    v_exp_f32 v41, v41
    v_mfma_f32_16x16x32_bf16 v[108:111], v[160:163], v[148:151], 0
    v_exp_f32 v42, v42
    v_exp_f32 v43, v43
    v_exp_f32 v44, v44
    v_mfma_f32_16x16x32_bf16 v[112:115], v[212:215], v[152:155], 0
    v_exp_f32 v45, v45
    v_exp_f32 v46, v46
    v_exp_f32 v47, v47
    v_mfma_f32_16x16x32_bf16 v[116:119], v[160:163], v[152:155], 0
    v_exp_f32 v48, v48
    v_exp_f32 v49, v49
    v_exp_f32 v50, v50
    v_mfma_f32_16x16x32_bf16 v[120:123], v[224:227], v[156:159], 0
    v_exp_f32 v51, v51
    v_exp_f32 v52, v52
    v_exp_f32 v53, v53
    v_mfma_f32_16x16x32_bf16 v[124:127], v[160:163], v[156:159], 0
    v_exp_f32 v54, v54
    v_exp_f32 v55, v55
    v_exp_f32 v56, v56
    v_exp_f32 v57, v57
    v_exp_f32 v58, v58
    v_exp_f32 v59, v59
    v_exp_f32 v60, v60
    v_exp_f32 v61, v61
    v_exp_f32 v62, v62
    v_exp_f32 v63, v63
    v_cvt_pk_bf16_f32 v168, v32, v33
    v_cvt_pk_bf16_f32 v169, v34, v35
    v_cvt_pk_bf16_f32 v170, v36, v37
    v_cvt_pk_bf16_f32 v171, v38, v39
    v_cvt_pk_bf16_f32 v172, v40, v41
    v_cvt_pk_bf16_f32 v173, v42, v43
    v_cvt_pk_bf16_f32 v174, v44, v45
    v_cvt_pk_bf16_f32 v175, v46, v47
    v_cvt_pk_bf16_f32 v176, v48, v49
    v_cvt_pk_bf16_f32 v177, v50, v51
    v_cvt_pk_bf16_f32 v178, v52, v53
    v_cvt_pk_bf16_f32 v179, v54, v55
    v_cvt_pk_bf16_f32 v180, v56, v57
    v_cvt_pk_bf16_f32 v181, v58, v59
    v_cvt_pk_bf16_f32 v182, v60, v61
    v_cvt_pk_bf16_f32 v183, v62, v63
    s_nop 0
    v_mfma_f32_16x16x32_bf16 v[32:35], v[204:207], v[168:171], 0
    v_mfma_f32_16x16x32_bf16 v[36:39], v[160:163], v[168:171], 0
    v_mfma_f32_16x16x32_bf16 v[40:43], v[216:219], v[172:175], 0
    v_mfma_f32_16x16x32_bf16 v[44:47], v[160:163], v[172:175], 0
    v_mfma_f32_16x16x32_bf16 v[48:51], v[210:213], v[176:179], 0
    v_mfma_f32_16x16x32_bf16 v[52:55], v[160:163], v[176:179], 0
    v_mfma_f32_16x16x32_bf16 v[56:59], v[222:225], v[180:183], 0
    v_mfma_f32_16x16x32_bf16 v[60:63], v[160:163], v[180:183], 0
    v_rcp_f32 v136, v100
    v_rcp_f32 v138, v108
    v_rcp_f32 v140, v116
    v_rcp_f32 v142, v124
    s_nop 0
    v_pk_mul_f32 v[96:97], v[96:97], v[136:137] op_sel:[0,0] op_sel_hi:[1,0]
    v_pk_mul_f32 v[98:99], v[98:99], v[136:137] op_sel:[0,0] op_sel_hi:[1,0]
    v_pk_mul_f32 v[104:105], v[104:105], v[138:139] op_sel:[0,0] op_sel_hi:[1,0]
    v_pk_mul_f32 v[106:107], v[106:107], v[138:139] op_sel:[0,0] op_sel_hi:[1,0]
    v_pk_mul_f32 v[112:113], v[112:113], v[140:141] op_sel:[0,0] op_sel_hi:[1,0]
    v_pk_mul_f32 v[114:115], v[114:115], v[140:141] op_sel:[0,0] op_sel_hi:[1,0]
    v_pk_mul_f32 v[120:121], v[120:121], v[142:143] op_sel:[0,0] op_sel_hi:[1,0]
    v_pk_mul_f32 v[122:123], v[122:123], v[142:143] op_sel:[0,0] op_sel_hi:[1,0]
    v_cvt_pk_bf16_f32 v192, v96, v97
    v_cvt_pk_bf16_f32 v193, v98, v99
    v_cvt_pk_bf16_f32 v194, v104, v105
    v_cvt_pk_bf16_f32 v195, v106, v107
    buffer_store_dwordx4 v[192:195], v250, s[48:51], s72 offen sc1
    v_cvt_pk_bf16_f32 v196, v112, v113
    v_cvt_pk_bf16_f32 v197, v114, v115
    v_cvt_pk_bf16_f32 v198, v120, v121
    v_cvt_pk_bf16_f32 v199, v122, v123
    buffer_store_dwordx4 v[196:199], v251, s[48:51], s72 offen sc1
    v_rcp_f32 v128, v36
    v_rcp_f32 v130, v44
    v_rcp_f32 v132, v52
    v_rcp_f32 v134, v60
    s_nop 0
    v_pk_mul_f32 v[32:33], v[32:33], v[128:129] op_sel:[0,0] op_sel_hi:[1,0]
    v_pk_mul_f32 v[34:35], v[34:35], v[128:129] op_sel:[0,0] op_sel_hi:[1,0]
    v_pk_mul_f32 v[40:41], v[40:41], v[130:131] op_sel:[0,0] op_sel_hi:[1,0]
    v_pk_mul_f32 v[42:43], v[42:43], v[130:131] op_sel:[0,0] op_sel_hi:[1,0]
    v_pk_mul_f32 v[48:49], v[48:49], v[132:133] op_sel:[0,0] op_sel_hi:[1,0]
    v_pk_mul_f32 v[50:51], v[50:51], v[132:133] op_sel:[0,0] op_sel_hi:[1,0]
    v_pk_mul_f32 v[56:57], v[56:57], v[134:135] op_sel:[0,0] op_sel_hi:[1,0]
    v_pk_mul_f32 v[58:59], v[58:59], v[134:135] op_sel:[0,0] op_sel_hi:[1,0]
    v_cvt_pk_bf16_f32 v192, v32, v33
    v_cvt_pk_bf16_f32 v193, v34, v35
    v_cvt_pk_bf16_f32 v194, v40, v41
    v_cvt_pk_bf16_f32 v195, v42, v43
    buffer_store_dwordx4 v[192:195], v248, s[48:51], s72 offen sc1
    v_cvt_pk_bf16_f32 v196, v48, v49
    v_cvt_pk_bf16_f32 v197, v50, v51
    v_cvt_pk_bf16_f32 v198, v56, v57
    v_cvt_pk_bf16_f32 v199, v58, v59
    buffer_store_dwordx4 v[196:199], v249, s[48:51], s72 offen sc1
    s_branch L_CW
L_CB:
    v_and_b32 v8, 15, v230
    v_lshrrev_b32 v9, 4, v230
    s_lshr_b32 s67, s60, 1
    s_and_b32 s68, s60, 1
    s_lshl_b32 s69, s67, 8
    s_add_u32 s69, s69, 152832
    v_lshl_add_u32 v231, v8, 2, s69
    v_lshl_add_u32 v232, v9, 4, s69
    s_lshl_b32 s69, s68, 7
    s_add_u32 s69, s69, 151552
    v_lshl_add_u32 v233, v9, 4, s69
    v_lshl_add_u32 v234, v8, 2, s69
    s_lshl_b32 s75, s61, 1
    s_add_u32 s75, s75, s67
    s_mul_i32 s75, s75, 368640
    s_and_b32 s69, s62, 7
    s_mul_i32 s69, s69, 5
    s_add_u32 s69, s69, 16
    s_and_b32 s70, s62, 1
    s_add_u32 s71, s69, s70
    s_add_u32 s71, s71, s68
    s_mul_i32 s71, s71, 5120
    s_add_u32 s71, s71, s75
    s_xor_b32 s70, s70, 1
    s_lshl_b32 s70, s70, 2
    s_add_u32 s72, s69, s70
    s_mul_i32 s72, s72, 5120
    s_add_u32 s72, s72, s75
    s_cmp_eq_u32 s68, 1
    s_cselect_b64 vcc, -1, 0
    v_cndmask_b32 v238, v248, v250, vcc
    v_cndmask_b32 v239, v249, v251, vcc
    s_add_u32 s73, s71, 10240
    s_lshl_b32 s69, s67, 12
    s_add_u32 s69, s69, 153984
    s_lshl_b32 s70, s68, 3
    v_lshl_add_u32 v236, v230, 4, s69
    s_lshl_b32 s69, s68, 11
    v_add_u32 v237, s69, v236
    v_add_u32 v236, s70, v236
    v_mov_b32 v0, 0
    v_mov_b32 v1, 0
    v_mov_b32 v2, 0
    v_mov_b32 v3, 0
    v_mov_b32 v4, 0
    v_mov_b32 v5, 0
    v_mov_b32 v6, 0
    v_mov_b32 v7, 0
    v_mov_b32 v8, 0
    v_mov_b32 v9, 0
    v_mov_b32 v10, 0
    v_mov_b32 v11, 0
    v_mov_b32 v12, 0
    v_mov_b32 v13, 0
    v_mov_b32 v14, 0
    v_mov_b32 v15, 0
    v_mov_b32 v16, 0
    v_mov_b32 v17, 0
    v_mov_b32 v18, 0
    v_mov_b32 v19, 0
    v_mov_b32 v20, 0
    v_mov_b32 v21, 0
    v_mov_b32 v22, 0
    v_mov_b32 v23, 0
    v_mov_b32 v24, 0
    v_mov_b32 v25, 0
    v_mov_b32 v26, 0
    v_mov_b32 v27, 0
    v_mov_b32 v28, 0
    v_mov_b32 v29, 0
    v_mov_b32 v30, 0
    v_mov_b32 v31, 0
    v_mov_b32 v32, 0
    v_mov_b32 v33, 0
    v_mov_b32 v34, 0
    v_mov_b32 v35, 0
    v_mov_b32 v36, 0
    v_mov_b32 v37, 0
    v_mov_b32 v38, 0
    v_mov_b32 v39, 0
    v_mov_b32 v40, 0
    v_mov_b32 v41, 0
    v_mov_b32 v42, 0
    v_mov_b32 v43, 0
    v_mov_b32 v44, 0
    v_mov_b32 v45, 0
    v_mov_b32 v46, 0
    v_mov_b32 v47, 0
    v_mov_b32 v48, 0
    v_mov_b32 v49, 0
    v_mov_b32 v50, 0
    v_mov_b32 v51, 0
    v_mov_b32 v52, 0
    v_mov_b32 v53, 0
    v_mov_b32 v54, 0
    v_mov_b32 v55, 0
    v_mov_b32 v56, 0
    v_mov_b32 v57, 0
    v_mov_b32 v58, 0
    v_mov_b32 v59, 0
    v_mov_b32 v60, 0
    v_mov_b32 v61, 0
    v_mov_b32 v62, 0
    v_mov_b32 v63, 0
    v_mov_b32 v64, 0
    v_mov_b32 v65, 0
    v_mov_b32 v66, 0
    v_mov_b32 v67, 0
    v_mov_b32 v68, 0
    v_mov_b32 v69, 0
    v_mov_b32 v70, 0
    v_mov_b32 v71, 0
    v_mov_b32 v72, 0
    v_mov_b32 v73, 0
    v_mov_b32 v74, 0
    v_mov_b32 v75, 0
    v_mov_b32 v76, 0
    v_mov_b32 v77, 0
    v_mov_b32 v78, 0
    v_mov_b32 v79, 0
    v_mov_b32 v80, 0
    v_mov_b32 v81, 0
    v_mov_b32 v82, 0
    v_mov_b32 v83, 0
    v_mov_b32 v84, 0
    v_mov_b32 v85, 0
    v_mov_b32 v86, 0
    v_mov_b32 v87, 0
    v_mov_b32 v88, 0
    v_mov_b32 v89, 0
    v_mov_b32 v90, 0
    v_mov_b32 v91, 0
    v_mov_b32 v92, 0
    v_mov_b32 v93, 0
    v_mov_b32 v94, 0
    v_mov_b32 v95, 0
    v_mov_b32 v96, 0
    v_mov_b32 v97, 0
    v_mov_b32 v98, 0
    v_mov_b32 v99, 0
    v_mov_b32 v100, 0
    v_mov_b32 v101, 0
    v_mov_b32 v102, 0
    v_mov_b32 v103, 0
    v_mov_b32 v104, 0
    v_mov_b32 v105, 0
    v_mov_b32 v106, 0
    v_mov_b32 v107, 0
    v_mov_b32 v108, 0
    v_mov_b32 v109, 0
    v_mov_b32 v110, 0
    v_mov_b32 v111, 0
    v_mov_b32 v112, 0
    v_mov_b32 v113, 0
    v_mov_b32 v114, 0
    v_mov_b32 v115, 0
    v_mov_b32 v116, 0
    v_mov_b32 v117, 0
    v_mov_b32 v118, 0
    v_mov_b32 v119, 0
    v_mov_b32 v120, 0
    v_mov_b32 v121, 0
    v_mov_b32 v122, 0
    v_mov_b32 v123, 0
    v_mov_b32 v124, 0
    v_mov_b32 v125, 0
    v_mov_b32 v126, 0
    v_mov_b32 v127, 0
    v_mov_b32 v128, 0
    v_mov_b32 v129, 0
    v_mov_b32 v130, 0
    v_mov_b32 v131, 0
    v_mov_b32 v132, 0
    v_mov_b32 v133, 0
    v_mov_b32 v134, 0
    v_mov_b32 v135, 0
    v_mov_b32 v136, 0
    v_mov_b32 v137, 0
    v_mov_b32 v138, 0
    v_mov_b32 v139, 0
    v_mov_b32 v140, 0
    v_mov_b32 v141, 0
    v_mov_b32 v142, 0
    v_mov_b32 v143, 0
    v_mov_b32 v144, 0
    v_mov_b32 v145, 0
    v_mov_b32 v146, 0
    v_mov_b32 v147, 0
    v_mov_b32 v148, 0
    v_mov_b32 v149, 0
    v_mov_b32 v150, 0
    v_mov_b32 v151, 0
    v_mov_b32 v152, 0
    v_mov_b32 v153, 0
    v_mov_b32 v154, 0
    v_mov_b32 v155, 0
    v_mov_b32 v156, 0
    v_mov_b32 v157, 0
    v_mov_b32 v158, 0
    v_mov_b32 v159, 0
    s_barrier
    ds_read_b64_tr_b16 v[192:193], v224 offset:0
    ds_read_b64_tr_b16 v[194:195], v224 offset:512
    ds_read_b64_tr_b16 v[196:197], v224 offset:4096
    ds_read_b64_tr_b16 v[198:199], v224 offset:4608
    ds_read_b128 v[160:163], v228 offset:0
    ds_read_b128 v[164:167], v229 offset:0
    ds_read_b64_tr_b16 v[200:201], v225 offset:0
    ds_read_b64_tr_b16 v[202:203], v225 offset:512
    ds_read_b64_tr_b16 v[204:205], v225 offset:4096
    ds_read_b64_tr_b16 v[206:207], v225 offset:4608
    ds_read_b128 v[168:171], v228 offset:2048
    ds_read_b128 v[172:175], v229 offset:2048
    ds_read_b128 v[176:179], v228 offset:4096
    ds_read_b128 v[180:183], v229 offset:4096
    ds_read_b128 v[184:187], v228 offset:6144
    ds_read_b128 v[188:191], v229 offset:6144
    s_mov_b32 s98, 0
    .p2alignl 3, 0xBF800000
L_ckB:
    s_waitcnt lgkmcnt(6)
    v_mfma_f32_16x16x32_bf16 v[0:3], v[192:195], v[160:163], v[0:3]
    ds_read_b64_tr_b16 v[208:209], v224 offset:8192
    v_mfma_f32_16x16x32_bf16 v[0:3], v[196:199], v[164:167], v[0:3]
    ds_read_b64_tr_b16 v[210:211], v224 offset:8704
    v_mfma_f32_16x16x32_bf16 v[16:19], v[200:203], v[160:163], v[16:19]
    ds_read_b64_tr_b16 v[212:213], v224 offset:12288
    v_mfma_f32_16x16x32_bf16 v[16:19], v[204:207], v[164:167], v[16:19]
    ds_read_b64_tr_b16 v[214:215], v224 offset:12800
    s_waitcnt lgkmcnt(8)
    v_mfma_f32_16x16x32_bf16 v[4:7], v[192:195], v[168:171], v[4:7]
    ds_read_b64_tr_b16 v[216:217], v225 offset:8192
    v_mfma_f32_16x16x32_bf16 v[4:7], v[196:199], v[172:175], v[4:7]
    ds_read_b64_tr_b16 v[218:219], v225 offset:8704
    v_mfma_f32_16x16x32_bf16 v[20:23], v[200:203], v[168:171], v[20:23]
    ds_read_b64_tr_b16 v[220:221], v225 offset:12288
    v_mfma_f32_16x16x32_bf16 v[20:23], v[204:207], v[172:175], v[20:23]
    ds_read_b64_tr_b16 v[222:223], v225 offset:12800
    s_waitcnt lgkmcnt(10)
    v_mfma_f32_16x16x32_bf16 v[8:11], v[192:195], v[176:179], v[8:11]
    v_mfma_f32_16x16x32_bf16 v[8:11], v[196:199], v[180:183], v[8:11]
    v_mfma_f32_16x16x32_bf16 v[24:27], v[200:203], v[176:179], v[24:27]
    v_mfma_f32_16x16x32_bf16 v[24:27], v[204:207], v[180:183], v[24:27]
    s_waitcnt lgkmcnt(8)
    v_mfma_f32_16x16x32_bf16 v[12:15], v[192:195], v[184:187], v[12:15]
    v_mfma_f32_16x16x32_bf16 v[12:15], v[196:199], v[188:191], v[12:15]
    v_mfma_f32_16x16x32_bf16 v[28:31], v[200:203], v[184:187], v[28:31]
    v_mfma_f32_16x16x32_bf16 v[28:31], v[204:207], v[188:191], v[28:31]
    s_waitcnt lgkmcnt(0)
    s_barrier
    v_mfma_f32_16x16x32_bf16 v[32:35], v[208:211], v[160:163], v[32:35]
    ds_read_b64_tr_b16 v[192:193], v224 offset:16384
    v_mfma_f32_16x16x32_bf16 v[32:35], v[212:215], v[164:167], v[32:35]
    ds_read_b64_tr_b16 v[194:195], v224 offset:16896
    v_mfma_f32_16x16x32_bf16 v[48:51], v[216:219], v[160:163], v[48:51]
    ds_read_b64_tr_b16 v[196:197], v224 offset:20480
    v_mfma_f32_16x16x32_bf16 v[48:51], v[220:223], v[164:167], v[48:51]
    ds_read_b64_tr_b16 v[198:199], v224 offset:20992
    v_mfma_f32_16x16x32_bf16 v[36:39], v[208:211], v[168:171], v[36:39]
    ds_read_b64_tr_b16 v[200:201], v225 offset:16384
    v_mfma_f32_16x16x32_bf16 v[36:39], v[212:215], v[172:175], v[36:39]
    ds_read_b64_tr_b16 v[202:203], v225 offset:16896
    v_mfma_f32_16x16x32_bf16 v[52:55], v[216:219], v[168:171], v[52:55]
    ds_read_b64_tr_b16 v[204:205], v225 offset:20480
    v_mfma_f32_16x16x32_bf16 v[52:55], v[220:223], v[172:175], v[52:55]
    ds_read_b64_tr_b16 v[206:207], v225 offset:20992
    v_mfma_f32_16x16x32_bf16 v[40:43], v[208:211], v[176:179], v[40:43]
    v_mfma_f32_16x16x32_bf16 v[40:43], v[212:215], v[180:183], v[40:43]
    v_mfma_f32_16x16x32_bf16 v[56:59], v[216:219], v[176:179], v[56:59]
    v_mfma_f32_16x16x32_bf16 v[56:59], v[220:223], v[180:183], v[56:59]
    v_mfma_f32_16x16x32_bf16 v[44:47], v[208:211], v[184:187], v[44:47]
    v_mfma_f32_16x16x32_bf16 v[44:47], v[212:215], v[188:191], v[44:47]
    v_mfma_f32_16x16x32_bf16 v[60:63], v[216:219], v[184:187], v[60:63]
    v_mfma_f32_16x16x32_bf16 v[60:63], v[220:223], v[188:191], v[60:63]
    s_waitcnt lgkmcnt(0)
    v_mfma_f32_16x16x32_bf16 v[64:67], v[192:195], v[160:163], v[64:67]
    ds_read_b64_tr_b16 v[208:209], v224 offset:24576
    v_mfma_f32_16x16x32_bf16 v[64:67], v[196:199], v[164:167], v[64:67]
    ds_read_b64_tr_b16 v[210:211], v224 offset:25088
    v_mfma_f32_16x16x32_bf16 v[80:83], v[200:203], v[160:163], v[80:83]
    ds_read_b64_tr_b16 v[212:213], v224 offset:28672
    v_mfma_f32_16x16x32_bf16 v[80:83], v[204:207], v[164:167], v[80:83]
    ds_read_b64_tr_b16 v[214:215], v224 offset:29184
    v_mfma_f32_16x16x32_bf16 v[68:71], v[192:195], v[168:171], v[68:71]
    ds_read_b64_tr_b16 v[216:217], v225 offset:24576
    v_mfma_f32_16x16x32_bf16 v[68:71], v[196:199], v[172:175], v[68:71]
    ds_read_b64_tr_b16 v[218:219], v225 offset:25088
    v_mfma_f32_16x16x32_bf16 v[84:87], v[200:203], v[168:171], v[84:87]
    ds_read_b64_tr_b16 v[220:221], v225 offset:28672
    v_mfma_f32_16x16x32_bf16 v[84:87], v[204:207], v[172:175], v[84:87]
    ds_read_b64_tr_b16 v[222:223], v225 offset:29184
    v_mfma_f32_16x16x32_bf16 v[72:75], v[192:195], v[176:179], v[72:75]
    v_mfma_f32_16x16x32_bf16 v[72:75], v[196:199], v[180:183], v[72:75]
    v_mfma_f32_16x16x32_bf16 v[88:91], v[200:203], v[176:179], v[88:91]
    v_mfma_f32_16x16x32_bf16 v[88:91], v[204:207], v[180:183], v[88:91]
    v_mfma_f32_16x16x32_bf16 v[76:79], v[192:195], v[184:187], v[76:79]
    v_mfma_f32_16x16x32_bf16 v[76:79], v[196:199], v[188:191], v[76:79]
    v_mfma_f32_16x16x32_bf16 v[92:95], v[200:203], v[184:187], v[92:95]
    v_mfma_f32_16x16x32_bf16 v[92:95], v[204:207], v[188:191], v[92:95]
    s_waitcnt lgkmcnt(0)
    v_mfma_f32_16x16x32_bf16 v[96:99], v[208:211], v[160:163], v[96:99]
    ds_read_b64_tr_b16 v[192:193], v224 offset:32768
    v_mfma_f32_16x16x32_bf16 v[96:99], v[212:215], v[164:167], v[96:99]
    ds_read_b64_tr_b16 v[194:195], v224 offset:33280
    v_mfma_f32_16x16x32_bf16 v[112:115], v[216:219], v[160:163], v[112:115]
    ds_read_b64_tr_b16 v[196:197], v224 offset:36864
    v_mfma_f32_16x16x32_bf16 v[112:115], v[220:223], v[164:167], v[112:115]
    ds_read_b64_tr_b16 v[198:199], v224 offset:37376
    v_mfma_f32_16x16x32_bf16 v[100:103], v[208:211], v[168:171], v[100:103]
    ds_read_b64_tr_b16 v[200:201], v225 offset:32768
    v_mfma_f32_16x16x32_bf16 v[100:103], v[212:215], v[172:175], v[100:103]
    ds_read_b64_tr_b16 v[202:203], v225 offset:33280
    v_mfma_f32_16x16x32_bf16 v[116:119], v[216:219], v[168:171], v[116:119]
    ds_read_b64_tr_b16 v[204:205], v225 offset:36864
    v_mfma_f32_16x16x32_bf16 v[116:119], v[220:223], v[172:175], v[116:119]
    ds_read_b64_tr_b16 v[206:207], v225 offset:37376
    v_mfma_f32_16x16x32_bf16 v[104:107], v[208:211], v[176:179], v[104:107]
    v_mfma_f32_16x16x32_bf16 v[104:107], v[212:215], v[180:183], v[104:107]
    v_mfma_f32_16x16x32_bf16 v[120:123], v[216:219], v[176:179], v[120:123]
    v_mfma_f32_16x16x32_bf16 v[120:123], v[220:223], v[180:183], v[120:123]
    v_mfma_f32_16x16x32_bf16 v[108:111], v[208:211], v[184:187], v[108:111]
    v_mfma_f32_16x16x32_bf16 v[108:111], v[212:215], v[188:191], v[108:111]
    v_mfma_f32_16x16x32_bf16 v[124:127], v[216:219], v[184:187], v[124:127]
    v_mfma_f32_16x16x32_bf16 v[124:127], v[220:223], v[188:191], v[124:127]
    s_waitcnt lgkmcnt(0)
    s_barrier
    v_mfma_f32_16x16x32_bf16 v[128:131], v[192:195], v[160:163], v[128:131]
    ds_read_b64_tr_b16 v[208:209], v226 offset:8192
    v_mfma_f32_16x16x32_bf16 v[128:131], v[196:199], v[164:167], v[128:131]
    ds_read_b64_tr_b16 v[210:211], v226 offset:8704
    v_mfma_f32_16x16x32_bf16 v[144:147], v[200:203], v[160:163], v[144:147]
    ds_read_b64_tr_b16 v[212:213], v226 offset:12288
    v_mfma_f32_16x16x32_bf16 v[144:147], v[204:207], v[164:167], v[144:147]
    ds_read_b64_tr_b16 v[214:215], v226 offset:12800
    ds_read_b128 v[160:163], v228 offset:16384
    ds_read_b128 v[164:167], v229 offset:16384
    v_mfma_f32_16x16x32_bf16 v[132:135], v[192:195], v[168:171], v[132:135]
    ds_read_b64_tr_b16 v[216:217], v227 offset:8192
    v_mfma_f32_16x16x32_bf16 v[132:135], v[196:199], v[172:175], v[132:135]
    ds_read_b64_tr_b16 v[218:219], v227 offset:8704
    v_mfma_f32_16x16x32_bf16 v[148:151], v[200:203], v[168:171], v[148:151]
    ds_read_b64_tr_b16 v[220:221], v227 offset:12288
    v_mfma_f32_16x16x32_bf16 v[148:151], v[204:207], v[172:175], v[148:151]
    ds_read_b64_tr_b16 v[222:223], v227 offset:12800
    ds_read_b128 v[168:171], v228 offset:18432
    ds_read_b128 v[172:175], v229 offset:18432
    v_mfma_f32_16x16x32_bf16 v[136:139], v[192:195], v[176:179], v[136:139]
    v_mfma_f32_16x16x32_bf16 v[136:139], v[196:199], v[180:183], v[136:139]
    v_mfma_f32_16x16x32_bf16 v[152:155], v[200:203], v[176:179], v[152:155]
    v_mfma_f32_16x16x32_bf16 v[152:155], v[204:207], v[180:183], v[152:155]
    ds_read_b128 v[176:179], v228 offset:20480
    ds_read_b128 v[180:183], v229 offset:20480
    v_mfma_f32_16x16x32_bf16 v[140:143], v[192:195], v[184:187], v[140:143]
    v_mfma_f32_16x16x32_bf16 v[140:143], v[196:199], v[188:191], v[140:143]
    v_mfma_f32_16x16x32_bf16 v[156:159], v[200:203], v[184:187], v[156:159]
    v_mfma_f32_16x16x32_bf16 v[156:159], v[204:207], v[188:191], v[156:159]
    ds_read_b128 v[184:187], v228 offset:22528
    ds_read_b128 v[188:191], v229 offset:22528
    s_waitcnt lgkmcnt(6)
    v_mfma_f32_16x16x32_bf16 v[0:3], v[208:211], v[160:163], v[0:3]
    ds_read_b64_tr_b16 v[192:193], v226 offset:16384
    v_mfma_f32_16x16x32_bf16 v[0:3], v[212:215], v[164:167], v[0:3]
    ds_read_b64_tr_b16 v[194:195], v226 offset:16896
    v_mfma_f32_16x16x32_bf16 v[16:19], v[216:219], v[160:163], v[16:19]
    ds_read_b64_tr_b16 v[196:197], v226 offset:20480
    v_mfma_f32_16x16x32_bf16 v[16:19], v[220:223], v[164:167], v[16:19]
    ds_read_b64_tr_b16 v[198:199], v226 offset:20992
    s_waitcnt lgkmcnt(8)
    v_mfma_f32_16x16x32_bf16 v[4:7], v[208:211], v[168:171], v[4:7]
    ds_read_b64_tr_b16 v[200:201], v227 offset:16384
    v_mfma_f32_16x16x32_bf16 v[4:7], v[212:215], v[172:175], v[4:7]
    ds_read_b64_tr_b16 v[202:203], v227 offset:16896
    v_mfma_f32_16x16x32_bf16 v[20:23], v[216:219], v[168:171], v[20:23]
    ds_read_b64_tr_b16 v[204:205], v227 offset:20480
    v_mfma_f32_16x16x32_bf16 v[20:23], v[220:223], v[172:175], v[20:23]
    ds_read_b64_tr_b16 v[206:207], v227 offset:20992
    s_waitcnt lgkmcnt(10)
    v_mfma_f32_16x16x32_bf16 v[8:11], v[208:211], v[176:179], v[8:11]
    v_mfma_f32_16x16x32_bf16 v[8:11], v[212:215], v[180:183], v[8:11]
    v_mfma_f32_16x16x32_bf16 v[24:27], v[216:219], v[176:179], v[24:27]
    v_mfma_f32_16x16x32_bf16 v[24:27], v[220:223], v[180:183], v[24:27]
    s_waitcnt lgkmcnt(8)
    v_mfma_f32_16x16x32_bf16 v[12:15], v[208:211], v[184:187], v[12:15]
    v_mfma_f32_16x16x32_bf16 v[12:15], v[212:215], v[188:191], v[12:15]
    v_mfma_f32_16x16x32_bf16 v[28:31], v[216:219], v[184:187], v[28:31]
    v_mfma_f32_16x16x32_bf16 v[28:31], v[220:223], v[188:191], v[28:31]
    s_waitcnt lgkmcnt(0)
    s_barrier
    v_mfma_f32_16x16x32_bf16 v[32:35], v[192:195], v[160:163], v[32:35]
    ds_read_b64_tr_b16 v[208:209], v226 offset:24576
    v_mfma_f32_16x16x32_bf16 v[32:35], v[196:199], v[164:167], v[32:35]
    ds_read_b64_tr_b16 v[210:211], v226 offset:25088
    v_mfma_f32_16x16x32_bf16 v[48:51], v[200:203], v[160:163], v[48:51]
    ds_read_b64_tr_b16 v[212:213], v226 offset:28672
    v_mfma_f32_16x16x32_bf16 v[48:51], v[204:207], v[164:167], v[48:51]
    ds_read_b64_tr_b16 v[214:215], v226 offset:29184
    v_mfma_f32_16x16x32_bf16 v[36:39], v[192:195], v[168:171], v[36:39]
    ds_read_b64_tr_b16 v[216:217], v227 offset:24576
    v_mfma_f32_16x16x32_bf16 v[36:39], v[196:199], v[172:175], v[36:39]
    ds_read_b64_tr_b16 v[218:219], v227 offset:25088
    v_mfma_f32_16x16x32_bf16 v[52:55], v[200:203], v[168:171], v[52:55]
    ds_read_b64_tr_b16 v[220:221], v227 offset:28672
    v_mfma_f32_16x16x32_bf16 v[52:55], v[204:207], v[172:175], v[52:55]
    ds_read_b64_tr_b16 v[222:223], v227 offset:29184
    v_mfma_f32_16x16x32_bf16 v[40:43], v[192:195], v[176:179], v[40:43]
    v_mfma_f32_16x16x32_bf16 v[40:43], v[196:199], v[180:183], v[40:43]
    v_mfma_f32_16x16x32_bf16 v[56:59], v[200:203], v[176:179], v[56:59]
    v_mfma_f32_16x16x32_bf16 v[56:59], v[204:207], v[180:183], v[56:59]
    v_mfma_f32_16x16x32_bf16 v[44:47], v[192:195], v[184:187], v[44:47]
    v_mfma_f32_16x16x32_bf16 v[44:47], v[196:199], v[188:191], v[44:47]
    v_mfma_f32_16x16x32_bf16 v[60:63], v[200:203], v[184:187], v[60:63]
    v_mfma_f32_16x16x32_bf16 v[60:63], v[204:207], v[188:191], v[60:63]
    s_waitcnt lgkmcnt(0)
    s_cmp_lg_u32 s98, 0
    s_cbranch_scc1 L_ckB_nt
    s_mov_b64 exec, s[86:87]
    buffer_load_dword v253, v253, s[76:79], 0 offen
    s_mov_b64 exec, -1
    s_nop 0
L_ckB_nt:
    v_mfma_f32_16x16x32_bf16 v[64:67], v[208:211], v[160:163], v[64:67]
    ds_read_b64_tr_b16 v[192:193], v226 offset:32768
    v_mfma_f32_16x16x32_bf16 v[64:67], v[212:215], v[164:167], v[64:67]
    ds_read_b64_tr_b16 v[194:195], v226 offset:33280
    v_mfma_f32_16x16x32_bf16 v[80:83], v[216:219], v[160:163], v[80:83]
    ds_read_b64_tr_b16 v[196:197], v226 offset:36864
    v_mfma_f32_16x16x32_bf16 v[80:83], v[220:223], v[164:167], v[80:83]
    ds_read_b64_tr_b16 v[198:199], v226 offset:37376
    v_mfma_f32_16x16x32_bf16 v[68:71], v[208:211], v[168:171], v[68:71]
    ds_read_b64_tr_b16 v[200:201], v227 offset:32768
    v_mfma_f32_16x16x32_bf16 v[68:71], v[212:215], v[172:175], v[68:71]
    ds_read_b64_tr_b16 v[202:203], v227 offset:33280
    v_mfma_f32_16x16x32_bf16 v[84:87], v[216:219], v[168:171], v[84:87]
    ds_read_b64_tr_b16 v[204:205], v227 offset:36864
    v_mfma_f32_16x16x32_bf16 v[84:87], v[220:223], v[172:175], v[84:87]
    ds_read_b64_tr_b16 v[206:207], v227 offset:37376
    v_mfma_f32_16x16x32_bf16 v[72:75], v[208:211], v[176:179], v[72:75]
    v_mfma_f32_16x16x32_bf16 v[72:75], v[212:215], v[180:183], v[72:75]
    v_mfma_f32_16x16x32_bf16 v[88:91], v[216:219], v[176:179], v[88:91]
    v_mfma_f32_16x16x32_bf16 v[88:91], v[220:223], v[180:183], v[88:91]
    v_mfma_f32_16x16x32_bf16 v[76:79], v[208:211], v[184:187], v[76:79]
    v_mfma_f32_16x16x32_bf16 v[76:79], v[212:215], v[188:191], v[76:79]
    v_mfma_f32_16x16x32_bf16 v[92:95], v[216:219], v[184:187], v[92:95]
    v_mfma_f32_16x16x32_bf16 v[92:95], v[220:223], v[188:191], v[92:95]
    s_waitcnt lgkmcnt(0)
    v_mfma_f32_16x16x32_bf16 v[96:99], v[192:195], v[160:163], v[96:99]
    ds_read_b64_tr_b16 v[208:209], v226 offset:0
    v_mfma_f32_16x16x32_bf16 v[96:99], v[196:199], v[164:167], v[96:99]
    ds_read_b64_tr_b16 v[210:211], v226 offset:512
    v_mfma_f32_16x16x32_bf16 v[112:115], v[200:203], v[160:163], v[112:115]
    ds_read_b64_tr_b16 v[212:213], v226 offset:4096
    v_mfma_f32_16x16x32_bf16 v[112:115], v[204:207], v[164:167], v[112:115]
    ds_read_b64_tr_b16 v[214:215], v226 offset:4608
    v_mfma_f32_16x16x32_bf16 v[100:103], v[192:195], v[168:171], v[100:103]
    ds_read_b64_tr_b16 v[216:217], v227 offset:0
    v_mfma_f32_16x16x32_bf16 v[100:103], v[196:199], v[172:175], v[100:103]
    ds_read_b64_tr_b16 v[218:219], v227 offset:512
    v_mfma_f32_16x16x32_bf16 v[116:119], v[200:203], v[168:171], v[116:119]
    ds_read_b64_tr_b16 v[220:221], v227 offset:4096
    v_mfma_f32_16x16x32_bf16 v[116:119], v[204:207], v[172:175], v[116:119]
    ds_read_b64_tr_b16 v[222:223], v227 offset:4608
    v_mfma_f32_16x16x32_bf16 v[104:107], v[192:195], v[176:179], v[104:107]
    v_mfma_f32_16x16x32_bf16 v[104:107], v[196:199], v[180:183], v[104:107]
    v_mfma_f32_16x16x32_bf16 v[120:123], v[200:203], v[176:179], v[120:123]
    v_mfma_f32_16x16x32_bf16 v[120:123], v[204:207], v[180:183], v[120:123]
    v_mfma_f32_16x16x32_bf16 v[108:111], v[192:195], v[184:187], v[108:111]
    v_mfma_f32_16x16x32_bf16 v[108:111], v[196:199], v[188:191], v[108:111]
    v_mfma_f32_16x16x32_bf16 v[124:127], v[200:203], v[184:187], v[124:127]
    v_mfma_f32_16x16x32_bf16 v[124:127], v[204:207], v[188:191], v[124:127]
    s_waitcnt lgkmcnt(0)
    s_barrier
    s_cmp_eq_u32 s98, 3
    s_cbranch_scc1 L_ckB_last
    v_mfma_f32_16x16x32_bf16 v[128:131], v[208:211], v[160:163], v[128:131]
    ds_read_b64_tr_b16 v[192:193], v224 offset:0
    v_mfma_f32_16x16x32_bf16 v[128:131], v[212:215], v[164:167], v[128:131]
    ds_read_b64_tr_b16 v[194:195], v224 offset:512
    v_mfma_f32_16x16x32_bf16 v[144:147], v[216:219], v[160:163], v[144:147]
    ds_read_b64_tr_b16 v[196:197], v224 offset:4096
    v_mfma_f32_16x16x32_bf16 v[144:147], v[220:223], v[164:167], v[144:147]
    ds_read_b64_tr_b16 v[198:199], v224 offset:4608
    ds_read_b128 v[160:163], v228 offset:0
    ds_read_b128 v[164:167], v229 offset:0
    v_mfma_f32_16x16x32_bf16 v[132:135], v[208:211], v[168:171], v[132:135]
    ds_read_b64_tr_b16 v[200:201], v225 offset:0
    v_mfma_f32_16x16x32_bf16 v[132:135], v[212:215], v[172:175], v[132:135]
    ds_read_b64_tr_b16 v[202:203], v225 offset:512
    v_mfma_f32_16x16x32_bf16 v[148:151], v[216:219], v[168:171], v[148:151]
    ds_read_b64_tr_b16 v[204:205], v225 offset:4096
    v_mfma_f32_16x16x32_bf16 v[148:151], v[220:223], v[172:175], v[148:151]
    ds_read_b64_tr_b16 v[206:207], v225 offset:4608
    ds_read_b128 v[168:171], v228 offset:2048
    ds_read_b128 v[172:175], v229 offset:2048
    v_mfma_f32_16x16x32_bf16 v[136:139], v[208:211], v[176:179], v[136:139]
    v_mfma_f32_16x16x32_bf16 v[136:139], v[212:215], v[180:183], v[136:139]
    v_mfma_f32_16x16x32_bf16 v[152:155], v[216:219], v[176:179], v[152:155]
    v_mfma_f32_16x16x32_bf16 v[152:155], v[220:223], v[180:183], v[152:155]
    ds_read_b128 v[176:179], v228 offset:4096
    ds_read_b128 v[180:183], v229 offset:4096
    v_mfma_f32_16x16x32_bf16 v[140:143], v[208:211], v[184:187], v[140:143]
    v_mfma_f32_16x16x32_bf16 v[140:143], v[212:215], v[188:191], v[140:143]
    v_mfma_f32_16x16x32_bf16 v[156:159], v[216:219], v[184:187], v[156:159]
    v_mfma_f32_16x16x32_bf16 v[156:159], v[220:223], v[188:191], v[156:159]
    ds_read_b128 v[184:187], v228 offset:6144
    ds_read_b128 v[188:191], v229 offset:6144
    s_add_u32 s98, s98, 1
    s_branch L_ckB
    .p2alignl 3, 0xBF800000
L_ckB_last:
    v_mfma_f32_16x16x32_bf16 v[128:131], v[208:211], v[160:163], v[128:131]
    ds_read_b128 v[192:195], v233 offset:1024
    v_mfma_f32_16x16x32_bf16 v[128:131], v[212:215], v[164:167], v[128:131]
    ds_read_b128 v[196:199], v233 offset:1088
    v_mfma_f32_16x16x32_bf16 v[144:147], v[216:219], v[160:163], v[144:147]
    ds_read_b128 v[200:203], v233 offset:0
    v_mfma_f32_16x16x32_bf16 v[144:147], v[220:223], v[164:167], v[144:147]
    ds_read_b128 v[204:207], v233 offset:64
    ds_read2_b32 v[160:161], v231 offset0:0 offset1:144
    ds_read2_b32 v[162:163], v231 offset0:16 offset1:160
    ds_read2_b32 v[164:165], v231 offset0:32 offset1:176
    ds_read2_b32 v[166:167], v231 offset0:48 offset1:192
    v_mfma_f32_16x16x32_bf16 v[132:135], v[208:211], v[168:171], v[132:135]
    v_mfma_f32_16x16x32_bf16 v[132:135], v[212:215], v[172:175], v[132:135]
    v_mfma_f32_16x16x32_bf16 v[148:151], v[216:219], v[168:171], v[148:151]
    v_mfma_f32_16x16x32_bf16 v[148:151], v[220:223], v[172:175], v[148:151]
    ds_read_b128 v[168:171], v233 offset:256
    ds_read_b128 v[172:175], v233 offset:320
    v_mfma_f32_16x16x32_bf16 v[136:139], v[208:211], v[176:179], v[136:139]
    v_mfma_f32_16x16x32_bf16 v[136:139], v[212:215], v[180:183], v[136:139]
    v_mfma_f32_16x16x32_bf16 v[152:155], v[216:219], v[176:179], v[152:155]
    v_mfma_f32_16x16x32_bf16 v[152:155], v[220:223], v[180:183], v[152:155]
    ds_read_b128 v[176:179], v233 offset:512
    ds_read_b128 v[180:183], v233 offset:576
    v_mfma_f32_16x16x32_bf16 v[140:143], v[208:211], v[184:187], v[140:143]
    v_mfma_f32_16x16x32_bf16 v[140:143], v[212:215], v[188:191], v[140:143]
    v_mfma_f32_16x16x32_bf16 v[156:159], v[216:219], v[184:187], v[156:159]
    v_mfma_f32_16x16x32_bf16 v[156:159], v[220:223], v[188:191], v[156:159]
    ds_read_b128 v[184:187], v233 offset:768
    ds_read_b128 v[188:191], v233 offset:832
    s_waitcnt lgkmcnt(4)
    v_mul_f32 v161, v161, v161
    v_mul_f32 v163, v163, v163
    v_mul_f32 v165, v165, v165
    v_mul_f32 v167, v167, v167
    .p2alignl 3, 0xBF800000
    v_pk_fma_f32 v[0:1], v[200:201], v[160:161], v[0:1] op_sel:[0,0,0] op_sel_hi:[1,0,1] neg_lo:[0,1,0] neg_hi:[0,1,0]
    v_pk_fma_f32 v[2:3], v[202:203], v[160:161], v[2:3] op_sel:[0,0,0] op_sel_hi:[1,0,1] neg_lo:[0,1,0] neg_hi:[0,1,0]
    v_pk_fma_f32 v[32:33], v[168:169], v[160:161], v[32:33] op_sel:[0,0,0] op_sel_hi:[1,0,1] neg_lo:[0,1,0] neg_hi:[0,1,0]
    v_pk_fma_f32 v[34:35], v[170:171], v[160:161], v[34:35] op_sel:[0,0,0] op_sel_hi:[1,0,1] neg_lo:[0,1,0] neg_hi:[0,1,0]
    v_max_f32 v0, 0, v0
    v_max_f32 v1, 0, v1
    v_max_f32 v2, 0, v2
    v_max_f32 v3, 0, v3
    v_pk_mul_f32 v[32:33], v[32:33], v[160:161] op_sel:[0,1] op_sel_hi:[1,1]
    v_pk_mul_f32 v[34:35], v[34:35], v[160:161] op_sel:[0,1] op_sel_hi:[1,1]
    v_pk_mul_f32 v[0:1], v[0:1], v[32:33]
    v_pk_mul_f32 v[2:3], v[2:3], v[34:35]
    v_cvt_pk_bf16_f32 v0, v0, v1
    v_cvt_pk_bf16_f32 v1, v2, v3
    v_pk_fma_f32 v[16:17], v[204:205], v[160:161], v[16:17] op_sel:[0,0,0] op_sel_hi:[1,0,1] neg_lo:[0,1,0] neg_hi:[0,1,0]
    v_pk_fma_f32 v[18:19], v[206:207], v[160:161], v[18:19] op_sel:[0,0,0] op_sel_hi:[1,0,1] neg_lo:[0,1,0] neg_hi:[0,1,0]
    v_pk_fma_f32 v[48:49], v[172:173], v[160:161], v[48:49] op_sel:[0,0,0] op_sel_hi:[1,0,1] neg_lo:[0,1,0] neg_hi:[0,1,0]
    v_pk_fma_f32 v[50:51], v[174:175], v[160:161], v[50:51] op_sel:[0,0,0] op_sel_hi:[1,0,1] neg_lo:[0,1,0] neg_hi:[0,1,0]
    v_max_f32 v16, 0, v16
    v_max_f32 v17, 0, v17
    v_max_f32 v18, 0, v18
    v_max_f32 v19, 0, v19
    v_pk_mul_f32 v[48:49], v[48:49], v[160:161] op_sel:[0,1] op_sel_hi:[1,1]
    v_pk_mul_f32 v[50:51], v[50:51], v[160:161] op_sel:[0,1] op_sel_hi:[1,1]
    v_pk_mul_f32 v[16:17], v[16:17], v[48:49]
    v_pk_mul_f32 v[18:19], v[18:19], v[50:51]
    v_cvt_pk_bf16_f32 v2, v16, v17
    v_cvt_pk_bf16_f32 v3, v18, v19
    buffer_store_dwordx4 v[0:3], v248, s[48:51], s71 offen sc1
    v_pk_fma_f32 v[4:5], v[200:201], v[162:163], v[4:5] op_sel:[0,0,0] op_sel_hi:[1,0,1] neg_lo:[0,1,0] neg_hi:[0,1,0]
    v_pk_fma_f32 v[6:7], v[202:203], v[162:163], v[6:7] op_sel:[0,0,0] op_sel_hi:[1,0,1] neg_lo:[0,1,0] neg_hi:[0,1,0]
    v_pk_fma_f32 v[36:37], v[168:169], v[162:163], v[36:37] op_sel:[0,0,0] op_sel_hi:[1,0,1] neg_lo:[0,1,0] neg_hi:[0,1,0]
    v_pk_fma_f32 v[38:39], v[170:171], v[162:163], v[38:39] op_sel:[0,0,0] op_sel_hi:[1,0,1] neg_lo:[0,1,0] neg_hi:[0,1,0]
    v_max_f32 v4, 0, v4
    v_max_f32 v5, 0, v5
    v_max_f32 v6, 0, v6
    v_max_f32 v7, 0, v7
    v_pk_mul_f32 v[36:37], v[36:37], v[162:163] op_sel:[0,1] op_sel_hi:[1,1]
    v_pk_mul_f32 v[38:39], v[38:39], v[162:163] op_sel:[0,1] op_sel_hi:[1,1]
    v_pk_mul_f32 v[4:5], v[4:5], v[36:37]
    v_pk_mul_f32 v[6:7], v[6:7], v[38:39]
    v_cvt_pk_bf16_f32 v4, v4, v5
    v_cvt_pk_bf16_f32 v5, v6, v7
    v_pk_fma_f32 v[20:21], v[204:205], v[162:163], v[20:21] op_sel:[0,0,0] op_sel_hi:[1,0,1] neg_lo:[0,1,0] neg_hi:[0,1,0]
    v_pk_fma_f32 v[22:23], v[206:207], v[162:163], v[22:23] op_sel:[0,0,0] op_sel_hi:[1,0,1] neg_lo:[0,1,0] neg_hi:[0,1,0]
    v_pk_fma_f32 v[52:53], v[172:173], v[162:163], v[52:53] op_sel:[0,0,0] op_sel_hi:[1,0,1] neg_lo:[0,1,0] neg_hi:[0,1,0]
    v_pk_fma_f32 v[54:55], v[174:175], v[162:163], v[54:55] op_sel:[0,0,0] op_sel_hi:[1,0,1] neg_lo:[0,1,0] neg_hi:[0,1,0]
    v_max_f32 v20, 0, v20
    v_max_f32 v21, 0, v21
    v_max_f32 v22, 0, v22
    v_max_f32 v23, 0, v23
    v_pk_mul_f32 v[52:53], v[52:53], v[162:163] op_sel:[0,1] op_sel_hi:[1,1]
    v_pk_mul_f32 v[54:55], v[54:55], v[162:163] op_sel:[0,1] op_sel_hi:[1,1]
    v_pk_mul_f32 v[20:21], v[20:21], v[52:53]
    v_pk_mul_f32 v[22:23], v[22:23], v[54:55]
    v_cvt_pk_bf16_f32 v6, v20, v21
    v_cvt_pk_bf16_f32 v7, v22, v23
    buffer_store_dwordx4 v[4:7], v249, s[48:51], s71 offen sc1
    v_pk_fma_f32 v[128:129], v[192:193], v[160:161], v[128:129] op_sel:[0,0,0] op_sel_hi:[1,0,1] neg_lo:[0,1,0] neg_hi:[0,1,0]
    v_pk_fma_f32 v[130:131], v[194:195], v[160:161], v[130:131] op_sel:[0,0,0] op_sel_hi:[1,0,1] neg_lo:[0,1,0] neg_hi:[0,1,0]
    v_pk_fma_f32 v[144:145], v[196:197], v[160:161], v[144:145] op_sel:[0,0,0] op_sel_hi:[1,0,1] neg_lo:[0,1,0] neg_hi:[0,1,0]
    v_pk_fma_f32 v[146:147], v[198:199], v[160:161], v[146:147] op_sel:[0,0,0] op_sel_hi:[1,0,1] neg_lo:[0,1,0] neg_hi:[0,1,0]
    v_max_f32 v128, 0, v128
    v_max_f32 v129, 0, v129
    v_max_f32 v130, 0, v130
    v_max_f32 v131, 0, v131
    v_pk_mul_f32 v[144:145], v[144:145], v[160:161] op_sel:[0,1] op_sel_hi:[1,1]
    v_pk_mul_f32 v[146:147], v[146:147], v[160:161] op_sel:[0,1] op_sel_hi:[1,1]
    v_pk_mul_f32 v[128:129], v[128:129], v[144:145]
    v_pk_mul_f32 v[130:131], v[130:131], v[146:147]
    v_cvt_pk_bf16_f32 v216, v128, v129
    v_cvt_pk_bf16_f32 v217, v130, v131
    ds_write_b64 v236, v[216:217] offset:0
    v_pk_fma_f32 v[132:133], v[192:193], v[162:163], v[132:133] op_sel:[0,0,0] op_sel_hi:[1,0,1] neg_lo:[0,1,0] neg_hi:[0,1,0]
    v_pk_fma_f32 v[134:135], v[194:195], v[162:163], v[134:135] op_sel:[0,0,0] op_sel_hi:[1,0,1] neg_lo:[0,1,0] neg_hi:[0,1,0]
    v_pk_fma_f32 v[148:149], v[196:197], v[162:163], v[148:149] op_sel:[0,0,0] op_sel_hi:[1,0,1] neg_lo:[0,1,0] neg_hi:[0,1,0]
    v_pk_fma_f32 v[150:151], v[198:199], v[162:163], v[150:151] op_sel:[0,0,0] op_sel_hi:[1,0,1] neg_lo:[0,1,0] neg_hi:[0,1,0]
    v_max_f32 v132, 0, v132
    v_max_f32 v133, 0, v133
    v_max_f32 v134, 0, v134
    v_max_f32 v135, 0, v135
    v_pk_mul_f32 v[148:149], v[148:149], v[162:163] op_sel:[0,1] op_sel_hi:[1,1]
    v_pk_mul_f32 v[150:151], v[150:151], v[162:163] op_sel:[0,1] op_sel_hi:[1,1]
    v_pk_mul_f32 v[132:133], v[132:133], v[148:149]
    v_pk_mul_f32 v[134:135], v[134:135], v[150:151]
    v_cvt_pk_bf16_f32 v218, v132, v133
    v_cvt_pk_bf16_f32 v219, v134, v135
    ds_write_b64 v236, v[218:219] offset:1024
    v_pk_fma_f32 v[136:137], v[192:193], v[164:165], v[136:137] op_sel:[0,0,0] op_sel_hi:[1,0,1] neg_lo:[0,1,0] neg_hi:[0,1,0]
    v_pk_fma_f32 v[138:139], v[194:195], v[164:165], v[138:139] op_sel:[0,0,0] op_sel_hi:[1,0,1] neg_lo:[0,1,0] neg_hi:[0,1,0]
    v_pk_fma_f32 v[152:153], v[196:197], v[164:165], v[152:153] op_sel:[0,0,0] op_sel_hi:[1,0,1] neg_lo:[0,1,0] neg_hi:[0,1,0]
    v_pk_fma_f32 v[154:155], v[198:199], v[164:165], v[154:155] op_sel:[0,0,0] op_sel_hi:[1,0,1] neg_lo:[0,1,0] neg_hi:[0,1,0]
    v_max_f32 v136, 0, v136
    v_max_f32 v137, 0, v137
    v_max_f32 v138, 0, v138
    v_max_f32 v139, 0, v139
    v_pk_mul_f32 v[152:153], v[152:153], v[164:165] op_sel:[0,1] op_sel_hi:[1,1]
    v_pk_mul_f32 v[154:155], v[154:155], v[164:165] op_sel:[0,1] op_sel_hi:[1,1]
    v_pk_mul_f32 v[136:137], v[136:137], v[152:153]
    v_pk_mul_f32 v[138:139], v[138:139], v[154:155]
    v_cvt_pk_bf16_f32 v220, v136, v137
    v_cvt_pk_bf16_f32 v221, v138, v139
    ds_write_b64 v236, v[220:221] offset:2048
    v_pk_fma_f32 v[140:141], v[192:193], v[166:167], v[140:141] op_sel:[0,0,0] op_sel_hi:[1,0,1] neg_lo:[0,1,0] neg_hi:[0,1,0]
    v_pk_fma_f32 v[142:143], v[194:195], v[166:167], v[142:143] op_sel:[0,0,0] op_sel_hi:[1,0,1] neg_lo:[0,1,0] neg_hi:[0,1,0]
    v_pk_fma_f32 v[156:157], v[196:197], v[166:167], v[156:157] op_sel:[0,0,0] op_sel_hi:[1,0,1] neg_lo:[0,1,0] neg_hi:[0,1,0]
    v_pk_fma_f32 v[158:159], v[198:199], v[166:167], v[158:159] op_sel:[0,0,0] op_sel_hi:[1,0,1] neg_lo:[0,1,0] neg_hi:[0,1,0]
    v_max_f32 v140, 0, v140
    v_max_f32 v141, 0, v141
    v_max_f32 v142, 0, v142
    v_max_f32 v143, 0, v143
    v_pk_mul_f32 v[156:157], v[156:157], v[166:167] op_sel:[0,1] op_sel_hi:[1,1]
    v_pk_mul_f32 v[158:159], v[158:159], v[166:167] op_sel:[0,1] op_sel_hi:[1,1]
    v_pk_mul_f32 v[140:141], v[140:141], v[156:157]
    v_pk_mul_f32 v[142:143], v[142:143], v[158:159]
    v_cvt_pk_bf16_f32 v222, v140, v141
    v_cvt_pk_bf16_f32 v223, v142, v143
    ds_write_b64 v236, v[222:223] offset:3072
    v_pk_fma_f32 v[8:9], v[200:201], v[164:165], v[8:9] op_sel:[0,0,0] op_sel_hi:[1,0,1] neg_lo:[0,1,0] neg_hi:[0,1,0]
    v_pk_fma_f32 v[10:11], v[202:203], v[164:165], v[10:11] op_sel:[0,0,0] op_sel_hi:[1,0,1] neg_lo:[0,1,0] neg_hi:[0,1,0]
    v_pk_fma_f32 v[40:41], v[168:169], v[164:165], v[40:41] op_sel:[0,0,0] op_sel_hi:[1,0,1] neg_lo:[0,1,0] neg_hi:[0,1,0]
    v_pk_fma_f32 v[42:43], v[170:171], v[164:165], v[42:43] op_sel:[0,0,0] op_sel_hi:[1,0,1] neg_lo:[0,1,0] neg_hi:[0,1,0]
    v_max_f32 v8, 0, v8
    v_max_f32 v9, 0, v9
    v_max_f32 v10, 0, v10
    v_max_f32 v11, 0, v11
    v_pk_mul_f32 v[40:41], v[40:41], v[164:165] op_sel:[0,1] op_sel_hi:[1,1]
    v_pk_mul_f32 v[42:43], v[42:43], v[164:165] op_sel:[0,1] op_sel_hi:[1,1]
    v_pk_mul_f32 v[8:9], v[8:9], v[40:41]
    v_pk_mul_f32 v[10:11], v[10:11], v[42:43]
    v_cvt_pk_bf16_f32 v8, v8, v9
    v_cvt_pk_bf16_f32 v9, v10, v11
    v_pk_fma_f32 v[24:25], v[204:205], v[164:165], v[24:25] op_sel:[0,0,0] op_sel_hi:[1,0,1] neg_lo:[0,1,0] neg_hi:[0,1,0]
    v_pk_fma_f32 v[26:27], v[206:207], v[164:165], v[26:27] op_sel:[0,0,0] op_sel_hi:[1,0,1] neg_lo:[0,1,0] neg_hi:[0,1,0]
    v_pk_fma_f32 v[56:57], v[172:173], v[164:165], v[56:57] op_sel:[0,0,0] op_sel_hi:[1,0,1] neg_lo:[0,1,0] neg_hi:[0,1,0]
    v_pk_fma_f32 v[58:59], v[174:175], v[164:165], v[58:59] op_sel:[0,0,0] op_sel_hi:[1,0,1] neg_lo:[0,1,0] neg_hi:[0,1,0]
    v_max_f32 v24, 0, v24
    v_max_f32 v25, 0, v25
    v_max_f32 v26, 0, v26
    v_max_f32 v27, 0, v27
    v_pk_mul_f32 v[56:57], v[56:57], v[164:165] op_sel:[0,1] op_sel_hi:[1,1]
    v_pk_mul_f32 v[58:59], v[58:59], v[164:165] op_sel:[0,1] op_sel_hi:[1,1]
    v_pk_mul_f32 v[24:25], v[24:25], v[56:57]
    v_pk_mul_f32 v[26:27], v[26:27], v[58:59]
    v_cvt_pk_bf16_f32 v10, v24, v25
    v_cvt_pk_bf16_f32 v11, v26, v27
    buffer_store_dwordx4 v[8:11], v250, s[48:51], s71 offen sc1
    v_pk_fma_f32 v[12:13], v[200:201], v[166:167], v[12:13] op_sel:[0,0,0] op_sel_hi:[1,0,1] neg_lo:[0,1,0] neg_hi:[0,1,0]
    v_pk_fma_f32 v[14:15], v[202:203], v[166:167], v[14:15] op_sel:[0,0,0] op_sel_hi:[1,0,1] neg_lo:[0,1,0] neg_hi:[0,1,0]
    v_pk_fma_f32 v[44:45], v[168:169], v[166:167], v[44:45] op_sel:[0,0,0] op_sel_hi:[1,0,1] neg_lo:[0,1,0] neg_hi:[0,1,0]
    v_pk_fma_f32 v[46:47], v[170:171], v[166:167], v[46:47] op_sel:[0,0,0] op_sel_hi:[1,0,1] neg_lo:[0,1,0] neg_hi:[0,1,0]
    v_max_f32 v12, 0, v12
    v_max_f32 v13, 0, v13
    v_max_f32 v14, 0, v14
    v_max_f32 v15, 0, v15
    v_pk_mul_f32 v[44:45], v[44:45], v[166:167] op_sel:[0,1] op_sel_hi:[1,1]
    v_pk_mul_f32 v[46:47], v[46:47], v[166:167] op_sel:[0,1] op_sel_hi:[1,1]
    v_pk_mul_f32 v[12:13], v[12:13], v[44:45]
    v_pk_mul_f32 v[14:15], v[14:15], v[46:47]
    v_cvt_pk_bf16_f32 v12, v12, v13
    v_cvt_pk_bf16_f32 v13, v14, v15
    v_pk_fma_f32 v[28:29], v[204:205], v[166:167], v[28:29] op_sel:[0,0,0] op_sel_hi:[1,0,1] neg_lo:[0,1,0] neg_hi:[0,1,0]
    v_pk_fma_f32 v[30:31], v[206:207], v[166:167], v[30:31] op_sel:[0,0,0] op_sel_hi:[1,0,1] neg_lo:[0,1,0] neg_hi:[0,1,0]
    v_pk_fma_f32 v[60:61], v[172:173], v[166:167], v[60:61] op_sel:[0,0,0] op_sel_hi:[1,0,1] neg_lo:[0,1,0] neg_hi:[0,1,0]
    v_pk_fma_f32 v[62:63], v[174:175], v[166:167], v[62:63] op_sel:[0,0,0] op_sel_hi:[1,0,1] neg_lo:[0,1,0] neg_hi:[0,1,0]
    v_max_f32 v28, 0, v28
    v_max_f32 v29, 0, v29
    v_max_f32 v30, 0, v30
    v_max_f32 v31, 0, v31
    v_pk_mul_f32 v[60:61], v[60:61], v[166:167] op_sel:[0,1] op_sel_hi:[1,1]
    v_pk_mul_f32 v[62:63], v[62:63], v[166:167] op_sel:[0,1] op_sel_hi:[1,1]
    v_pk_mul_f32 v[28:29], v[28:29], v[60:61]
    v_pk_mul_f32 v[30:31], v[30:31], v[62:63]
    v_cvt_pk_bf16_f32 v14, v28, v29
    v_cvt_pk_bf16_f32 v15, v30, v31
    buffer_store_dwordx4 v[12:15], v251, s[48:51], s71 offen sc1
    s_waitcnt lgkmcnt(0)
    s_barrier
    ds_read_b128 v[216:219], v237 offset:0
    ds_read_b128 v[220:223], v237 offset:1024
    v_pk_fma_f32 v[64:65], v[176:177], v[160:161], v[64:65] op_sel:[0,0,0] op_sel_hi:[1,0,1] neg_lo:[0,1,0] neg_hi:[0,1,0]
    v_pk_fma_f32 v[66:67], v[178:179], v[160:161], v[66:67] op_sel:[0,0,0] op_sel_hi:[1,0,1] neg_lo:[0,1,0] neg_hi:[0,1,0]
    v_pk_fma_f32 v[96:97], v[184:185], v[160:161], v[96:97] op_sel:[0,0,0] op_sel_hi:[1,0,1] neg_lo:[0,1,0] neg_hi:[0,1,0]
    v_pk_fma_f32 v[98:99], v[186:187], v[160:161], v[98:99] op_sel:[0,0,0] op_sel_hi:[1,0,1] neg_lo:[0,1,0] neg_hi:[0,1,0]
    v_max_f32 v64, 0, v64
    v_max_f32 v65, 0, v65
    v_max_f32 v66, 0, v66
    v_max_f32 v67, 0, v67
    v_pk_mul_f32 v[96:97], v[96:97], v[160:161] op_sel:[0,1] op_sel_hi:[1,1]
    v_pk_mul_f32 v[98:99], v[98:99], v[160:161] op_sel:[0,1] op_sel_hi:[1,1]
    v_pk_mul_f32 v[64:65], v[64:65], v[96:97]
    v_pk_mul_f32 v[66:67], v[66:67], v[98:99]
    v_cvt_pk_bf16_f32 v64, v64, v65
    v_cvt_pk_bf16_f32 v65, v66, v67
    v_pk_fma_f32 v[80:81], v[180:181], v[160:161], v[80:81] op_sel:[0,0,0] op_sel_hi:[1,0,1] neg_lo:[0,1,0] neg_hi:[0,1,0]
    v_pk_fma_f32 v[82:83], v[182:183], v[160:161], v[82:83] op_sel:[0,0,0] op_sel_hi:[1,0,1] neg_lo:[0,1,0] neg_hi:[0,1,0]
    v_pk_fma_f32 v[112:113], v[188:189], v[160:161], v[112:113] op_sel:[0,0,0] op_sel_hi:[1,0,1] neg_lo:[0,1,0] neg_hi:[0,1,0]
    v_pk_fma_f32 v[114:115], v[190:191], v[160:161], v[114:115] op_sel:[0,0,0] op_sel_hi:[1,0,1] neg_lo:[0,1,0] neg_hi:[0,1,0]
    v_max_f32 v80, 0, v80
    v_max_f32 v81, 0, v81
    v_max_f32 v82, 0, v82
    v_max_f32 v83, 0, v83
    v_pk_mul_f32 v[112:113], v[112:113], v[160:161] op_sel:[0,1] op_sel_hi:[1,1]
    v_pk_mul_f32 v[114:115], v[114:115], v[160:161] op_sel:[0,1] op_sel_hi:[1,1]
    v_pk_mul_f32 v[80:81], v[80:81], v[112:113]
    v_pk_mul_f32 v[82:83], v[82:83], v[114:115]
    v_cvt_pk_bf16_f32 v66, v80, v81
    v_cvt_pk_bf16_f32 v67, v82, v83
    buffer_store_dwordx4 v[64:67], v248, s[48:51], s73 offen sc1
    v_pk_fma_f32 v[68:69], v[176:177], v[162:163], v[68:69] op_sel:[0,0,0] op_sel_hi:[1,0,1] neg_lo:[0,1,0] neg_hi:[0,1,0]
    v_pk_fma_f32 v[70:71], v[178:179], v[162:163], v[70:71] op_sel:[0,0,0] op_sel_hi:[1,0,1] neg_lo:[0,1,0] neg_hi:[0,1,0]
    v_pk_fma_f32 v[100:101], v[184:185], v[162:163], v[100:101] op_sel:[0,0,0] op_sel_hi:[1,0,1] neg_lo:[0,1,0] neg_hi:[0,1,0]
    v_pk_fma_f32 v[102:103], v[186:187], v[162:163], v[102:103] op_sel:[0,0,0] op_sel_hi:[1,0,1] neg_lo:[0,1,0] neg_hi:[0,1,0]
    v_max_f32 v68, 0, v68
    v_max_f32 v69, 0, v69
    v_max_f32 v70, 0, v70
    v_max_f32 v71, 0, v71
    v_pk_mul_f32 v[100:101], v[100:101], v[162:163] op_sel:[0,1] op_sel_hi:[1,1]
    v_pk_mul_f32 v[102:103], v[102:103], v[162:163] op_sel:[0,1] op_sel_hi:[1,1]
    v_pk_mul_f32 v[68:69], v[68:69], v[100:101]
    v_pk_mul_f32 v[70:71], v[70:71], v[102:103]
    v_cvt_pk_bf16_f32 v68, v68, v69
    v_cvt_pk_bf16_f32 v69, v70, v71
    v_pk_fma_f32 v[84:85], v[180:181], v[162:163], v[84:85] op_sel:[0,0,0] op_sel_hi:[1,0,1] neg_lo:[0,1,0] neg_hi:[0,1,0]
    v_pk_fma_f32 v[86:87], v[182:183], v[162:163], v[86:87] op_sel:[0,0,0] op_sel_hi:[1,0,1] neg_lo:[0,1,0] neg_hi:[0,1,0]
    v_pk_fma_f32 v[116:117], v[188:189], v[162:163], v[116:117] op_sel:[0,0,0] op_sel_hi:[1,0,1] neg_lo:[0,1,0] neg_hi:[0,1,0]
    v_pk_fma_f32 v[118:119], v[190:191], v[162:163], v[118:119] op_sel:[0,0,0] op_sel_hi:[1,0,1] neg_lo:[0,1,0] neg_hi:[0,1,0]
    v_max_f32 v84, 0, v84
    v_max_f32 v85, 0, v85
    v_max_f32 v86, 0, v86
    v_max_f32 v87, 0, v87
    v_pk_mul_f32 v[116:117], v[116:117], v[162:163] op_sel:[0,1] op_sel_hi:[1,1]
    v_pk_mul_f32 v[118:119], v[118:119], v[162:163] op_sel:[0,1] op_sel_hi:[1,1]
    v_pk_mul_f32 v[84:85], v[84:85], v[116:117]
    v_pk_mul_f32 v[86:87], v[86:87], v[118:119]
    v_cvt_pk_bf16_f32 v70, v84, v85
    v_cvt_pk_bf16_f32 v71, v86, v87
    buffer_store_dwordx4 v[68:71], v249, s[48:51], s73 offen sc1
    s_waitcnt lgkmcnt(0)
    s_nop 0
    buffer_store_dwordx4 v[216:219], v238, s[48:51], s72 offen sc1
    buffer_store_dwordx4 v[220:223], v239, s[48:51], s72 offen sc1
    v_pk_fma_f32 v[72:73], v[176:177], v[164:165], v[72:73] op_sel:[0,0,0] op_sel_hi:[1,0,1] neg_lo:[0,1,0] neg_hi:[0,1,0]
    v_pk_fma_f32 v[74:75], v[178:179], v[164:165], v[74:75] op_sel:[0,0,0] op_sel_hi:[1,0,1] neg_lo:[0,1,0] neg_hi:[0,1,0]
    v_pk_fma_f32 v[104:105], v[184:185], v[164:165], v[104:105] op_sel:[0,0,0] op_sel_hi:[1,0,1] neg_lo:[0,1,0] neg_hi:[0,1,0]
    v_pk_fma_f32 v[106:107], v[186:187], v[164:165], v[106:107] op_sel:[0,0,0] op_sel_hi:[1,0,1] neg_lo:[0,1,0] neg_hi:[0,1,0]
    v_max_f32 v72, 0, v72
    v_max_f32 v73, 0, v73
    v_max_f32 v74, 0, v74
    v_max_f32 v75, 0, v75
    v_pk_mul_f32 v[104:105], v[104:105], v[164:165] op_sel:[0,1] op_sel_hi:[1,1]
    v_pk_mul_f32 v[106:107], v[106:107], v[164:165] op_sel:[0,1] op_sel_hi:[1,1]
    v_pk_mul_f32 v[72:73], v[72:73], v[104:105]
    v_pk_mul_f32 v[74:75], v[74:75], v[106:107]
    v_cvt_pk_bf16_f32 v72, v72, v73
    v_cvt_pk_bf16_f32 v73, v74, v75
    v_pk_fma_f32 v[88:89], v[180:181], v[164:165], v[88:89] op_sel:[0,0,0] op_sel_hi:[1,0,1] neg_lo:[0,1,0] neg_hi:[0,1,0]
    v_pk_fma_f32 v[90:91], v[182:183], v[164:165], v[90:91] op_sel:[0,0,0] op_sel_hi:[1,0,1] neg_lo:[0,1,0] neg_hi:[0,1,0]
    v_pk_fma_f32 v[120:121], v[188:189], v[164:165], v[120:121] op_sel:[0,0,0] op_sel_hi:[1,0,1] neg_lo:[0,1,0] neg_hi:[0,1,0]
    v_pk_fma_f32 v[122:123], v[190:191], v[164:165], v[122:123] op_sel:[0,0,0] op_sel_hi:[1,0,1] neg_lo:[0,1,0] neg_hi:[0,1,0]
    v_max_f32 v88, 0, v88
    v_max_f32 v89, 0, v89
    v_max_f32 v90, 0, v90
    v_max_f32 v91, 0, v91
    v_pk_mul_f32 v[120:121], v[120:121], v[164:165] op_sel:[0,1] op_sel_hi:[1,1]
    v_pk_mul_f32 v[122:123], v[122:123], v[164:165] op_sel:[0,1] op_sel_hi:[1,1]
    v_pk_mul_f32 v[88:89], v[88:89], v[120:121]
    v_pk_mul_f32 v[90:91], v[90:91], v[122:123]
    v_cvt_pk_bf16_f32 v74, v88, v89
    v_cvt_pk_bf16_f32 v75, v90, v91
    buffer_store_dwordx4 v[72:75], v250, s[48:51], s73 offen sc1
    v_pk_fma_f32 v[76:77], v[176:177], v[166:167], v[76:77] op_sel:[0,0,0] op_sel_hi:[1,0,1] neg_lo:[0,1,0] neg_hi:[0,1,0]
    v_pk_fma_f32 v[78:79], v[178:179], v[166:167], v[78:79] op_sel:[0,0,0] op_sel_hi:[1,0,1] neg_lo:[0,1,0] neg_hi:[0,1,0]
    v_pk_fma_f32 v[108:109], v[184:185], v[166:167], v[108:109] op_sel:[0,0,0] op_sel_hi:[1,0,1] neg_lo:[0,1,0] neg_hi:[0,1,0]
    v_pk_fma_f32 v[110:111], v[186:187], v[166:167], v[110:111] op_sel:[0,0,0] op_sel_hi:[1,0,1] neg_lo:[0,1,0] neg_hi:[0,1,0]
    v_max_f32 v76, 0, v76
    v_max_f32 v77, 0, v77
    v_max_f32 v78, 0, v78
    v_max_f32 v79, 0, v79
    v_pk_mul_f32 v[108:109], v[108:109], v[166:167] op_sel:[0,1] op_sel_hi:[1,1]
    v_pk_mul_f32 v[110:111], v[110:111], v[166:167] op_sel:[0,1] op_sel_hi:[1,1]
    v_pk_mul_f32 v[76:77], v[76:77], v[108:109]
    v_pk_mul_f32 v[78:79], v[78:79], v[110:111]
    v_cvt_pk_bf16_f32 v76, v76, v77
    v_cvt_pk_bf16_f32 v77, v78, v79
    v_pk_fma_f32 v[92:93], v[180:181], v[166:167], v[92:93] op_sel:[0,0,0] op_sel_hi:[1,0,1] neg_lo:[0,1,0] neg_hi:[0,1,0]
    v_pk_fma_f32 v[94:95], v[182:183], v[166:167], v[94:95] op_sel:[0,0,0] op_sel_hi:[1,0,1] neg_lo:[0,1,0] neg_hi:[0,1,0]
    v_pk_fma_f32 v[124:125], v[188:189], v[166:167], v[124:125] op_sel:[0,0,0] op_sel_hi:[1,0,1] neg_lo:[0,1,0] neg_hi:[0,1,0]
    v_pk_fma_f32 v[126:127], v[190:191], v[166:167], v[126:127] op_sel:[0,0,0] op_sel_hi:[1,0,1] neg_lo:[0,1,0] neg_hi:[0,1,0]
    v_max_f32 v92, 0, v92
    v_max_f32 v93, 0, v93
    v_max_f32 v94, 0, v94
    v_max_f32 v95, 0, v95
    v_pk_mul_f32 v[124:125], v[124:125], v[166:167] op_sel:[0,1] op_sel_hi:[1,1]
    v_pk_mul_f32 v[126:127], v[126:127], v[166:167] op_sel:[0,1] op_sel_hi:[1,1]
    v_pk_mul_f32 v[92:93], v[92:93], v[124:125]
    v_pk_mul_f32 v[94:95], v[94:95], v[126:127]
    v_cvt_pk_bf16_f32 v78, v92, v93
    v_cvt_pk_bf16_f32 v79, v94, v95
    buffer_store_dwordx4 v[76:79], v251, s[48:51], s73 offen sc1
L_CW:
    v_lshrrev_b32 v236, 2, v230
    v_and_b32 v237, 3, v230
    v_lshlrev_b32 v238, 7, v236
    v_lshl_add_u32 v238, v237, 3, v238
    v_add_u32 v238, s81, v238
    v_bfe_u32 v236, v236, 1, 2
    v_xor_b32 v237, 0, v236
    v_lshl_add_u32 v240, v237, 5, v238
    v_xor_b32 v237, 1, v236
    v_lshl_add_u32 v241, v237, 5, v238
    v_xor_b32 v237, 2, v236
    v_lshl_add_u32 v242, v237, 5, v238
    v_xor_b32 v237, 3, v236
    v_lshl_add_u32 v243, v237, 5, v238
    v_add_u32 v244, 0x10000, v240
    v_add_u32 v245, 0x10000, v241
    v_add_u32 v246, 0x10000, v242
    v_add_u32 v247, 0x10000, v243
    ds_read_b64_tr_b16 v[64:65], v240 offset:0
    ds_read_b64_tr_b16 v[66:67], v240 offset:2048
    ds_read_b64_tr_b16 v[68:69], v241 offset:0
    ds_read_b64_tr_b16 v[70:71], v241 offset:2048
    ds_read_b64_tr_b16 v[72:73], v242 offset:0
    ds_read_b64_tr_b16 v[74:75], v242 offset:2048
    ds_read_b64_tr_b16 v[76:77], v243 offset:0
    ds_read_b64_tr_b16 v[78:79], v243 offset:2048
    ds_read_b64_tr_b16 v[80:81], v244 offset:16384
    ds_read_b64_tr_b16 v[82:83], v244 offset:18432
    ds_read_b64_tr_b16 v[84:85], v245 offset:16384
    ds_read_b64_tr_b16 v[86:87], v245 offset:18432
    ds_read_b64_tr_b16 v[88:89], v246 offset:16384
    ds_read_b64_tr_b16 v[90:91], v246 offset:18432
    ds_read_b64_tr_b16 v[92:93], v247 offset:16384
    ds_read_b64_tr_b16 v[94:95], v247 offset:18432
    ds_read_b64_tr_b16 v[96:97], v240 offset:16384
    ds_read_b64_tr_b16 v[98:99], v240 offset:18432
    ds_read_b64_tr_b16 v[100:101], v241 offset:16384
    ds_read_b64_tr_b16 v[102:103], v241 offset:18432
    ds_read_b64_tr_b16 v[104:105], v242 offset:16384
    ds_read_b64_tr_b16 v[106:107], v242 offset:18432
    ds_read_b64_tr_b16 v[108:109], v243 offset:16384
    ds_read_b64_tr_b16 v[110:111], v243 offset:18432
    ds_read_b64_tr_b16 v[112:113], v240 offset:49152
    ds_read_b64_tr_b16 v[114:115], v240 offset:51200
    ds_read_b64_tr_b16 v[116:117], v241 offset:49152
    ds_read_b64_tr_b16 v[118:119], v241 offset:51200
    ds_read_b64_tr_b16 v[120:121], v242 offset:49152
    ds_read_b64_tr_b16 v[122:123], v242 offset:51200
    ds_read_b64_tr_b16 v[124:125], v243 offset:49152
    ds_read_b64_tr_b16 v[126:127], v243 offset:51200
    ds_read_b64_tr_b16 v[128:129], v244 offset:32768
    ds_read_b64_tr_b16 v[130:131], v244 offset:34816
    ds_read_b64_tr_b16 v[132:133], v245 offset:32768
    ds_read_b64_tr_b16 v[134:135], v245 offset:34816
    ds_read_b64_tr_b16 v[136:137], v246 offset:32768
    ds_read_b64_tr_b16 v[138:139], v246 offset:34816
    ds_read_b64_tr_b16 v[140:141], v247 offset:32768
    ds_read_b64_tr_b16 v[142:143], v247 offset:34816
    s_lshl_b32 s69, s61, 4
    s_add_u32 s69, s69, s62
    s_lshl_b32 s69, s69, 7
    s_lshl_b32 s70, s60, 2
    s_add_u32 s69, s69, s70
    s_add_u32 s69, s69, 16777216
    v_mov_b32 v238, 1
    v_mov_b32 v239, 0
    s_add_u32 s76, s81, 0
    s_add_u32 s77, s81, 81920
    s_add_u32 s78, s81, 16384
    s_add_u32 s79, s81, 49152
    v_lshrrev_b32 v232, 3, v230
    v_and_b32 v233, 7, v230
    v_bfe_u32 v234, v232, 1, 2
    v_lshlrev_b32 v234, 1, v234
    v_xor_b32 v234, v234, v233
    v_lshlrev_b32 v232, 10, v232
    v_lshl_add_u32 v252, v234, 4, v232
    v_mov_b32 v253, v230
    s_waitcnt vmcnt(0)
    s_mov_b64 exec, 1
    buffer_store_dword v238, v239, s[48:51], s69 offen sc1
    s_mov_b64 exec, -1
    s_waitcnt lgkmcnt(0)
    s_cmp_lt_u32 s62, 8
    s_cbranch_scc1 L_P2
    s_barrier
L_P2:
    s_add_u32 m0, s76, 0
    s_add_u32 s85, s93, 0
    buffer_load_dwordx4 v252, s[40:43], s85 offen lds
    s_add_u32 m0, s76, 1024
    s_add_u32 s85, s93, 8192
    buffer_load_dwordx4 v252, s[40:43], s85 offen lds
    s_add_u32 m0, s76, 2048
    s_add_u32 s85, s93, 16384
    buffer_load_dwordx4 v252, s[40:43], s85 offen lds
    s_add_u32 m0, s76, 3072
    s_add_u32 s85, s93, 24576
    buffer_load_dwordx4 v252, s[40:43], s85 offen lds
    s_add_u32 m0, s77, 0
    s_add_u32 s85, s94, 0
    buffer_load_dwordx4 v252, s[40:43], s85 offen lds
    s_add_u32 m0, s77, 1024
    s_add_u32 s85, s94, 8192
    buffer_load_dwordx4 v252, s[40:43], s85 offen lds
    s_add_u32 m0, s77, 2048
    s_add_u32 s85, s94, 16384
    buffer_load_dwordx4 v252, s[40:43], s85 offen lds
    s_add_u32 m0, s77, 3072
    s_add_u32 s85, s94, 24576
    buffer_load_dwordx4 v252, s[40:43], s85 offen lds
    s_add_u32 m0, s78, 0
    s_add_u32 s85, s95, 0
    buffer_load_dwordx4 v252, s[44:47], s85 offen lds
    s_add_u32 m0, s78, 1024
    s_add_u32 s85, s95, 8192
    buffer_load_dwordx4 v252, s[44:47], s85 offen lds
    s_add_u32 m0, s78, 2048
    s_add_u32 s85, s95, 16384
    buffer_load_dwordx4 v252, s[44:47], s85 offen lds
    s_add_u32 m0, s78, 3072
    s_add_u32 s85, s95, 24576
    buffer_load_dwordx4 v252, s[44:47], s85 offen lds
    buffer_load_dwordx2 v[0:1], off, s[48:51], s100 offset:1024 sc1
    s_mul_i32 s75, s64, 368640
    s_lshr_b32 s88, s88, 15
    s_mul_i32 s88, s88, 5120
    s_add_u32 s88, s88, s75
    s_lshr_b32 s89, s89, 15
    s_mul_i32 s89, s89, 5120
    s_add_u32 s89, s89, s75
    s_lshr_b32 s90, s90, 15
    s_mul_i32 s90, s90, 5120
    s_add_u32 s90, s90, s75
    s_lshr_b32 s91, s91, 15
    s_mul_i32 s91, s91, 5120
    s_add_u32 s91, s91, s75
    s_lshr_b32 s92, s92, 15
    s_mul_i32 s92, s92, 5120
    s_add_u32 s92, s92, s75
    s_lshr_b32 s71, s93, 15
    s_mul_i32 s71, s71, 5120
    s_add_u32 s71, s71, s75
    s_lshr_b32 s72, s94, 15
    s_mul_i32 s72, s72, 5120
    s_add_u32 s72, s72, s75
    s_lshr_b32 s73, s95, 15
    s_mul_i32 s73, s73, 5120
    s_add_u32 s73, s73, s75
    s_add_u32 s73, s73, 286720
    s_lshr_b32 s74, s96, 15
    s_mul_i32 s74, s74, 5120
    s_add_u32 s74, s74, s75
    s_add_u32 s74, s74, 286720
    s_mov_b32 s67, 0
    v_lshrrev_b32 v192, 2, v253
    v_and_b32 v193, 3, v253
    v_lshlrev_b32 v194, 7, v192
    v_lshl_add_u32 v194, v193, 3, v194
    v_add_u32 v194, s67, v194
    v_bfe_u32 v192, v192, 1, 2
    v_xor_b32 v193, 0, v192
    v_lshl_add_u32 v204, v193, 5, v194
    v_xor_b32 v193, 1, v192
    v_lshl_add_u32 v205, v193, 5, v194
    v_xor_b32 v193, 2, v192
    v_lshl_add_u32 v206, v193, 5, v194
    v_xor_b32 v193, 3, v192
    v_lshl_add_u32 v207, v193, 5, v194
    v_lshrrev_b32 v208, 3, v253
    v_and_b32 v209, 7, v253
    v_lshlrev_b32 v209, 4, v209
    v_add_u32 v210, 0, v208
    v_mul_u32_u24 v211, 37, v210
    v_lshrrev_b32 v211, 8, v211
    v_add_u32 v210, v210, v211
    v_and_b32 v211, 7, v210
    v_cmp_lt_u32 vcc, 2, v211
    s_nop 1
    v_addc_co_u32 v210, vcc, 0, v210, vcc
    v_lshl_add_u32 v248, v210, 7, v209
    v_add_u32 v210, 8, v208
    v_mul_u32_u24 v211, 37, v210
    v_lshrrev_b32 v211, 8, v211
    v_add_u32 v210, v210, v211
    v_and_b32 v211, 7, v210
    v_cmp_lt_u32 vcc, 2, v211
    s_nop 1
    v_addc_co_u32 v210, vcc, 0, v210, vcc
    v_lshl_add_u32 v249, v210, 7, v209
    v_add_u32 v210, 16, v208
    v_mul_u32_u24 v211, 37, v210
    v_lshrrev_b32 v211, 8, v211
    v_add_u32 v210, v210, v211
    v_and_b32 v211, 7, v210
    v_cmp_lt_u32 vcc, 2, v211
    s_nop 1
    v_addc_co_u32 v210, vcc, 0, v210, vcc
    v_lshl_add_u32 v250, v210, 7, v209
    v_add_u32 v210, 24, v208
    v_mul_u32_u24 v211, 37, v210
    v_lshrrev_b32 v211, 8, v211
    v_add_u32 v210, v210, v211
    v_and_b32 v211, 7, v210
    v_cmp_lt_u32 vcc, 2, v211
    s_nop 1
    v_addc_co_u32 v210, vcc, 0, v210, vcc
    v_lshl_add_u32 v251, v210, 7, v209
    v_and_b32 v254, 15, v253
    v_lshrrev_b32 v255, 4, v253
    v_lshlrev_b32 v254, 8, v254
    v_and_b32 v253, 7, v253
    v_xor_b32 v255, v255, v253
    v_lshl_add_u32 v254, v255, 4, v254
    s_waitcnt vmcnt(0)
    v_and_b32 v0, v0, v1
    s_nop 0
    v_readfirstlane_b32 s70, v0
    s_cmp_eq_u32 s70, 1
    s_cbranch_scc1 L_pollB_ok
    s_mov_b32 s98, 0
L_pollB:
    s_sleep 1
    buffer_load_dwordx2 v[0:1], off, s[48:51], s100 offset:1024 sc1
    s_waitcnt vmcnt(0)
    v_and_b32 v0, v0, v1
    s_nop 0
    v_readfirstlane_b32 s70, v0
    s_cmp_eq_u32 s70, 1
    s_cbranch_scc1 L_pollB_ok
    s_add_u32 s98, s98, 1
    s_cmp_lt_u32 s98, 0x40000
    s_cbranch_scc1 L_pollB
L_pollB_ok:
    buffer_load_dwordx4 v[208:211], v248, s[48:51], s88 offen sc1
    buffer_load_dwordx4 v[212:215], v248, s[48:51], s89 offen sc1
    buffer_load_dwordx4 v[216:219], v249, s[48:51], s88 offen sc1
    buffer_load_dwordx4 v[220:223], v249, s[48:51], s89 offen sc1
    buffer_load_dwordx4 v[224:227], v250, s[48:51], s88 offen sc1
    buffer_load_dwordx4 v[228:231], v250, s[48:51], s89 offen sc1
    buffer_load_dwordx4 v[232:235], v251, s[48:51], s88 offen sc1
    buffer_load_dwordx4 v[236:239], v251, s[48:51], s89 offen sc1
    buffer_load_dwordx4 v[240:243], v248, s[48:51], s90 offen sc1
    buffer_load_dwordx4 v[244:247], v248, s[48:51], s91 offen sc1
    s_waitcnt vmcnt(8)
    v_mfma_f32_16x16x32_bf16 v[0:3], v[64:67], v[208:211], 0
    v_add_u32 v200, s76, v204
    v_add_u32 v201, s76, v205
    v_mfma_f32_16x16x32_bf16 v[0:3], v[80:83], v[212:215], v[0:3]
    v_add_u32 v202, s76, v206
    v_add_u32 v203, s76, v207
    v_mfma_f32_16x16x32_bf16 v[16:19], v[68:71], v[208:211], 0
    ds_read_b64_tr_b16 v[144:145], v200 offset:0
    ds_read_b64_tr_b16 v[146:147], v200 offset:2048
    v_mfma_f32_16x16x32_bf16 v[16:19], v[84:87], v[212:215], v[16:19]
    ds_read_b64_tr_b16 v[148:149], v201 offset:0
    ds_read_b64_tr_b16 v[150:151], v201 offset:2048
    v_mfma_f32_16x16x32_bf16 v[32:35], v[72:75], v[208:211], 0
    ds_read_b64_tr_b16 v[152:153], v202 offset:0
    ds_read_b64_tr_b16 v[154:155], v202 offset:2048
    v_mfma_f32_16x16x32_bf16 v[32:35], v[88:91], v[212:215], v[32:35]
    ds_read_b64_tr_b16 v[156:157], v203 offset:0
    ds_read_b64_tr_b16 v[158:159], v203 offset:2048
    v_mfma_f32_16x16x32_bf16 v[48:51], v[76:79], v[208:211], 0
    v_mfma_f32_16x16x32_bf16 v[48:51], v[92:95], v[212:215], v[48:51]
    buffer_load_dwordx4 v[208:211], v249, s[48:51], s90 offen sc1
    buffer_load_dwordx4 v[212:215], v249, s[48:51], s91 offen sc1
    s_add_u32 m0, s79, 0
    s_add_u32 s85, s96, 0
    buffer_load_dwordx4 v252, s[44:47], s85 offen lds
    s_add_u32 m0, s79, 1024
    s_add_u32 s85, s96, 8192
    buffer_load_dwordx4 v252, s[44:47], s85 offen lds
    s_waitcnt vmcnt(10)
    v_mfma_f32_16x16x32_bf16 v[4:7], v[64:67], v[216:219], 0
    v_add_u32 v200, s77, v204
    v_add_u32 v201, s77, v205
    v_mfma_f32_16x16x32_bf16 v[4:7], v[80:83], v[220:223], v[4:7]
    v_add_u32 v202, s77, v206
    v_add_u32 v203, s77, v207
    v_mfma_f32_16x16x32_bf16 v[20:23], v[68:71], v[216:219], 0
    ds_read_b64_tr_b16 v[160:161], v200 offset:0
    ds_read_b64_tr_b16 v[162:163], v200 offset:2048
    v_mfma_f32_16x16x32_bf16 v[20:23], v[84:87], v[220:223], v[20:23]
    ds_read_b64_tr_b16 v[164:165], v201 offset:0
    ds_read_b64_tr_b16 v[166:167], v201 offset:2048
    v_mfma_f32_16x16x32_bf16 v[36:39], v[72:75], v[216:219], 0
    ds_read_b64_tr_b16 v[168:169], v202 offset:0
    ds_read_b64_tr_b16 v[170:171], v202 offset:2048
    v_mfma_f32_16x16x32_bf16 v[36:39], v[88:91], v[220:223], v[36:39]
    ds_read_b64_tr_b16 v[172:173], v203 offset:0
    ds_read_b64_tr_b16 v[174:175], v203 offset:2048
    v_mfma_f32_16x16x32_bf16 v[52:55], v[76:79], v[216:219], 0
    v_mfma_f32_16x16x32_bf16 v[52:55], v[92:95], v[220:223], v[52:55]
    buffer_load_dwordx4 v[216:219], v250, s[48:51], s90 offen sc1
    buffer_load_dwordx4 v[220:223], v250, s[48:51], s91 offen sc1
    s_add_u32 m0, s79, 2048
    s_add_u32 s85, s96, 16384
    buffer_load_dwordx4 v252, s[44:47], s85 offen lds
    s_add_u32 m0, s79, 3072
    s_add_u32 s85, s96, 24576
    buffer_load_dwordx4 v252, s[44:47], s85 offen lds
    s_waitcnt vmcnt(12)
    v_mfma_f32_16x16x32_bf16 v[8:11], v[64:67], v[224:227], 0
    v_add_u32 v200, s78, v204
    v_add_u32 v201, s78, v205
    v_mfma_f32_16x16x32_bf16 v[8:11], v[80:83], v[228:231], v[8:11]
    v_add_u32 v202, s78, v206
    v_add_u32 v203, s78, v207
    v_mfma_f32_16x16x32_bf16 v[24:27], v[68:71], v[224:227], 0
    ds_read_b64_tr_b16 v[176:177], v200 offset:0
    ds_read_b64_tr_b16 v[178:179], v200 offset:2048
    v_mfma_f32_16x16x32_bf16 v[24:27], v[84:87], v[228:231], v[24:27]
    ds_read_b64_tr_b16 v[180:181], v201 offset:0
    ds_read_b64_tr_b16 v[182:183], v201 offset:2048
    v_mfma_f32_16x16x32_bf16 v[40:43], v[72:75], v[224:227], 0
    ds_read_b64_tr_b16 v[184:185], v202 offset:0
    ds_read_b64_tr_b16 v[186:187], v202 offset:2048
    v_mfma_f32_16x16x32_bf16 v[40:43], v[88:91], v[228:231], v[40:43]
    ds_read_b64_tr_b16 v[188:189], v203 offset:0
    ds_read_b64_tr_b16 v[190:191], v203 offset:2048
    v_mfma_f32_16x16x32_bf16 v[56:59], v[76:79], v[224:227], 0
    v_mfma_f32_16x16x32_bf16 v[56:59], v[92:95], v[228:231], v[56:59]
    buffer_load_dwordx4 v[224:227], v251, s[48:51], s90 offen sc1
    buffer_load_dwordx4 v[228:231], v251, s[48:51], s91 offen sc1
    s_waitcnt vmcnt(12)
    v_mfma_f32_16x16x32_bf16 v[12:15], v[64:67], v[232:235], 0
    v_mfma_f32_16x16x32_bf16 v[12:15], v[80:83], v[236:239], v[12:15]
    v_mfma_f32_16x16x32_bf16 v[28:31], v[68:71], v[232:235], 0
    v_mfma_f32_16x16x32_bf16 v[28:31], v[84:87], v[236:239], v[28:31]
    v_mfma_f32_16x16x32_bf16 v[44:47], v[72:75], v[232:235], 0
    v_mfma_f32_16x16x32_bf16 v[44:47], v[88:91], v[236:239], v[44:47]
    v_mfma_f32_16x16x32_bf16 v[60:63], v[76:79], v[232:235], 0
    v_mfma_f32_16x16x32_bf16 v[60:63], v[92:95], v[236:239], v[60:63]
    buffer_load_dwordx4 v[232:235], v248, s[48:51], s92 offen sc1
    buffer_load_dwordx4 v[236:239], v249, s[48:51], s92 offen sc1
    s_waitcnt vmcnt(12)
    v_mfma_f32_16x16x32_bf16 v[0:3], v[96:99], v[240:243], v[0:3]
    v_mfma_f32_16x16x32_bf16 v[0:3], v[112:115], v[244:247], v[0:3]
    v_mfma_f32_16x16x32_bf16 v[16:19], v[100:103], v[240:243], v[16:19]
    v_mfma_f32_16x16x32_bf16 v[16:19], v[116:119], v[244:247], v[16:19]
    v_mfma_f32_16x16x32_bf16 v[32:35], v[104:107], v[240:243], v[32:35]
    v_mfma_f32_16x16x32_bf16 v[32:35], v[120:123], v[244:247], v[32:35]
    v_mfma_f32_16x16x32_bf16 v[48:51], v[108:111], v[240:243], v[48:51]
    v_mfma_f32_16x16x32_bf16 v[48:51], v[124:127], v[244:247], v[48:51]
    buffer_load_dwordx4 v[240:243], v250, s[48:51], s92 offen sc1
    buffer_load_dwordx4 v[244:247], v251, s[48:51], s92 offen sc1
    s_waitcnt vmcnt(12)
    buffer_load_dword v253, off, s[48:51], s100 offset:0 sc1
    buffer_load_dword v255, off, s[48:51], s100 offset:4 sc1
    v_mfma_f32_16x16x32_bf16 v[4:7], v[96:99], v[208:211], v[4:7]
    v_mfma_f32_16x16x32_bf16 v[4:7], v[112:115], v[212:215], v[4:7]
    v_mfma_f32_16x16x32_bf16 v[20:23], v[100:103], v[208:211], v[20:23]
    v_mfma_f32_16x16x32_bf16 v[20:23], v[116:119], v[212:215], v[20:23]
    v_mfma_f32_16x16x32_bf16 v[36:39], v[104:107], v[208:211], v[36:39]
    v_mfma_f32_16x16x32_bf16 v[36:39], v[120:123], v[212:215], v[36:39]
    v_mfma_f32_16x16x32_bf16 v[52:55], v[108:111], v[208:211], v[52:55]
    v_mfma_f32_16x16x32_bf16 v[52:55], v[124:127], v[212:215], v[52:55]
    s_waitcnt vmcnt(10)
    v_mfma_f32_16x16x32_bf16 v[8:11], v[96:99], v[216:219], v[8:11]
    v_mfma_f32_16x16x32_bf16 v[8:11], v[112:115], v[220:223], v[8:11]
    v_mfma_f32_16x16x32_bf16 v[24:27], v[100:103], v[216:219], v[24:27]
    v_mfma_f32_16x16x32_bf16 v[24:27], v[116:119], v[220:223], v[24:27]
    v_mfma_f32_16x16x32_bf16 v[40:43], v[104:107], v[216:219], v[40:43]
    v_mfma_f32_16x16x32_bf16 v[40:43], v[120:123], v[220:223], v[40:43]
    v_mfma_f32_16x16x32_bf16 v[56:59], v[108:111], v[216:219], v[56:59]
    v_mfma_f32_16x16x32_bf16 v[56:59], v[124:127], v[220:223], v[56:59]
    s_waitcnt vmcnt(6)
    v_mfma_f32_16x16x32_bf16 v[12:15], v[96:99], v[224:227], v[12:15]
    v_add_u32 v200, s79, v204
    v_add_u32 v201, s79, v205
    v_mfma_f32_16x16x32_bf16 v[12:15], v[112:115], v[228:231], v[12:15]
    v_add_u32 v202, s79, v206
    v_add_u32 v203, s79, v207
    v_mfma_f32_16x16x32_bf16 v[28:31], v[100:103], v[224:227], v[28:31]
    ds_read_b64_tr_b16 v[192:193], v200 offset:0
    ds_read_b64_tr_b16 v[194:195], v200 offset:2048
    v_mfma_f32_16x16x32_bf16 v[28:31], v[116:119], v[228:231], v[28:31]
    ds_read_b64_tr_b16 v[196:197], v201 offset:0
    ds_read_b64_tr_b16 v[198:199], v201 offset:2048
    v_mfma_f32_16x16x32_bf16 v[44:47], v[104:107], v[224:227], v[44:47]
    ds_read_b64_tr_b16 v[204:205], v203 offset:0
    ds_read_b64_tr_b16 v[206:207], v203 offset:2048
    v_mfma_f32_16x16x32_bf16 v[44:47], v[120:123], v[228:231], v[44:47]
    ds_read_b64_tr_b16 v[200:201], v202 offset:0
    ds_read_b64_tr_b16 v[202:203], v202 offset:2048
    v_mfma_f32_16x16x32_bf16 v[60:63], v[108:111], v[224:227], v[60:63]
    v_mfma_f32_16x16x32_bf16 v[60:63], v[124:127], v[228:231], v[60:63]
    s_waitcnt vmcnt(0)
    v_and_b32 v253, v253, v255
    s_nop 0
    v_readfirstlane_b32 s70, v253
    s_cmp_eq_u32 s70, 1
    s_cbranch_scc1 L_pollA_ok
    s_mov_b32 s98, 0
L_pollA:
    s_sleep 1
    buffer_load_dword v253, off, s[48:51], s100 offset:0 sc1
    buffer_load_dword v255, off, s[48:51], s100 offset:4 sc1
    s_waitcnt vmcnt(0)
    v_and_b32 v253, v253, v255
    s_nop 0
    v_readfirstlane_b32 s70, v253
    s_cmp_eq_u32 s70, 1
    s_cbranch_scc1 L_pollA_ok
    s_add_u32 s98, s98, 1
    s_cmp_lt_u32 s98, 0x40000
    s_cbranch_scc1 L_pollA
L_pollA_ok:
    buffer_load_dwordx4 v[208:211], v248, s[48:51], s71 offen sc1
    buffer_load_dwordx4 v[212:215], v248, s[48:51], s72 offen sc1
    buffer_load_dwordx4 v[216:219], v249, s[48:51], s71 offen sc1
    buffer_load_dwordx4 v[220:223], v249, s[48:51], s72 offen sc1
    buffer_load_dwordx4 v[224:227], v248, s[48:51], s73 offen sc1
    buffer_load_dwordx4 v[228:231], v248, s[48:51], s74 offen sc1
    s_waitcnt vmcnt(11)
    v_mfma_f32_16x16x32_bf16 v[0:3], v[128:131], v[232:235], v[0:3]
    v_mfma_f32_16x16x32_bf16 v[16:19], v[132:135], v[232:235], v[16:19]
    v_mfma_f32_16x16x32_bf16 v[32:35], v[136:139], v[232:235], v[32:35]
    v_mfma_f32_16x16x32_bf16 v[48:51], v[140:143], v[232:235], v[48:51]
    buffer_load_dwordx4 v[232:235], v249, s[48:51], s73 offen sc1
    s_waitcnt vmcnt(11)
    v_mfma_f32_16x16x32_bf16 v[4:7], v[128:131], v[236:239], v[4:7]
    v_mfma_f32_16x16x32_bf16 v[20:23], v[132:135], v[236:239], v[20:23]
    v_mfma_f32_16x16x32_bf16 v[36:39], v[136:139], v[236:239], v[36:39]
    v_mfma_f32_16x16x32_bf16 v[52:55], v[140:143], v[236:239], v[52:55]
    buffer_load_dwordx4 v[236:239], v249, s[48:51], s74 offen sc1
    s_waitcnt vmcnt(11)
    v_mfma_f32_16x16x32_bf16 v[8:11], v[128:131], v[240:243], v[8:11]
    v_mfma_f32_16x16x32_bf16 v[24:27], v[132:135], v[240:243], v[24:27]
    v_mfma_f32_16x16x32_bf16 v[40:43], v[136:139], v[240:243], v[40:43]
    v_mfma_f32_16x16x32_bf16 v[56:59], v[140:143], v[240:243], v[56:59]
    buffer_load_dwordx4 v[240:243], v250, s[48:51], s71 offen sc1
    s_waitcnt vmcnt(11)
    v_mfma_f32_16x16x32_bf16 v[12:15], v[128:131], v[244:247], v[12:15]
    v_mfma_f32_16x16x32_bf16 v[28:31], v[132:135], v[244:247], v[28:31]
    v_mfma_f32_16x16x32_bf16 v[44:47], v[136:139], v[244:247], v[44:47]
    v_mfma_f32_16x16x32_bf16 v[60:63], v[140:143], v[244:247], v[60:63]
    buffer_load_dwordx4 v[244:247], v250, s[48:51], s72 offen sc1
    s_waitcnt vmcnt(8)
    s_waitcnt lgkmcnt(0)
    v_mfma_f32_16x16x32_bf16 v[0:3], v[144:147], v[208:211], v[0:3]
    v_mfma_f32_16x16x32_bf16 v[0:3], v[160:163], v[212:215], v[0:3]
    v_mfma_f32_16x16x32_bf16 v[16:19], v[148:151], v[208:211], v[16:19]
    v_mfma_f32_16x16x32_bf16 v[16:19], v[164:167], v[212:215], v[16:19]
    v_mfma_f32_16x16x32_bf16 v[32:35], v[152:155], v[208:211], v[32:35]
    v_mfma_f32_16x16x32_bf16 v[32:35], v[168:171], v[212:215], v[32:35]
    v_mfma_f32_16x16x32_bf16 v[48:51], v[156:159], v[208:211], v[48:51]
    v_mfma_f32_16x16x32_bf16 v[48:51], v[172:175], v[212:215], v[48:51]
    buffer_load_dwordx4 v[208:211], v251, s[48:51], s71 offen sc1
    buffer_load_dwordx4 v[212:215], v251, s[48:51], s72 offen sc1
    s_waitcnt vmcnt(8)
    v_mfma_f32_16x16x32_bf16 v[4:7], v[144:147], v[216:219], v[4:7]
    v_mfma_f32_16x16x32_bf16 v[4:7], v[160:163], v[220:223], v[4:7]
    v_mfma_f32_16x16x32_bf16 v[20:23], v[148:151], v[216:219], v[20:23]
    v_mfma_f32_16x16x32_bf16 v[20:23], v[164:167], v[220:223], v[20:23]
    v_mfma_f32_16x16x32_bf16 v[36:39], v[152:155], v[216:219], v[36:39]
    v_mfma_f32_16x16x32_bf16 v[36:39], v[168:171], v[220:223], v[36:39]
    v_mfma_f32_16x16x32_bf16 v[52:55], v[156:159], v[216:219], v[52:55]
    v_mfma_f32_16x16x32_bf16 v[52:55], v[172:175], v[220:223], v[52:55]
    buffer_load_dwordx4 v[216:219], v250, s[48:51], s73 offen sc1
    buffer_load_dwordx4 v[220:223], v250, s[48:51], s74 offen sc1
    v_mbcnt_lo_u32_b32 v64, -1, 0
    v_mbcnt_hi_u32_b32 v64, -1, v64
    v_and_b32 v66, 7, v64
    v_lshrrev_b32 v71, 3, v64
    s_lshl_b32 s68, s60, 3
    v_add_u32 v72, s68, v71
    v_and_b32 v75, 15, v72
    v_bfe_u32 v74, v72, 4, 1
    v_lshl_add_u32 v73, v75, 1, v74
    v_and_b32 v74, 32, v72
    v_add_u32 v73, v73, v74
    v_lshlrev_b32 v73, 10, v73
    v_lshl_add_u32 v73, v66, 4, v73
    s_lshl_b32 s69, s64, 16
    s_lshl_b32 s68, s65, 7
    s_add_u32 s69, s69, s68
    s_lshr_b32 s67, s60, 1
    s_mov_b32 s88, 0
    s_cmp_eq_u32 s67, 1
    s_cselect_b32 s88, 81920, s88
    s_cmp_eq_u32 s67, 2
    s_cselect_b32 s88, 16384, s88
    s_cmp_eq_u32 s67, 3
    s_cselect_b32 s88, 49152, s88
    s_mov_b32 s89, 32768
    s_cmp_eq_u32 s67, 1
    s_cselect_b32 s89, 65536, s89
    s_cmp_eq_u32 s67, 2
    s_cselect_b32 s89, 118784, s89
    s_cmp_eq_u32 s67, 3
    s_cselect_b32 s89, 135168, s89
    v_lshlrev_b32 v74, 1, v66
    v_xor_b32 v74, v74, v71
    v_lshlrev_b32 v80, 8, v75
    v_lshl_add_u32 v80, v74, 4, v80
    v_add_u32 v81, s88, v80
    v_add_u32 v83, s89, v80
    v_xor_b32 v82, 16, v81
    v_xor_b32 v84, 16, v83
    s_waitcnt vmcnt(8)
    v_mfma_f32_16x16x32_bf16 v[0:3], v[176:179], v[224:227], v[0:3]
    v_mfma_f32_16x16x32_bf16 v[0:3], v[192:195], v[228:231], v[0:3]
    v_mfma_f32_16x16x32_bf16 v[16:19], v[180:183], v[224:227], v[16:19]
    v_mfma_f32_16x16x32_bf16 v[16:19], v[196:199], v[228:231], v[16:19]
    v_mfma_f32_16x16x32_bf16 v[32:35], v[184:187], v[224:227], v[32:35]
    v_mfma_f32_16x16x32_bf16 v[32:35], v[200:203], v[228:231], v[32:35]
    v_mfma_f32_16x16x32_bf16 v[48:51], v[188:191], v[224:227], v[48:51]
    v_mfma_f32_16x16x32_bf16 v[48:51], v[204:207], v[228:231], v[48:51]
    buffer_load_dwordx4 v[224:227], v251, s[48:51], s73 offen sc1
    buffer_load_dwordx4 v[228:231], v251, s[48:51], s74 offen sc1
    s_waitcnt vmcnt(8)
    v_mfma_f32_16x16x32_bf16 v[4:7], v[176:179], v[232:235], v[4:7]
    v_mfma_f32_16x16x32_bf16 v[4:7], v[192:195], v[236:239], v[4:7]
    v_mfma_f32_16x16x32_bf16 v[20:23], v[180:183], v[232:235], v[20:23]
    v_mfma_f32_16x16x32_bf16 v[20:23], v[196:199], v[236:239], v[20:23]
    v_mfma_f32_16x16x32_bf16 v[36:39], v[184:187], v[232:235], v[36:39]
    v_mfma_f32_16x16x32_bf16 v[36:39], v[200:203], v[236:239], v[36:39]
    v_mfma_f32_16x16x32_bf16 v[52:55], v[188:191], v[232:235], v[52:55]
    v_mfma_f32_16x16x32_bf16 v[52:55], v[204:207], v[236:239], v[52:55]
    s_waitcnt vmcnt(6)
    v_mfma_f32_16x16x32_bf16 v[8:11], v[144:147], v[240:243], v[8:11]
    v_mfma_f32_16x16x32_bf16 v[8:11], v[160:163], v[244:247], v[8:11]
    v_mfma_f32_16x16x32_bf16 v[24:27], v[148:151], v[240:243], v[24:27]
    v_mfma_f32_16x16x32_bf16 v[24:27], v[164:167], v[244:247], v[24:27]
    v_mfma_f32_16x16x32_bf16 v[40:43], v[152:155], v[240:243], v[40:43]
    v_mfma_f32_16x16x32_bf16 v[40:43], v[168:171], v[244:247], v[40:43]
    v_mfma_f32_16x16x32_bf16 v[56:59], v[156:159], v[240:243], v[56:59]
    v_mfma_f32_16x16x32_bf16 v[56:59], v[172:175], v[244:247], v[56:59]
    v_add_u32 v253, s76, v254
    v_xor_b32 v255, 64, v253
    ds_write_b128 v253, v[0:3] offset:0
    ds_write_b128 v255, v[16:19] offset:0
    ds_write_b128 v253, v[32:35] offset:128
    ds_write_b128 v255, v[48:51] offset:128
    s_waitcnt vmcnt(4)
    v_mfma_f32_16x16x32_bf16 v[12:15], v[144:147], v[208:211], v[12:15]
    v_mfma_f32_16x16x32_bf16 v[12:15], v[160:163], v[212:215], v[12:15]
    v_mfma_f32_16x16x32_bf16 v[28:31], v[148:151], v[208:211], v[28:31]
    v_mfma_f32_16x16x32_bf16 v[28:31], v[164:167], v[212:215], v[28:31]
    v_mfma_f32_16x16x32_bf16 v[44:47], v[152:155], v[208:211], v[44:47]
    v_mfma_f32_16x16x32_bf16 v[44:47], v[168:171], v[212:215], v[44:47]
    v_mfma_f32_16x16x32_bf16 v[60:63], v[156:159], v[208:211], v[60:63]
    v_mfma_f32_16x16x32_bf16 v[60:63], v[172:175], v[212:215], v[60:63]
    v_add_u32 v253, s77, v254
    v_xor_b32 v255, 64, v253
    ds_write_b128 v253, v[4:7] offset:0
    ds_write_b128 v255, v[20:23] offset:0
    ds_write_b128 v253, v[36:39] offset:128
    ds_write_b128 v255, v[52:55] offset:128
    s_waitcnt vmcnt(2)
    v_mfma_f32_16x16x32_bf16 v[8:11], v[176:179], v[216:219], v[8:11]
    v_mfma_f32_16x16x32_bf16 v[8:11], v[192:195], v[220:223], v[8:11]
    v_mfma_f32_16x16x32_bf16 v[24:27], v[180:183], v[216:219], v[24:27]
    v_mfma_f32_16x16x32_bf16 v[24:27], v[196:199], v[220:223], v[24:27]
    v_mfma_f32_16x16x32_bf16 v[40:43], v[184:187], v[216:219], v[40:43]
    v_mfma_f32_16x16x32_bf16 v[40:43], v[200:203], v[220:223], v[40:43]
    v_mfma_f32_16x16x32_bf16 v[56:59], v[188:191], v[216:219], v[56:59]
    v_mfma_f32_16x16x32_bf16 v[56:59], v[204:207], v[220:223], v[56:59]
    s_waitcnt vmcnt(0)
    v_mfma_f32_16x16x32_bf16 v[12:15], v[176:179], v[224:227], v[12:15]
    v_mfma_f32_16x16x32_bf16 v[12:15], v[192:195], v[228:231], v[12:15]
    v_mfma_f32_16x16x32_bf16 v[28:31], v[180:183], v[224:227], v[28:31]
    v_mfma_f32_16x16x32_bf16 v[28:31], v[196:199], v[228:231], v[28:31]
    v_mfma_f32_16x16x32_bf16 v[44:47], v[184:187], v[224:227], v[44:47]
    v_mfma_f32_16x16x32_bf16 v[44:47], v[200:203], v[228:231], v[44:47]
    v_mfma_f32_16x16x32_bf16 v[60:63], v[188:191], v[224:227], v[60:63]
    v_mfma_f32_16x16x32_bf16 v[60:63], v[204:207], v[228:231], v[60:63]
L_P2T:
    buffer_load_dwordx4 v[76:79], v73, s[24:27], s69 offen
    v_add_u32 v253, s78, v254
    v_xor_b32 v255, 64, v253
    ds_write_b128 v253, v[8:11] offset:0
    ds_write_b128 v255, v[24:27] offset:0
    ds_write_b128 v253, v[40:43] offset:128
    ds_write_b128 v255, v[56:59] offset:128
    v_add_u32 v253, s79, v254
    v_xor_b32 v255, 64, v253
    ds_write_b128 v253, v[12:15] offset:0
    ds_write_b128 v255, v[28:31] offset:0
    ds_write_b128 v253, v[44:47] offset:128
    ds_write_b128 v255, v[60:63] offset:128
    s_waitcnt lgkmcnt(0)
    s_barrier
    ds_read_b128 v[96:99], v81 offset:0
    ds_read_b128 v[100:103], v82 offset:0
    ds_read_b128 v[104:107], v81 offset:4096
    ds_read_b128 v[108:111], v82 offset:4096
    ds_read_b128 v[112:115], v81 offset:8192
    ds_read_b128 v[116:119], v82 offset:8192
    ds_read_b128 v[120:123], v81 offset:12288
    ds_read_b128 v[124:127], v82 offset:12288
    ds_read_b128 v[128:131], v83 offset:0
    ds_read_b128 v[132:135], v84 offset:0
    ds_read_b128 v[136:139], v83 offset:4096
    ds_read_b128 v[140:143], v84 offset:4096
    ds_read_b128 v[144:147], v83 offset:8192
    ds_read_b128 v[148:151], v84 offset:8192
    ds_read_b128 v[152:155], v83 offset:12288
    ds_read_b128 v[156:159], v84 offset:12288
    s_waitcnt vmcnt(0)
    v_lshlrev_b32 v160, 16, v76
    v_and_b32 v161, 0xffff0000, v76
    v_lshlrev_b32 v162, 16, v77
    v_and_b32 v163, 0xffff0000, v77
    v_lshlrev_b32 v164, 16, v78
    v_and_b32 v165, 0xffff0000, v78
    v_lshlrev_b32 v166, 16, v79
    v_and_b32 v167, 0xffff0000, v79
    s_waitcnt lgkmcnt(14)
    v_pk_add_f32 v[160:161], v[160:161], v[96:97]
    v_pk_add_f32 v[162:163], v[162:163], v[98:99]
    v_pk_add_f32 v[164:165], v[164:165], v[100:101]
    v_pk_add_f32 v[166:167], v[166:167], v[102:103]
    s_waitcnt lgkmcnt(12)
    v_pk_add_f32 v[160:161], v[160:161], v[104:105]
    v_pk_add_f32 v[162:163], v[162:163], v[106:107]
    v_pk_add_f32 v[164:165], v[164:165], v[108:109]
    v_pk_add_f32 v[166:167], v[166:167], v[110:111]
    s_waitcnt lgkmcnt(10)
    v_pk_add_f32 v[160:161], v[160:161], v[112:113]
    v_pk_add_f32 v[162:163], v[162:163], v[114:115]
    v_pk_add_f32 v[164:165], v[164:165], v[116:117]
    v_pk_add_f32 v[166:167], v[166:167], v[118:119]
    s_waitcnt lgkmcnt(8)
    v_pk_add_f32 v[160:161], v[160:161], v[120:121]
    v_pk_add_f32 v[162:163], v[162:163], v[122:123]
    v_pk_add_f32 v[164:165], v[164:165], v[124:125]
    v_pk_add_f32 v[166:167], v[166:167], v[126:127]
    s_waitcnt lgkmcnt(6)
    v_pk_add_f32 v[160:161], v[160:161], v[128:129]
    v_pk_add_f32 v[162:163], v[162:163], v[130:131]
    v_pk_add_f32 v[164:165], v[164:165], v[132:133]
    v_pk_add_f32 v[166:167], v[166:167], v[134:135]
    s_waitcnt lgkmcnt(4)
    v_pk_add_f32 v[160:161], v[160:161], v[136:137]
    v_pk_add_f32 v[162:163], v[162:163], v[138:139]
    v_pk_add_f32 v[164:165], v[164:165], v[140:141]
    v_pk_add_f32 v[166:167], v[166:167], v[142:143]
    s_waitcnt lgkmcnt(2)
    v_pk_add_f32 v[160:161], v[160:161], v[144:145]
    v_pk_add_f32 v[162:163], v[162:163], v[146:147]
    v_pk_add_f32 v[164:165], v[164:165], v[148:149]
    v_pk_add_f32 v[166:167], v[166:167], v[150:151]
    s_waitcnt lgkmcnt(0)
    v_pk_add_f32 v[160:161], v[160:161], v[152:153]
    v_pk_add_f32 v[162:163], v[162:163], v[154:155]
    v_pk_add_f32 v[164:165], v[164:165], v[156:157]
    v_pk_add_f32 v[166:167], v[166:167], v[158:159]
    v_cvt_pk_bf16_f32 v168, v160, v161
    v_cvt_pk_bf16_f32 v169, v162, v163
    v_cvt_pk_bf16_f32 v170, v164, v165
    v_cvt_pk_bf16_f32 v171, v166, v167
    buffer_store_dwordx4 v[168:171], v73, s[52:55], s69 offen
L_end:
    s_endpgm
.section .rodata,"a"
.p2align 6
.amdhsa_kernel parallel_sum__sliding_local_dilated__glu_gated_reglu__prompt_kernel
  .amdhsa_next_free_vgpr 256
  .amdhsa_next_free_sgpr 102
  .amdhsa_accum_offset 256
  .amdhsa_group_segment_fixed_size 0
  .amdhsa_kernarg_size 80
  .amdhsa_user_sgpr_count 2
  .amdhsa_user_sgpr_kernarg_segment_ptr 1
  .amdhsa_system_sgpr_workgroup_id_x 1
  .amdhsa_float_denorm_mode_32 3
.end_amdhsa_kernel
```
